```python
import torch

def _softmax(x, axis=-1):
    return torch.softmax(x, dim=axis)
def _gelu(x):
    return torch.nn.functional.gelu(x, approximate="tanh")
def _silu(x):
    return torch.nn.functional.silu(x)
def _sigmoid(x):
    return torch.sigmoid(x)
def _layernorm(x, axis=-1, eps=1e-5):
    m = x.mean(dim=axis, keepdim=True)
    v = x.var(dim=axis, keepdim=True, unbiased=False)
    return (x - m) / torch.sqrt(v + eps)
def _scatter_add(tgt, idx, src, axis=0):
    return tgt.clone().index_add_(axis, idx, src)
def _segment_sum(src, seg, n):
    out = torch.zeros((n,) + src.shape[1:], dtype=src.dtype)
    return out.index_add_(0, seg, src)
def _pad(x, pw):
    flat = tuple(v for pair in reversed(pw) for v in pair)
    return torch.nn.functional.pad(x, flat)

kernel_name = 'interleave_layers__spectral_fnet__dense_activation_relu__prompt'

def setup_inputs():

    _w = (lambda a: (lambda t: t.to(torch.bfloat16) if t.is_floating_point() else t)(torch.as_tensor(a)))
    def _A_setup():
        B, S, D = 1, 2048, 640
        ns = torch.arange(S)[:, None] * torch.arange(S)[None, :]
        nd = torch.arange(D)[:, None] * torch.arange(D)[None, :]
        Ws_re = torch.cos(-2.0 * torch.pi * ns / S).to(float)
        Ws_im = torch.sin(-2.0 * torch.pi * ns / S).to(float)
        Wd_re = torch.cos(-2.0 * torch.pi * nd / D).to(float)
        Wd_im = torch.sin(-2.0 * torch.pi * nd / D).to(float)
        return {
            "x": _w((lambda *s: torch.randn(*s, dtype=torch.bfloat16) * 0.05)(B, S, D)),
            "dft_seq_re": _w(Ws_re),
            "dft_seq_im": _w(Ws_im),
            "dft_hid_re": _w(Wd_re),
            "dft_hid_im": _w(Wd_im),
        }
    _A_in = _A_setup()

    def _B_setup():
        B, S, D, Dff = 1, 2048, 640, 1536
        return {
            "x": _w((lambda *s: torch.randn(*s, dtype=torch.bfloat16) * 0.05)(B, S, D)),
            "w1": _w((lambda *s: torch.randn(*s, dtype=torch.bfloat16) * 1.6)(D, Dff)),
            "w2": _w((lambda *s: torch.randn(*s, dtype=torch.bfloat16) * 1.6)(Dff, D)),
        }
    _B_in = _B_setup()

    return {
        "A_x": _A_in["x"],
        "A_dft_seq_re": _A_in["dft_seq_re"],
        "A_dft_seq_im": _A_in["dft_seq_im"],
        "A_dft_hid_re": _A_in["dft_hid_re"],
        "A_dft_hid_im": _A_in["dft_hid_im"],
        "B_x": _B_in["x"],
        "B_w1": _B_in["w1"],
        "B_w2": _B_in["w2"],
    }

def reference(A_x, A_dft_seq_re, A_dft_seq_im, A_dft_hid_re, A_dft_hid_im, B_x, B_w1, B_w2):
    def _A_ref(x, dft_seq_re, dft_seq_im, dft_hid_re, dft_hid_im):
        a = torch.einsum("bsd,ed->bse", x, dft_hid_re)
        b = torch.einsum("bsd,ed->bse", x, dft_hid_im)
        y = torch.einsum("ts,bse->bte", dft_seq_re, a) - torch.einsum("ts,bse->bte", dft_seq_im, b)
        return y

    def _B_ref(x, w1, w2):
        h = torch.einsum("bsd,df->bsf", x, w1)
        zero = torch.zeros_like(h)
        h = torch.maximum(h, zero)
        return torch.einsum("bsf,fd->bsd", h, w2)

    x = A_x
    x = x + _A_ref(_layernorm(x, axis=-1), A_dft_seq_re, A_dft_seq_im, A_dft_hid_re, A_dft_hid_im)
    x = x + _B_ref(_layernorm(x, axis=-1), B_w1, B_w2)
    x = x + _A_ref(_layernorm(x, axis=-1), A_dft_seq_re, A_dft_seq_im, A_dft_hid_re, A_dft_hid_im)
    x = x + _B_ref(_layernorm(x, axis=-1), B_w1, B_w2)
    return x
```

```asm
; @launch grid=(256,1,1) block=(256,1,1) lds=160768
.amdgcn_target "amdgcn-amd-amdhsa--gfx950"
.text
.globl interleave_layers__spectral_fnet__dense_activation_relu__prompt_kernel
.p2align 8
.type interleave_layers__spectral_fnet__dense_activation_relu__prompt_kernel,@function
interleave_layers__spectral_fnet__dense_activation_relu__prompt_kernel:
    s_cmp_ge_u32 s2, 256
    s_cbranch_scc1 k2_done
    s_getpc_b64 s[40:41]
k2_pc:
    s_sub_u32 s40, s40, k2_pc-interleave_layers__spectral_fnet__dense_activation_relu__prompt_kernel
    s_subb_u32 s41, s41, 0
    s_mov_b32 s42, k2_end-interleave_layers__spectral_fnet__dense_activation_relu__prompt_kernel
    s_mov_b32 s43, 0x20000
    s_lshr_b32 s23, s2, 3
    s_lshl_b32 s23, s23, 10
    v_lshl_add_u32 v14, v0, 2, s23
    v_add_u32 v15, 0x8000, v14
    buffer_load_dword v12, v14, s[40:43], 0 offen
    buffer_load_dword v12, v15, s[40:43], 0 offen
    s_load_dwordx2 s[4:5], s[0:1], 0
    s_load_dwordx4 s[60:63], s[0:1], 48
    s_load_dwordx2 s[12:13], s[0:1], 64
    s_load_dwordx2 s[52:53], s[0:1], 72
    s_load_dwordx2 s[8:9], s[0:1], 80
    s_memrealtime s[46:47]
    v_lshrrev_b32 v1, 6, v0
    s_mov_b32 s6, 2621440
    s_mov_b32 s7, 0x20000
    v_readfirstlane_b32 s18, v1
    s_mov_b32 s10, 268435456
    s_mov_b32 s11, 0x20000
    s_mov_b32 s14, 2621440
    s_mov_b32 s15, 0x20000
    s_mov_b32 s54, 256
    s_mov_b32 s55, 0x20000
    s_and_b32 s16, s2, 7
    s_lshr_b32 s23, s2, 6
    s_lshl_b32 s23, s23, 3
    s_or_b32 s16, s16, s23
    s_lshr_b32 s17, s2, 3
    s_and_b32 s17, s17, 7
    s_lshr_b32 s19, s17, 2
    s_sub_u32 s20, 64, s16
    s_cmp_eq_u32 s16, 0
    s_cselect_b32 s20, 32, s20
    s_cmp_eq_u32 s19, 0
    s_cselect_b32 s20, s16, s20
    s_and_b32 s23, s17, 3
    s_mul_i32 s21, s23, 5
    s_add_u32 s21, s21, 1
    s_lshr_b32 s21, s21, 1
    s_and_b32 s23, s23, 1
    s_sub_u32 s22, 3, s23
    v_lshrrev_b32 v1, 3, v0
    v_and_b32 v2, 7, v0
    v_lshlrev_b32 v3, 6, v1
    v_add_u32 v3, s20, v3
    v_mul_u32_u24 v3, 1280, v3
    v_lshl_add_u32 v4, v2, 4, v3
    v_add_u32 v4, 0, v4
    v_lshlrev_b32 v5, 4, v2
    v_sub_u32 v5, v3, v5
    v_add_u32 v5, 752, v5
    v_mov_b32 v10, 0
    s_waitcnt lgkmcnt(0)
    buffer_load_dwordx4 v[216:219], v4, s[4:7], 0 offen offset:0
    buffer_load_dwordx4 v[220:223], v5, s[4:7], 0 offen offset:512
    buffer_load_dwordx4 v[224:227], v4, s[4:7], 0 offen offset:128
    buffer_load_dwordx4 v[228:231], v5, s[4:7], 0 offen offset:384
    buffer_load_dwordx4 v[232:235], v4, s[4:7], 0 offen offset:256
    buffer_load_dwordx4 v[236:239], v5, s[4:7], 0 offen offset:256
    buffer_load_dwordx4 v[240:243], v4, s[4:7], 0 offen offset:384
    buffer_load_dwordx4 v[244:247], v5, s[4:7], 0 offen offset:128
    buffer_load_dwordx4 v[248:251], v4, s[4:7], 0 offen offset:512
    buffer_load_dwordx4 v[252:255], v5, s[4:7], 0 offen offset:0
    s_lshl_b32 s56, s2, 2
    s_add_u32 s56, s56, s18
    s_cmp_lg_u32 s56, 0
    s_cbranch_scc1 k2_non
    s_or_b32 s46, s46, 1
    v_mov_b32 v11, s46
    s_mov_b64 exec, 1
    buffer_store_dword v11, v10, s[52:55], 0 offen sc1
    s_mov_b64 exec, -1
k2_non:
    v_mul_u32_u24 v6, 528, v2
    v_lshl_add_u32 v6, v1, 4, v6
    v_cmp_eq_u32 s[30:31], 7, v2
    v_lshlrev_b32 v8, 2, v1
    v_and_b32 v0, 63, v0
    s_add_u32 s21, s21, s18
    v_and_b32 v1, 15, v0
    v_lshrrev_b32 v2, 4, v0
    v_lshlrev_b32 v3, 4, v0
    s_mov_b32 s51, 0x20000
    s_lshr_b32 s59, s2, 5
    s_and_b32 s56, s2, 31
    s_lshl_b32 s57, s56, 1
    s_add_u32 s57, s57, s18
    s_min_u32 s57, s57, 60
    s_lshr_b32 s23, s56, 4
    s_lshl_b32 s23, s23, 3
    s_and_b32 s38, s56, 7
    s_add_u32 s23, s23, s38
    s_add_u32 s23, s23, 32
    s_cmp_eq_u32 s18, 3
    s_cselect_b32 s56, s56, s23
    s_add_u32 s56, s56, 61
    s_cmp_lt_u32 s18, s22
    s_cselect_b32 s56, 60, s56
    s_cmp_lt_u32 s18, 2
    s_cselect_b32 s56, s57, s56
    s_lshl_b32 s23, s18, 2
    s_lshl_b32 s45, s16, 8
    s_lshl_b32 s38, s17, 4
    s_add_u32 s45, s45, s38
    s_add_u32 s45, s45, s23
    s_lshl_b32 s98, s2, 7
    s_add_u32 s98, s98, s23
    s_add_u32 s98, s98, 32768
    s_mov_b64 exec, 1
    buffer_store_dword v10, v10, s[8:11], s45 offen offset:0
    s_mov_b64 exec, 3
    v_lshlrev_b32 v13, 4, v0
    buffer_store_dword v10, v13, s[8:11], s98 offen sc1
    s_mov_b64 exec, -1
    buffer_load_dword v11, v10, s[52:55], 0 offen sc1
    s_mov_b32 s48, s60
    s_mov_b32 s49, s61
    s_mov_b32 s50, 1966080
    s_mul_i32 s57, s56, 171
    s_lshr_b32 s57, s57, 9
    s_sub_u32 s58, s59, s57
    s_mul_i32 s58, s58, 3
    s_add_u32 s58, s58, s56
    s_cmp_ge_u32 s57, 10
    s_cselect_b32 s33, 10, 0
    s_sub_u32 s33, s57, s33
    s_lshl_b32 s33, s33, 5
    v_lshl_add_u32 v4, v2, 3, s33
    v_add_u32 v5, 1, v4
    v_sub_u32 v7, 632, v4
    s_cmp_ge_u32 s57, 10
    s_cselect_b64 s[34:35], -1, 0
    s_cselect_b32 s36, 7, 0
    v_cndmask_b32 v5, v5, v7, s[34:35]
    v_mul_u32_u24 v5, 3072, v5
    s_lshl_b32 s33, s58, 7
    v_lshl_add_u32 v7, v1, 3, s33
    v_add_u32 v5, v5, v7
    v_cmp_eq_u32 vcc, 312, v4
    s_and_b64 vcc, vcc, s[34:35]
    s_nop 1
    v_cndmask_b32 v7, v5, v7, vcc
k2_pk2:
    s_cmp_ge_u32 s18, s22
    s_cbranch_scc1 k2_nog
    s_lshl_b32 s23, s21, 5
    s_add_u32 s23, s23, 1
    v_and_b32 v210, 31, v0
    v_add_u32 v210, s23, v210
    v_cvt_f32_u32 v210, v210
    v_mul_f32 v210, 0x3acccccd, v210
    v_lshrrev_b32 v211, 5, v0
    v_lshlrev_b32 v211, 3, v211
    v_add_u32 v211, 1, v211
    v_cvt_f32_u32 v211, v211
    v_mul_f32 v211, v211, v210
    v_mul_f32 v212, 0x41800000, v210
    v_cos_f32 v208, v212
    v_add_f32 v213, v211, v212
    v_add_f32 v208, v208, v208
    v_cos_f32 v176, v211
    v_sin_f32 v177, v211
    v_cos_f32 v192, v213
    v_sin_f32 v193, v213
    v_add_f32 v211, v211, v210
    v_add_f32 v213, v213, v210
    v_cos_f32 v178, v211
    v_sin_f32 v179, v211
    v_cos_f32 v194, v213
    v_sin_f32 v195, v213
    v_add_f32 v211, v211, v210
    v_add_f32 v213, v213, v210
    v_cos_f32 v180, v211
    v_sin_f32 v181, v211
    v_cos_f32 v196, v213
    v_sin_f32 v197, v213
    v_add_f32 v211, v211, v210
    v_add_f32 v213, v213, v210
    v_cos_f32 v182, v211
    v_sin_f32 v183, v211
    v_cos_f32 v198, v213
    v_sin_f32 v199, v213
    v_add_f32 v211, v211, v210
    v_add_f32 v213, v213, v210
    v_cos_f32 v184, v211
    v_sin_f32 v185, v211
    v_cos_f32 v200, v213
    v_sin_f32 v201, v213
    v_add_f32 v211, v211, v210
    v_add_f32 v213, v213, v210
    v_cos_f32 v186, v211
    v_sin_f32 v187, v211
    v_cos_f32 v202, v213
    v_sin_f32 v203, v213
    v_add_f32 v211, v211, v210
    v_add_f32 v213, v213, v210
    v_cos_f32 v188, v211
    v_sin_f32 v189, v211
    v_cos_f32 v204, v213
    v_sin_f32 v205, v213
    v_add_f32 v211, v211, v210
    v_add_f32 v213, v213, v210
    v_cos_f32 v190, v211
    v_sin_f32 v191, v211
    v_cos_f32 v206, v213
    v_sin_f32 v207, v213
    v_mov_b32 v209, v208
    v_cvt_pk_bf16_f32 v16, v176, v178
    v_cvt_pk_bf16_f32 v20, v177, v179
    v_cvt_pk_bf16_f32 v17, v180, v182
    v_cvt_pk_bf16_f32 v21, v181, v183
    v_cvt_pk_bf16_f32 v18, v184, v186
    v_cvt_pk_bf16_f32 v22, v185, v187
    v_cvt_pk_bf16_f32 v19, v188, v190
    v_cvt_pk_bf16_f32 v23, v189, v191
    v_cvt_pk_bf16_f32 v24, v192, v194
    v_cvt_pk_bf16_f32 v28, v193, v195
    v_cvt_pk_bf16_f32 v25, v196, v198
    v_cvt_pk_bf16_f32 v29, v197, v199
    v_cvt_pk_bf16_f32 v26, v200, v202
    v_cvt_pk_bf16_f32 v30, v201, v203
    v_cvt_pk_bf16_f32 v27, v204, v206
    v_cvt_pk_bf16_f32 v31, v205, v207
    s_cmp_ge_u32 s56, 60
    s_cbranch_scc1 k2_nw1
    s_xor_b32 s37, s36, 0
    s_mul_i32 s37, s37, 3072
    buffer_load_dwordx2 a[0:1], v5, s[48:51], s37 offen
    s_xor_b32 s37, s36, 1
    s_mul_i32 s37, s37, 3072
    buffer_load_dwordx2 a[2:3], v5, s[48:51], s37 offen
    s_xor_b32 s37, s36, 2
    s_mul_i32 s37, s37, 3072
    buffer_load_dwordx2 a[4:5], v5, s[48:51], s37 offen
    s_xor_b32 s37, s36, 3
    s_mul_i32 s37, s37, 3072
    buffer_load_dwordx2 a[6:7], v5, s[48:51], s37 offen
    s_xor_b32 s37, s36, 4
    s_mul_i32 s37, s37, 3072
    buffer_load_dwordx2 a[8:9], v5, s[48:51], s37 offen
    s_xor_b32 s37, s36, 5
    s_mul_i32 s37, s37, 3072
    buffer_load_dwordx2 a[10:11], v5, s[48:51], s37 offen
    s_xor_b32 s37, s36, 6
    s_mul_i32 s37, s37, 3072
    buffer_load_dwordx2 a[12:13], v5, s[48:51], s37 offen
    s_xor_b32 s37, s36, 7
    s_mul_i32 s37, s37, 3072
    buffer_load_dwordx2 a[14:15], v7, s[48:51], s37 offen
k2_nw1:
    v_pk_fma_f32 v[176:177], v[192:193], v[208:209], v[176:177] neg_lo:[0,0,1] neg_hi:[0,0,1]
    v_pk_fma_f32 v[178:179], v[194:195], v[208:209], v[178:179] neg_lo:[0,0,1] neg_hi:[0,0,1]
    v_pk_fma_f32 v[180:181], v[196:197], v[208:209], v[180:181] neg_lo:[0,0,1] neg_hi:[0,0,1]
    v_pk_fma_f32 v[182:183], v[198:199], v[208:209], v[182:183] neg_lo:[0,0,1] neg_hi:[0,0,1]
    v_pk_fma_f32 v[184:185], v[200:201], v[208:209], v[184:185] neg_lo:[0,0,1] neg_hi:[0,0,1]
    v_pk_fma_f32 v[186:187], v[202:203], v[208:209], v[186:187] neg_lo:[0,0,1] neg_hi:[0,0,1]
    v_pk_fma_f32 v[188:189], v[204:205], v[208:209], v[188:189] neg_lo:[0,0,1] neg_hi:[0,0,1]
    v_pk_fma_f32 v[190:191], v[206:207], v[208:209], v[190:191] neg_lo:[0,0,1] neg_hi:[0,0,1]
    v_cvt_pk_bf16_f32 v32, v176, v178
    v_cvt_pk_bf16_f32 v36, v177, v179
    v_cvt_pk_bf16_f32 v33, v180, v182
    v_cvt_pk_bf16_f32 v37, v181, v183
    v_cvt_pk_bf16_f32 v34, v184, v186
    v_cvt_pk_bf16_f32 v38, v185, v187
    v_cvt_pk_bf16_f32 v35, v188, v190
    v_cvt_pk_bf16_f32 v39, v189, v191
    v_pk_fma_f32 v[192:193], v[176:177], v[208:209], v[192:193] neg_lo:[0,0,1] neg_hi:[0,0,1]
    v_pk_fma_f32 v[194:195], v[178:179], v[208:209], v[194:195] neg_lo:[0,0,1] neg_hi:[0,0,1]
    v_pk_fma_f32 v[196:197], v[180:181], v[208:209], v[196:197] neg_lo:[0,0,1] neg_hi:[0,0,1]
    v_pk_fma_f32 v[198:199], v[182:183], v[208:209], v[198:199] neg_lo:[0,0,1] neg_hi:[0,0,1]
    v_pk_fma_f32 v[200:201], v[184:185], v[208:209], v[200:201] neg_lo:[0,0,1] neg_hi:[0,0,1]
    v_pk_fma_f32 v[202:203], v[186:187], v[208:209], v[202:203] neg_lo:[0,0,1] neg_hi:[0,0,1]
    v_pk_fma_f32 v[204:205], v[188:189], v[208:209], v[204:205] neg_lo:[0,0,1] neg_hi:[0,0,1]
    v_pk_fma_f32 v[206:207], v[190:191], v[208:209], v[206:207] neg_lo:[0,0,1] neg_hi:[0,0,1]
    v_cvt_pk_bf16_f32 v40, v192, v194
    v_cvt_pk_bf16_f32 v44, v193, v195
    v_cvt_pk_bf16_f32 v41, v196, v198
    v_cvt_pk_bf16_f32 v45, v197, v199
    v_cvt_pk_bf16_f32 v42, v200, v202
    v_cvt_pk_bf16_f32 v46, v201, v203
    v_cvt_pk_bf16_f32 v43, v204, v206
    v_cvt_pk_bf16_f32 v47, v205, v207
    v_pk_fma_f32 v[176:177], v[192:193], v[208:209], v[176:177] neg_lo:[0,0,1] neg_hi:[0,0,1]
    v_pk_fma_f32 v[178:179], v[194:195], v[208:209], v[178:179] neg_lo:[0,0,1] neg_hi:[0,0,1]
    v_pk_fma_f32 v[180:181], v[196:197], v[208:209], v[180:181] neg_lo:[0,0,1] neg_hi:[0,0,1]
    v_pk_fma_f32 v[182:183], v[198:199], v[208:209], v[182:183] neg_lo:[0,0,1] neg_hi:[0,0,1]
    v_pk_fma_f32 v[184:185], v[200:201], v[208:209], v[184:185] neg_lo:[0,0,1] neg_hi:[0,0,1]
    v_pk_fma_f32 v[186:187], v[202:203], v[208:209], v[186:187] neg_lo:[0,0,1] neg_hi:[0,0,1]
    v_pk_fma_f32 v[188:189], v[204:205], v[208:209], v[188:189] neg_lo:[0,0,1] neg_hi:[0,0,1]
    v_pk_fma_f32 v[190:191], v[206:207], v[208:209], v[190:191] neg_lo:[0,0,1] neg_hi:[0,0,1]
    v_cvt_pk_bf16_f32 v48, v176, v178
    v_cvt_pk_bf16_f32 v52, v177, v179
    v_cvt_pk_bf16_f32 v49, v180, v182
    v_cvt_pk_bf16_f32 v53, v181, v183
    v_cvt_pk_bf16_f32 v50, v184, v186
    v_cvt_pk_bf16_f32 v54, v185, v187
    v_cvt_pk_bf16_f32 v51, v188, v190
    v_cvt_pk_bf16_f32 v55, v189, v191
    v_pk_fma_f32 v[192:193], v[176:177], v[208:209], v[192:193] neg_lo:[0,0,1] neg_hi:[0,0,1]
    v_pk_fma_f32 v[194:195], v[178:179], v[208:209], v[194:195] neg_lo:[0,0,1] neg_hi:[0,0,1]
    v_pk_fma_f32 v[196:197], v[180:181], v[208:209], v[196:197] neg_lo:[0,0,1] neg_hi:[0,0,1]
    v_pk_fma_f32 v[198:199], v[182:183], v[208:209], v[198:199] neg_lo:[0,0,1] neg_hi:[0,0,1]
    v_pk_fma_f32 v[200:201], v[184:185], v[208:209], v[200:201] neg_lo:[0,0,1] neg_hi:[0,0,1]
    v_pk_fma_f32 v[202:203], v[186:187], v[208:209], v[202:203] neg_lo:[0,0,1] neg_hi:[0,0,1]
    v_pk_fma_f32 v[204:205], v[188:189], v[208:209], v[204:205] neg_lo:[0,0,1] neg_hi:[0,0,1]
    v_pk_fma_f32 v[206:207], v[190:191], v[208:209], v[206:207] neg_lo:[0,0,1] neg_hi:[0,0,1]
    v_cvt_pk_bf16_f32 v56, v192, v194
    v_cvt_pk_bf16_f32 v60, v193, v195
    v_cvt_pk_bf16_f32 v57, v196, v198
    v_cvt_pk_bf16_f32 v61, v197, v199
    v_cvt_pk_bf16_f32 v58, v200, v202
    v_cvt_pk_bf16_f32 v62, v201, v203
    v_cvt_pk_bf16_f32 v59, v204, v206
    v_cvt_pk_bf16_f32 v63, v205, v207
    v_pk_fma_f32 v[176:177], v[192:193], v[208:209], v[176:177] neg_lo:[0,0,1] neg_hi:[0,0,1]
    v_pk_fma_f32 v[178:179], v[194:195], v[208:209], v[178:179] neg_lo:[0,0,1] neg_hi:[0,0,1]
    v_pk_fma_f32 v[180:181], v[196:197], v[208:209], v[180:181] neg_lo:[0,0,1] neg_hi:[0,0,1]
    v_pk_fma_f32 v[182:183], v[198:199], v[208:209], v[182:183] neg_lo:[0,0,1] neg_hi:[0,0,1]
    v_pk_fma_f32 v[184:185], v[200:201], v[208:209], v[184:185] neg_lo:[0,0,1] neg_hi:[0,0,1]
    v_pk_fma_f32 v[186:187], v[202:203], v[208:209], v[186:187] neg_lo:[0,0,1] neg_hi:[0,0,1]
    v_pk_fma_f32 v[188:189], v[204:205], v[208:209], v[188:189] neg_lo:[0,0,1] neg_hi:[0,0,1]
    v_pk_fma_f32 v[190:191], v[206:207], v[208:209], v[190:191] neg_lo:[0,0,1] neg_hi:[0,0,1]
    v_cvt_pk_bf16_f32 v64, v176, v178
    v_cvt_pk_bf16_f32 v68, v177, v179
    v_cvt_pk_bf16_f32 v65, v180, v182
    v_cvt_pk_bf16_f32 v69, v181, v183
    v_cvt_pk_bf16_f32 v66, v184, v186
    v_cvt_pk_bf16_f32 v70, v185, v187
    v_cvt_pk_bf16_f32 v67, v188, v190
    v_cvt_pk_bf16_f32 v71, v189, v191
    v_pk_fma_f32 v[192:193], v[176:177], v[208:209], v[192:193] neg_lo:[0,0,1] neg_hi:[0,0,1]
    v_pk_fma_f32 v[194:195], v[178:179], v[208:209], v[194:195] neg_lo:[0,0,1] neg_hi:[0,0,1]
    v_pk_fma_f32 v[196:197], v[180:181], v[208:209], v[196:197] neg_lo:[0,0,1] neg_hi:[0,0,1]
    v_pk_fma_f32 v[198:199], v[182:183], v[208:209], v[198:199] neg_lo:[0,0,1] neg_hi:[0,0,1]
    v_pk_fma_f32 v[200:201], v[184:185], v[208:209], v[200:201] neg_lo:[0,0,1] neg_hi:[0,0,1]
    v_pk_fma_f32 v[202:203], v[186:187], v[208:209], v[202:203] neg_lo:[0,0,1] neg_hi:[0,0,1]
    v_pk_fma_f32 v[204:205], v[188:189], v[208:209], v[204:205] neg_lo:[0,0,1] neg_hi:[0,0,1]
    v_pk_fma_f32 v[206:207], v[190:191], v[208:209], v[206:207] neg_lo:[0,0,1] neg_hi:[0,0,1]
    v_cvt_pk_bf16_f32 v72, v192, v194
    v_cvt_pk_bf16_f32 v76, v193, v195
    v_cvt_pk_bf16_f32 v73, v196, v198
    v_cvt_pk_bf16_f32 v77, v197, v199
    v_cvt_pk_bf16_f32 v74, v200, v202
    v_cvt_pk_bf16_f32 v78, v201, v203
    v_cvt_pk_bf16_f32 v75, v204, v206
    v_cvt_pk_bf16_f32 v79, v205, v207
    v_pk_fma_f32 v[176:177], v[192:193], v[208:209], v[176:177] neg_lo:[0,0,1] neg_hi:[0,0,1]
    v_pk_fma_f32 v[178:179], v[194:195], v[208:209], v[178:179] neg_lo:[0,0,1] neg_hi:[0,0,1]
    v_pk_fma_f32 v[180:181], v[196:197], v[208:209], v[180:181] neg_lo:[0,0,1] neg_hi:[0,0,1]
    v_pk_fma_f32 v[182:183], v[198:199], v[208:209], v[182:183] neg_lo:[0,0,1] neg_hi:[0,0,1]
    v_pk_fma_f32 v[184:185], v[200:201], v[208:209], v[184:185] neg_lo:[0,0,1] neg_hi:[0,0,1]
    v_pk_fma_f32 v[186:187], v[202:203], v[208:209], v[186:187] neg_lo:[0,0,1] neg_hi:[0,0,1]
    v_pk_fma_f32 v[188:189], v[204:205], v[208:209], v[188:189] neg_lo:[0,0,1] neg_hi:[0,0,1]
    v_pk_fma_f32 v[190:191], v[206:207], v[208:209], v[190:191] neg_lo:[0,0,1] neg_hi:[0,0,1]
    v_cvt_pk_bf16_f32 v80, v176, v178
    v_cvt_pk_bf16_f32 v84, v177, v179
    v_cvt_pk_bf16_f32 v81, v180, v182
    v_cvt_pk_bf16_f32 v85, v181, v183
    v_cvt_pk_bf16_f32 v82, v184, v186
    v_cvt_pk_bf16_f32 v86, v185, v187
    v_cvt_pk_bf16_f32 v83, v188, v190
    v_cvt_pk_bf16_f32 v87, v189, v191
    v_pk_fma_f32 v[192:193], v[176:177], v[208:209], v[192:193] neg_lo:[0,0,1] neg_hi:[0,0,1]
    v_pk_fma_f32 v[194:195], v[178:179], v[208:209], v[194:195] neg_lo:[0,0,1] neg_hi:[0,0,1]
    v_pk_fma_f32 v[196:197], v[180:181], v[208:209], v[196:197] neg_lo:[0,0,1] neg_hi:[0,0,1]
    v_pk_fma_f32 v[198:199], v[182:183], v[208:209], v[198:199] neg_lo:[0,0,1] neg_hi:[0,0,1]
    v_pk_fma_f32 v[200:201], v[184:185], v[208:209], v[200:201] neg_lo:[0,0,1] neg_hi:[0,0,1]
    v_pk_fma_f32 v[202:203], v[186:187], v[208:209], v[202:203] neg_lo:[0,0,1] neg_hi:[0,0,1]
    v_pk_fma_f32 v[204:205], v[188:189], v[208:209], v[204:205] neg_lo:[0,0,1] neg_hi:[0,0,1]
    v_pk_fma_f32 v[206:207], v[190:191], v[208:209], v[206:207] neg_lo:[0,0,1] neg_hi:[0,0,1]
    v_cvt_pk_bf16_f32 v88, v192, v194
    v_cvt_pk_bf16_f32 v92, v193, v195
    v_cvt_pk_bf16_f32 v89, v196, v198
    v_cvt_pk_bf16_f32 v93, v197, v199
    v_cvt_pk_bf16_f32 v90, v200, v202
    v_cvt_pk_bf16_f32 v94, v201, v203
    v_cvt_pk_bf16_f32 v91, v204, v206
    v_cvt_pk_bf16_f32 v95, v205, v207
    v_pk_fma_f32 v[176:177], v[192:193], v[208:209], v[176:177] neg_lo:[0,0,1] neg_hi:[0,0,1]
    v_pk_fma_f32 v[178:179], v[194:195], v[208:209], v[178:179] neg_lo:[0,0,1] neg_hi:[0,0,1]
    v_pk_fma_f32 v[180:181], v[196:197], v[208:209], v[180:181] neg_lo:[0,0,1] neg_hi:[0,0,1]
    v_pk_fma_f32 v[182:183], v[198:199], v[208:209], v[182:183] neg_lo:[0,0,1] neg_hi:[0,0,1]
    v_pk_fma_f32 v[184:185], v[200:201], v[208:209], v[184:185] neg_lo:[0,0,1] neg_hi:[0,0,1]
    v_pk_fma_f32 v[186:187], v[202:203], v[208:209], v[186:187] neg_lo:[0,0,1] neg_hi:[0,0,1]
    v_pk_fma_f32 v[188:189], v[204:205], v[208:209], v[188:189] neg_lo:[0,0,1] neg_hi:[0,0,1]
    v_pk_fma_f32 v[190:191], v[206:207], v[208:209], v[190:191] neg_lo:[0,0,1] neg_hi:[0,0,1]
    v_cvt_pk_bf16_f32 v96, v176, v178
    v_cvt_pk_bf16_f32 v100, v177, v179
    v_cvt_pk_bf16_f32 v97, v180, v182
    v_cvt_pk_bf16_f32 v101, v181, v183
    v_cvt_pk_bf16_f32 v98, v184, v186
    v_cvt_pk_bf16_f32 v102, v185, v187
    v_cvt_pk_bf16_f32 v99, v188, v190
    v_cvt_pk_bf16_f32 v103, v189, v191
    v_pk_fma_f32 v[192:193], v[176:177], v[208:209], v[192:193] neg_lo:[0,0,1] neg_hi:[0,0,1]
    v_pk_fma_f32 v[194:195], v[178:179], v[208:209], v[194:195] neg_lo:[0,0,1] neg_hi:[0,0,1]
    v_pk_fma_f32 v[196:197], v[180:181], v[208:209], v[196:197] neg_lo:[0,0,1] neg_hi:[0,0,1]
    v_pk_fma_f32 v[198:199], v[182:183], v[208:209], v[198:199] neg_lo:[0,0,1] neg_hi:[0,0,1]
    v_pk_fma_f32 v[200:201], v[184:185], v[208:209], v[200:201] neg_lo:[0,0,1] neg_hi:[0,0,1]
    v_pk_fma_f32 v[202:203], v[186:187], v[208:209], v[202:203] neg_lo:[0,0,1] neg_hi:[0,0,1]
    v_pk_fma_f32 v[204:205], v[188:189], v[208:209], v[204:205] neg_lo:[0,0,1] neg_hi:[0,0,1]
    v_pk_fma_f32 v[206:207], v[190:191], v[208:209], v[206:207] neg_lo:[0,0,1] neg_hi:[0,0,1]
    v_cvt_pk_bf16_f32 v104, v192, v194
    v_cvt_pk_bf16_f32 v108, v193, v195
    v_cvt_pk_bf16_f32 v105, v196, v198
    v_cvt_pk_bf16_f32 v109, v197, v199
    v_cvt_pk_bf16_f32 v106, v200, v202
    v_cvt_pk_bf16_f32 v110, v201, v203
    v_cvt_pk_bf16_f32 v107, v204, v206
    v_cvt_pk_bf16_f32 v111, v205, v207
    v_pk_fma_f32 v[176:177], v[192:193], v[208:209], v[176:177] neg_lo:[0,0,1] neg_hi:[0,0,1]
    v_pk_fma_f32 v[178:179], v[194:195], v[208:209], v[178:179] neg_lo:[0,0,1] neg_hi:[0,0,1]
    v_pk_fma_f32 v[180:181], v[196:197], v[208:209], v[180:181] neg_lo:[0,0,1] neg_hi:[0,0,1]
    v_pk_fma_f32 v[182:183], v[198:199], v[208:209], v[182:183] neg_lo:[0,0,1] neg_hi:[0,0,1]
    v_pk_fma_f32 v[184:185], v[200:201], v[208:209], v[184:185] neg_lo:[0,0,1] neg_hi:[0,0,1]
    v_pk_fma_f32 v[186:187], v[202:203], v[208:209], v[186:187] neg_lo:[0,0,1] neg_hi:[0,0,1]
    v_pk_fma_f32 v[188:189], v[204:205], v[208:209], v[188:189] neg_lo:[0,0,1] neg_hi:[0,0,1]
    v_pk_fma_f32 v[190:191], v[206:207], v[208:209], v[190:191] neg_lo:[0,0,1] neg_hi:[0,0,1]
    v_cvt_pk_bf16_f32 v112, v176, v178
    v_cvt_pk_bf16_f32 v116, v177, v179
    v_cvt_pk_bf16_f32 v113, v180, v182
    v_cvt_pk_bf16_f32 v117, v181, v183
    v_cvt_pk_bf16_f32 v114, v184, v186
    v_cvt_pk_bf16_f32 v118, v185, v187
    v_cvt_pk_bf16_f32 v115, v188, v190
    v_cvt_pk_bf16_f32 v119, v189, v191
    v_pk_fma_f32 v[192:193], v[176:177], v[208:209], v[192:193] neg_lo:[0,0,1] neg_hi:[0,0,1]
    v_pk_fma_f32 v[194:195], v[178:179], v[208:209], v[194:195] neg_lo:[0,0,1] neg_hi:[0,0,1]
    v_pk_fma_f32 v[196:197], v[180:181], v[208:209], v[196:197] neg_lo:[0,0,1] neg_hi:[0,0,1]
    v_pk_fma_f32 v[198:199], v[182:183], v[208:209], v[198:199] neg_lo:[0,0,1] neg_hi:[0,0,1]
    v_pk_fma_f32 v[200:201], v[184:185], v[208:209], v[200:201] neg_lo:[0,0,1] neg_hi:[0,0,1]
    v_pk_fma_f32 v[202:203], v[186:187], v[208:209], v[202:203] neg_lo:[0,0,1] neg_hi:[0,0,1]
    v_pk_fma_f32 v[204:205], v[188:189], v[208:209], v[204:205] neg_lo:[0,0,1] neg_hi:[0,0,1]
    v_pk_fma_f32 v[206:207], v[190:191], v[208:209], v[206:207] neg_lo:[0,0,1] neg_hi:[0,0,1]
    v_cvt_pk_bf16_f32 v120, v192, v194
    v_cvt_pk_bf16_f32 v124, v193, v195
    v_cvt_pk_bf16_f32 v121, v196, v198
    v_cvt_pk_bf16_f32 v125, v197, v199
    v_cvt_pk_bf16_f32 v122, v200, v202
    v_cvt_pk_bf16_f32 v126, v201, v203
    v_cvt_pk_bf16_f32 v123, v204, v206
    v_cvt_pk_bf16_f32 v127, v205, v207
    v_pk_fma_f32 v[176:177], v[192:193], v[208:209], v[176:177] neg_lo:[0,0,1] neg_hi:[0,0,1]
    v_pk_fma_f32 v[178:179], v[194:195], v[208:209], v[178:179] neg_lo:[0,0,1] neg_hi:[0,0,1]
    v_pk_fma_f32 v[180:181], v[196:197], v[208:209], v[180:181] neg_lo:[0,0,1] neg_hi:[0,0,1]
    v_pk_fma_f32 v[182:183], v[198:199], v[208:209], v[182:183] neg_lo:[0,0,1] neg_hi:[0,0,1]
    v_pk_fma_f32 v[184:185], v[200:201], v[208:209], v[184:185] neg_lo:[0,0,1] neg_hi:[0,0,1]
    v_pk_fma_f32 v[186:187], v[202:203], v[208:209], v[186:187] neg_lo:[0,0,1] neg_hi:[0,0,1]
    v_pk_fma_f32 v[188:189], v[204:205], v[208:209], v[188:189] neg_lo:[0,0,1] neg_hi:[0,0,1]
    v_pk_fma_f32 v[190:191], v[206:207], v[208:209], v[190:191] neg_lo:[0,0,1] neg_hi:[0,0,1]
    v_cvt_pk_bf16_f32 v128, v176, v178
    v_cvt_pk_bf16_f32 v132, v177, v179
    v_cvt_pk_bf16_f32 v129, v180, v182
    v_cvt_pk_bf16_f32 v133, v181, v183
    v_cvt_pk_bf16_f32 v130, v184, v186
    v_cvt_pk_bf16_f32 v134, v185, v187
    v_cvt_pk_bf16_f32 v131, v188, v190
    v_cvt_pk_bf16_f32 v135, v189, v191
    v_pk_fma_f32 v[192:193], v[176:177], v[208:209], v[192:193] neg_lo:[0,0,1] neg_hi:[0,0,1]
    v_pk_fma_f32 v[194:195], v[178:179], v[208:209], v[194:195] neg_lo:[0,0,1] neg_hi:[0,0,1]
    v_pk_fma_f32 v[196:197], v[180:181], v[208:209], v[196:197] neg_lo:[0,0,1] neg_hi:[0,0,1]
    v_pk_fma_f32 v[198:199], v[182:183], v[208:209], v[198:199] neg_lo:[0,0,1] neg_hi:[0,0,1]
    v_pk_fma_f32 v[200:201], v[184:185], v[208:209], v[200:201] neg_lo:[0,0,1] neg_hi:[0,0,1]
    v_pk_fma_f32 v[202:203], v[186:187], v[208:209], v[202:203] neg_lo:[0,0,1] neg_hi:[0,0,1]
    v_pk_fma_f32 v[204:205], v[188:189], v[208:209], v[204:205] neg_lo:[0,0,1] neg_hi:[0,0,1]
    v_pk_fma_f32 v[206:207], v[190:191], v[208:209], v[206:207] neg_lo:[0,0,1] neg_hi:[0,0,1]
    v_cvt_pk_bf16_f32 v136, v192, v194
    v_cvt_pk_bf16_f32 v140, v193, v195
    v_cvt_pk_bf16_f32 v137, v196, v198
    v_cvt_pk_bf16_f32 v141, v197, v199
    v_cvt_pk_bf16_f32 v138, v200, v202
    v_cvt_pk_bf16_f32 v142, v201, v203
    v_cvt_pk_bf16_f32 v139, v204, v206
    v_cvt_pk_bf16_f32 v143, v205, v207
    v_pk_fma_f32 v[176:177], v[192:193], v[208:209], v[176:177] neg_lo:[0,0,1] neg_hi:[0,0,1]
    v_pk_fma_f32 v[178:179], v[194:195], v[208:209], v[178:179] neg_lo:[0,0,1] neg_hi:[0,0,1]
    v_pk_fma_f32 v[180:181], v[196:197], v[208:209], v[180:181] neg_lo:[0,0,1] neg_hi:[0,0,1]
    v_pk_fma_f32 v[182:183], v[198:199], v[208:209], v[182:183] neg_lo:[0,0,1] neg_hi:[0,0,1]
    v_pk_fma_f32 v[184:185], v[200:201], v[208:209], v[184:185] neg_lo:[0,0,1] neg_hi:[0,0,1]
    v_pk_fma_f32 v[186:187], v[202:203], v[208:209], v[186:187] neg_lo:[0,0,1] neg_hi:[0,0,1]
    v_pk_fma_f32 v[188:189], v[204:205], v[208:209], v[188:189] neg_lo:[0,0,1] neg_hi:[0,0,1]
    v_pk_fma_f32 v[190:191], v[206:207], v[208:209], v[190:191] neg_lo:[0,0,1] neg_hi:[0,0,1]
    v_cvt_pk_bf16_f32 v144, v176, v178
    v_cvt_pk_bf16_f32 v148, v177, v179
    v_cvt_pk_bf16_f32 v145, v180, v182
    v_cvt_pk_bf16_f32 v149, v181, v183
    v_cvt_pk_bf16_f32 v146, v184, v186
    v_cvt_pk_bf16_f32 v150, v185, v187
    v_cvt_pk_bf16_f32 v147, v188, v190
    v_cvt_pk_bf16_f32 v151, v189, v191
    v_pk_fma_f32 v[192:193], v[176:177], v[208:209], v[192:193] neg_lo:[0,0,1] neg_hi:[0,0,1]
    v_pk_fma_f32 v[194:195], v[178:179], v[208:209], v[194:195] neg_lo:[0,0,1] neg_hi:[0,0,1]
    v_pk_fma_f32 v[196:197], v[180:181], v[208:209], v[196:197] neg_lo:[0,0,1] neg_hi:[0,0,1]
    v_pk_fma_f32 v[198:199], v[182:183], v[208:209], v[198:199] neg_lo:[0,0,1] neg_hi:[0,0,1]
    v_pk_fma_f32 v[200:201], v[184:185], v[208:209], v[200:201] neg_lo:[0,0,1] neg_hi:[0,0,1]
    v_pk_fma_f32 v[202:203], v[186:187], v[208:209], v[202:203] neg_lo:[0,0,1] neg_hi:[0,0,1]
    v_pk_fma_f32 v[204:205], v[188:189], v[208:209], v[204:205] neg_lo:[0,0,1] neg_hi:[0,0,1]
    v_pk_fma_f32 v[206:207], v[190:191], v[208:209], v[206:207] neg_lo:[0,0,1] neg_hi:[0,0,1]
    v_cvt_pk_bf16_f32 v152, v192, v194
    v_cvt_pk_bf16_f32 v156, v193, v195
    v_cvt_pk_bf16_f32 v153, v196, v198
    v_cvt_pk_bf16_f32 v157, v197, v199
    v_cvt_pk_bf16_f32 v154, v200, v202
    v_cvt_pk_bf16_f32 v158, v201, v203
    v_cvt_pk_bf16_f32 v155, v204, v206
    v_cvt_pk_bf16_f32 v159, v205, v207
    v_pk_fma_f32 v[176:177], v[192:193], v[208:209], v[176:177] neg_lo:[0,0,1] neg_hi:[0,0,1]
    v_pk_fma_f32 v[178:179], v[194:195], v[208:209], v[178:179] neg_lo:[0,0,1] neg_hi:[0,0,1]
    v_pk_fma_f32 v[180:181], v[196:197], v[208:209], v[180:181] neg_lo:[0,0,1] neg_hi:[0,0,1]
    v_pk_fma_f32 v[182:183], v[198:199], v[208:209], v[182:183] neg_lo:[0,0,1] neg_hi:[0,0,1]
    v_pk_fma_f32 v[184:185], v[200:201], v[208:209], v[184:185] neg_lo:[0,0,1] neg_hi:[0,0,1]
    v_pk_fma_f32 v[186:187], v[202:203], v[208:209], v[186:187] neg_lo:[0,0,1] neg_hi:[0,0,1]
    v_pk_fma_f32 v[188:189], v[204:205], v[208:209], v[188:189] neg_lo:[0,0,1] neg_hi:[0,0,1]
    v_pk_fma_f32 v[190:191], v[206:207], v[208:209], v[190:191] neg_lo:[0,0,1] neg_hi:[0,0,1]
    v_cvt_pk_bf16_f32 v160, v176, v178
    v_cvt_pk_bf16_f32 v164, v177, v179
    v_cvt_pk_bf16_f32 v161, v180, v182
    v_cvt_pk_bf16_f32 v165, v181, v183
    v_cvt_pk_bf16_f32 v162, v184, v186
    v_cvt_pk_bf16_f32 v166, v185, v187
    v_cvt_pk_bf16_f32 v163, v188, v190
    v_cvt_pk_bf16_f32 v167, v189, v191
    v_pk_fma_f32 v[192:193], v[176:177], v[208:209], v[192:193] neg_lo:[0,0,1] neg_hi:[0,0,1]
    v_pk_fma_f32 v[194:195], v[178:179], v[208:209], v[194:195] neg_lo:[0,0,1] neg_hi:[0,0,1]
    v_pk_fma_f32 v[196:197], v[180:181], v[208:209], v[196:197] neg_lo:[0,0,1] neg_hi:[0,0,1]
    v_pk_fma_f32 v[198:199], v[182:183], v[208:209], v[198:199] neg_lo:[0,0,1] neg_hi:[0,0,1]
    v_pk_fma_f32 v[200:201], v[184:185], v[208:209], v[200:201] neg_lo:[0,0,1] neg_hi:[0,0,1]
    v_pk_fma_f32 v[202:203], v[186:187], v[208:209], v[202:203] neg_lo:[0,0,1] neg_hi:[0,0,1]
    v_pk_fma_f32 v[204:205], v[188:189], v[208:209], v[204:205] neg_lo:[0,0,1] neg_hi:[0,0,1]
    v_pk_fma_f32 v[206:207], v[190:191], v[208:209], v[206:207] neg_lo:[0,0,1] neg_hi:[0,0,1]
    v_cvt_pk_bf16_f32 v168, v192, v194
    v_cvt_pk_bf16_f32 v172, v193, v195
    v_cvt_pk_bf16_f32 v169, v196, v198
    v_cvt_pk_bf16_f32 v173, v197, v199
    v_cvt_pk_bf16_f32 v170, v200, v202
    v_cvt_pk_bf16_f32 v174, v201, v203
    v_cvt_pk_bf16_f32 v171, v204, v206
    v_cvt_pk_bf16_f32 v175, v205, v207
    s_cmp_ge_u32 s56, 60
    s_cbranch_scc1 k2_xw0
    s_waitcnt vmcnt(8)
    s_branch k2_xw
k2_xw0:
    s_waitcnt vmcnt(0)
    s_branch k2_xw
k2_nog:
    s_cmp_lg_u32 s18, 3
    s_cbranch_scc1 k2_nw3
    s_mov_b32 s38, 0
k2_m1l:
    v_and_b32 v177, 15, v0
    v_bfe_u32 v176, v0, 4, 1
    s_lshr_b32 s23, s38, 1
    v_add_u32 v176, s23, v176
    v_lshlrev_b32 v176, 3, v176
    v_lshrrev_b32 v178, 5, v0
    v_lshlrev_b32 v178, 2, v178
    s_and_b32 s23, s38, 1
    s_lshl_b32 s23, s23, 4
    v_add_u32 v178, s23, v178
    s_lshl_b32 s23, s38, 10
    s_add_u32 s23, s23, 143360
    v_lshl_add_u32 v179, v0, 4, s23
    v_mad_u32_u24 v180, v178, v177, v176
    v_cvt_f32_u32 v181, v177
    v_cvt_f32_u32 v180, v180
    v_mul_f32 v181, 0x3d000000, v181
    v_mul_f32 v180, 0x3d000000, v180
    v_fmamk_f32 v185, v181, 0x3f800000, v180
    v_fmamk_f32 v186, v181, 0x40000000, v180
    v_fmamk_f32 v187, v181, 0x40400000, v180
    v_fmamk_f32 v188, v181, 0x41000000, v180
    v_fmamk_f32 v189, v181, 0x41100000, v180
    v_fmamk_f32 v190, v181, 0x41200000, v180
    v_fmamk_f32 v191, v181, 0x41300000, v180
    v_cos_f32 v184, v180
    v_cos_f32 v185, v185
    v_cos_f32 v186, v186
    v_cos_f32 v187, v187
    v_cos_f32 v188, v188
    v_cos_f32 v189, v189
    v_cos_f32 v190, v190
    v_cos_f32 v191, v191
    s_nop 0
    v_cvt_pk_bf16_f32 v184, v184, v185
    v_cvt_pk_bf16_f32 v185, v186, v187
    v_cvt_pk_bf16_f32 v186, v188, v189
    v_cvt_pk_bf16_f32 v187, v190, v191
    ds_write_b128 v179, v[184:187] offset:0
    v_add_u32 v177, 16, v177
    s_nop 0
    v_mad_u32_u24 v180, v178, v177, v176
    v_cvt_f32_u32 v181, v177
    v_cvt_f32_u32 v180, v180
    v_mul_f32 v181, 0x3d000000, v181
    v_mul_f32 v180, 0x3d000000, v180
    v_fmamk_f32 v185, v181, 0x3f800000, v180
    v_fmamk_f32 v186, v181, 0x40000000, v180
    v_fmamk_f32 v187, v181, 0x40400000, v180
    v_fmamk_f32 v188, v181, 0x41000000, v180
    v_fmamk_f32 v189, v181, 0x41100000, v180
    v_fmamk_f32 v190, v181, 0x41200000, v180
    v_fmamk_f32 v191, v181, 0x41300000, v180
    v_cos_f32 v184, v180
    v_cos_f32 v185, v185
    v_cos_f32 v186, v186
    v_cos_f32 v187, v187
    v_cos_f32 v188, v188
    v_cos_f32 v189, v189
    v_cos_f32 v190, v190
    v_cos_f32 v191, v191
    s_nop 0
    v_cvt_pk_bf16_f32 v184, v184, v185
    v_cvt_pk_bf16_f32 v185, v186, v187
    v_cvt_pk_bf16_f32 v186, v188, v189
    v_cvt_pk_bf16_f32 v187, v190, v191
    ds_write_b128 v179, v[184:187] offset:4096
    s_add_u32 s38, s38, 1
    s_cmp_lt_u32 s38, 4
    s_cbranch_scc1 k2_m1l
k2_nw3:
    s_mov_b32 s48, s62
    s_mov_b32 s49, s63
    s_mov_b32 s50, 1966080
    s_sub_u32 s57, s56, 61
    s_mov_b32 s58, s59
    s_mul_i32 s33, s57, 43
    s_lshr_b32 s33, s33, 8
    s_mul_i32 s32, s33, 6
    s_sub_u32 s32, s57, s32
    s_mul_i32 s33, s33, 12
    s_mul_i32 s34, s32, 3
    s_add_u32 s34, s34, s33
    s_mul_i32 s35, s32, 6
    s_add_u32 s35, s35, s33
    s_sub_u32 s35, s35, 22
    v_lshrrev_b32 v4, 1, v2
    v_mul_u32_u24 v4, 3, v4
    v_add_u32 v4, s35, v4
    v_and_b32 v5, 1, v2
    s_and_b32 s36, s34, 3
    s_cmp_eq_u32 s36, 3
    s_cselect_b32 s36, 61, 1
    s_cmp_ge_u32 s32, 4
    s_cselect_b32 s36, 32, s36
    s_cselect_b64 vcc, -1, 0
    v_mov_b32 v7, s34
    v_cndmask_b32 v4, v7, v4, vcc
    v_cndmask_b32 v5, v2, v5, vcc
    v_lshrrev_b32 v7, 2, v4
    v_and_b32 v4, 3, v4
    v_lshl_add_u32 v4, v7, 6, v4
    v_lshl_add_u32 v4, v5, 4, v4
    v_mul_u32_u24 v4, 1280, v4
    s_mul_i32 s36, s36, 1280
    s_mul_i32 s33, s58, 80
    s_add_u32 s34, s33, 2
    v_lshl_add_u32 v5, v1, 2, s34
    v_add_u32 v5, v5, v4
    s_sub_u32 s34, 1276, s33
    v_lshlrev_b32 v7, 2, v1
    v_sub_u32 v7, s34, v7
    v_add_u32 v7, v7, v4
    v_lshrrev_b32 v9, 2, v1
    v_and_b32 v13, 1, v1
    v_lshl_add_u32 v9, v9, 1, v13
    s_mul_i32 s33, s58, 40
    s_add_u32 s33, s33, 32
    v_add_u32 v9, s33, v9
    v_add_u32 v13, 1, v9
    v_cmp_eq_u32 vcc, 319, v9
    v_sub_u32 v9, 639, v9
    v_and_b32 v14, 2, v1
    v_cndmask_b32 v9, v9, 0, vcc
    v_cmp_eq_u32 vcc, 0, v14
    s_nop 1
    v_cndmask_b32 v9, v9, v13, vcc
    v_lshl_add_u32 v9, v9, 1, v4
    s_mul_i32 s37, s36, 0
    s_add_u32 s37, s37, 0
    buffer_load_dword a0, v5, s[48:51], s37 offen
    buffer_load_dword a8, v7, s[48:51], s37 offen
    buffer_load_ushort a16, v9, s[48:51], s37 offen
    s_mul_i32 s37, s36, 0
    s_add_u32 s37, s37, 5120
    buffer_load_dword a1, v5, s[48:51], s37 offen
    buffer_load_dword a9, v7, s[48:51], s37 offen
    buffer_load_ushort a17, v9, s[48:51], s37 offen
    s_mul_i32 s37, s36, 0
    s_add_u32 s37, s37, 10240
    buffer_load_dword a2, v5, s[48:51], s37 offen
    buffer_load_dword a10, v7, s[48:51], s37 offen
    buffer_load_ushort a18, v9, s[48:51], s37 offen
    s_mul_i32 s37, s36, 0
    s_add_u32 s37, s37, 15360
    buffer_load_dword a3, v5, s[48:51], s37 offen
    buffer_load_dword a11, v7, s[48:51], s37 offen
    buffer_load_ushort a19, v9, s[48:51], s37 offen
    s_mul_i32 s37, s36, 1
    s_add_u32 s37, s37, 0
    buffer_load_dword a4, v5, s[48:51], s37 offen
    buffer_load_dword a12, v7, s[48:51], s37 offen
    buffer_load_ushort a20, v9, s[48:51], s37 offen
    s_mul_i32 s37, s36, 1
    s_add_u32 s37, s37, 5120
    buffer_load_dword a5, v5, s[48:51], s37 offen
    buffer_load_dword a13, v7, s[48:51], s37 offen
    buffer_load_ushort a21, v9, s[48:51], s37 offen
    s_mul_i32 s37, s36, 1
    s_add_u32 s37, s37, 10240
    buffer_load_dword a6, v5, s[48:51], s37 offen
    buffer_load_dword a14, v7, s[48:51], s37 offen
    buffer_load_ushort a22, v9, s[48:51], s37 offen
    s_mul_i32 s37, s36, 1
    s_add_u32 s37, s37, 15360
    buffer_load_dword a7, v5, s[48:51], s37 offen
    buffer_load_dword a15, v7, s[48:51], s37 offen
    buffer_load_ushort a23, v9, s[48:51], s37 offen
    s_waitcnt vmcnt(24)
k2_xw:
    v_readfirstlane_b32 s46, v11
    s_mov_b32 s32, 0x05040100
    s_mov_b32 s33, 0x07060302
    s_cmp_eq_u32 s46, 0
    s_cbranch_scc1 k2_nonw
k2_nonb:
    s_cmp_ge_u32 s56, 60
    s_cbranch_scc1 k2_pkd
    s_waitcnt vmcnt(0)
    v_accvgpr_read_b32 v176, a0
    v_accvgpr_read_b32 v177, a1
    v_accvgpr_read_b32 v178, a2
    v_accvgpr_read_b32 v179, a3
    v_accvgpr_read_b32 v180, a4
    v_accvgpr_read_b32 v181, a5
    v_accvgpr_read_b32 v182, a6
    v_accvgpr_read_b32 v183, a7
    v_accvgpr_read_b32 v184, a8
    v_accvgpr_read_b32 v185, a9
    v_accvgpr_read_b32 v186, a10
    v_accvgpr_read_b32 v187, a11
    v_accvgpr_read_b32 v188, a12
    v_accvgpr_read_b32 v189, a13
    v_accvgpr_read_b32 v190, a14
    v_accvgpr_read_b32 v191, a15
    v_perm_b32 v200, v178, v176, s32
    v_perm_b32 v201, v182, v180, s32
    v_perm_b32 v202, v186, v184, s32
    v_perm_b32 v203, v190, v188, s32
    s_lshl_b32 s34, s58, 2
    s_add_u32 s34, s34, 0
    s_mul_i32 s35, s34, 171
    s_lshr_b32 s35, s35, 9
    s_mul_i32 s36, s35, 57
    s_add_u32 s36, s36, s34
    s_mul_i32 s37, s57, 3
    s_add_u32 s36, s36, s37
    s_lshl_b32 s36, s36, 10
    s_add_u32 s36, s36, 524288
    buffer_store_dwordx4 v[200:203], v3, s[8:11], s36 offen sc1
    v_perm_b32 v204, v178, v176, s33
    v_perm_b32 v205, v182, v180, s33
    v_perm_b32 v206, v186, v184, s33
    v_perm_b32 v207, v190, v188, s33
    s_lshl_b32 s34, s58, 2
    s_add_u32 s34, s34, 1
    s_mul_i32 s35, s34, 171
    s_lshr_b32 s35, s35, 9
    s_mul_i32 s36, s35, 57
    s_add_u32 s36, s36, s34
    s_mul_i32 s37, s57, 3
    s_add_u32 s36, s36, s37
    s_lshl_b32 s36, s36, 10
    s_add_u32 s36, s36, 524288
    buffer_store_dwordx4 v[204:207], v3, s[8:11], s36 offen sc1
    v_perm_b32 v208, v179, v177, s32
    v_perm_b32 v209, v183, v181, s32
    v_perm_b32 v210, v187, v185, s32
    v_perm_b32 v211, v191, v189, s32
    s_lshl_b32 s34, s58, 2
    s_add_u32 s34, s34, 2
    s_mul_i32 s35, s34, 171
    s_lshr_b32 s35, s35, 9
    s_mul_i32 s36, s35, 57
    s_add_u32 s36, s36, s34
    s_mul_i32 s37, s57, 3
    s_add_u32 s36, s36, s37
    s_lshl_b32 s36, s36, 10
    s_add_u32 s36, s36, 524288
    buffer_store_dwordx4 v[208:211], v3, s[8:11], s36 offen sc1
    v_perm_b32 v212, v179, v177, s33
    v_perm_b32 v213, v183, v181, s33
    v_perm_b32 v214, v187, v185, s33
    v_perm_b32 v215, v191, v189, s33
    s_lshl_b32 s34, s58, 2
    s_add_u32 s34, s34, 3
    s_mul_i32 s35, s34, 171
    s_lshr_b32 s35, s35, 9
    s_mul_i32 s36, s35, 57
    s_add_u32 s36, s36, s34
    s_mul_i32 s37, s57, 3
    s_add_u32 s36, s36, s37
    s_lshl_b32 s36, s36, 10
    s_add_u32 s36, s36, 524288
    buffer_store_dwordx4 v[212:215], v3, s[8:11], s36 offen sc1
    s_nop 1
k2_pkd:
    v_mov_b32 v212, 0
    v_mov_b32 v213, 0
    v_mov_b32 v214, 0
    v_mov_b32 v215, 0
    v_mov_b32_dpp v14, v216 row_shl:1 row_mask:0xf bank_mask:0xf
    v_mov_b32_dpp v15, v224 row_shr:7 row_mask:0xf bank_mask:0xf
    v_cndmask_b32 v14, v14, v15, s[30:31]
    v_and_b32 v180, 0xffff0000, v216
    v_lshlrev_b32 v181, 16, v217
    v_and_b32 v188, 0xffff0000, v223
    v_lshlrev_b32 v189, 16, v223
    v_and_b32 v182, 0xffff0000, v217
    v_lshlrev_b32 v183, 16, v218
    v_and_b32 v190, 0xffff0000, v222
    v_lshlrev_b32 v191, 16, v222
    v_and_b32 v184, 0xffff0000, v218
    v_lshlrev_b32 v185, 16, v219
    v_and_b32 v192, 0xffff0000, v221
    v_lshlrev_b32 v193, 16, v221
    v_and_b32 v186, 0xffff0000, v219
    v_lshlrev_b32 v187, 16, v14
    v_and_b32 v194, 0xffff0000, v220
    v_lshlrev_b32 v195, 16, v220
    v_pk_add_f32 v[196:197], v[180:181], v[188:189]
    v_pk_add_f32 v[204:205], v[180:181], v[188:189] neg_lo:[0,1] neg_hi:[0,1]
    v_pk_fma_f32 v[214:215], v[180:181], v[180:181], v[214:215]
    v_pk_add_f32 v[212:213], v[212:213], v[196:197]
    v_pk_fma_f32 v[214:215], v[188:189], v[188:189], v[214:215]
    v_pk_add_f32 v[198:199], v[182:183], v[190:191]
    v_pk_add_f32 v[206:207], v[182:183], v[190:191] neg_lo:[0,1] neg_hi:[0,1]
    v_pk_fma_f32 v[214:215], v[182:183], v[182:183], v[214:215]
    v_pk_add_f32 v[212:213], v[212:213], v[198:199]
    v_pk_fma_f32 v[214:215], v[190:191], v[190:191], v[214:215]
    v_pk_add_f32 v[200:201], v[184:185], v[192:193]
    v_pk_add_f32 v[208:209], v[184:185], v[192:193] neg_lo:[0,1] neg_hi:[0,1]
    v_pk_fma_f32 v[214:215], v[184:185], v[184:185], v[214:215]
    v_pk_add_f32 v[212:213], v[212:213], v[200:201]
    v_pk_fma_f32 v[214:215], v[192:193], v[192:193], v[214:215]
    v_pk_add_f32 v[202:203], v[186:187], v[194:195]
    v_pk_add_f32 v[210:211], v[186:187], v[194:195] neg_lo:[0,1] neg_hi:[0,1]
    v_pk_fma_f32 v[214:215], v[186:187], v[186:187], v[214:215]
    v_pk_add_f32 v[212:213], v[212:213], v[202:203]
    v_pk_fma_f32 v[214:215], v[194:195], v[194:195], v[214:215]
    v_cvt_pk_bf16_f32 v196, v196, v197
    v_cvt_pk_bf16_f32 v197, v198, v199
    v_cvt_pk_bf16_f32 v198, v200, v201
    v_cvt_pk_bf16_f32 v199, v202, v203
    v_cvt_pk_bf16_f32 v204, v204, v205
    v_cvt_pk_bf16_f32 v205, v206, v207
    v_cvt_pk_bf16_f32 v206, v208, v209
    v_cvt_pk_bf16_f32 v207, v210, v211
    ds_write_b128 v6, v[196:199] offset:0
    ds_write_b128 v6, v[204:207] offset:21120
    v_mov_b32_dpp v14, v224 row_shl:1 row_mask:0xf bank_mask:0xf
    v_mov_b32_dpp v15, v232 row_shr:7 row_mask:0xf bank_mask:0xf
    v_cndmask_b32 v14, v14, v15, s[30:31]
    v_and_b32 v180, 0xffff0000, v224
    v_lshlrev_b32 v181, 16, v225
    v_and_b32 v188, 0xffff0000, v231
    v_lshlrev_b32 v189, 16, v231
    v_and_b32 v182, 0xffff0000, v225
    v_lshlrev_b32 v183, 16, v226
    v_and_b32 v190, 0xffff0000, v230
    v_lshlrev_b32 v191, 16, v230
    v_and_b32 v184, 0xffff0000, v226
    v_lshlrev_b32 v185, 16, v227
    v_and_b32 v192, 0xffff0000, v229
    v_lshlrev_b32 v193, 16, v229
    v_and_b32 v186, 0xffff0000, v227
    v_lshlrev_b32 v187, 16, v14
    v_and_b32 v194, 0xffff0000, v228
    v_lshlrev_b32 v195, 16, v228
    v_pk_add_f32 v[196:197], v[180:181], v[188:189]
    v_pk_add_f32 v[204:205], v[180:181], v[188:189] neg_lo:[0,1] neg_hi:[0,1]
    v_pk_fma_f32 v[214:215], v[180:181], v[180:181], v[214:215]
    v_pk_add_f32 v[212:213], v[212:213], v[196:197]
    v_pk_fma_f32 v[214:215], v[188:189], v[188:189], v[214:215]
    v_pk_add_f32 v[198:199], v[182:183], v[190:191]
    v_pk_add_f32 v[206:207], v[182:183], v[190:191] neg_lo:[0,1] neg_hi:[0,1]
    v_pk_fma_f32 v[214:215], v[182:183], v[182:183], v[214:215]
    v_pk_add_f32 v[212:213], v[212:213], v[198:199]
    v_pk_fma_f32 v[214:215], v[190:191], v[190:191], v[214:215]
    v_pk_add_f32 v[200:201], v[184:185], v[192:193]
    v_pk_add_f32 v[208:209], v[184:185], v[192:193] neg_lo:[0,1] neg_hi:[0,1]
    v_pk_fma_f32 v[214:215], v[184:185], v[184:185], v[214:215]
    v_pk_add_f32 v[212:213], v[212:213], v[200:201]
    v_pk_fma_f32 v[214:215], v[192:193], v[192:193], v[214:215]
    v_pk_add_f32 v[202:203], v[186:187], v[194:195]
    v_pk_add_f32 v[210:211], v[186:187], v[194:195] neg_lo:[0,1] neg_hi:[0,1]
    v_pk_fma_f32 v[214:215], v[186:187], v[186:187], v[214:215]
    v_pk_add_f32 v[212:213], v[212:213], v[202:203]
    v_pk_fma_f32 v[214:215], v[194:195], v[194:195], v[214:215]
    v_cvt_pk_bf16_f32 v196, v196, v197
    v_cvt_pk_bf16_f32 v197, v198, v199
    v_cvt_pk_bf16_f32 v198, v200, v201
    v_cvt_pk_bf16_f32 v199, v202, v203
    v_cvt_pk_bf16_f32 v204, v204, v205
    v_cvt_pk_bf16_f32 v205, v206, v207
    v_cvt_pk_bf16_f32 v206, v208, v209
    v_cvt_pk_bf16_f32 v207, v210, v211
    ds_write_b128 v6, v[196:199] offset:4224
    ds_write_b128 v6, v[204:207] offset:25344
    v_mov_b32_dpp v14, v232 row_shl:1 row_mask:0xf bank_mask:0xf
    v_mov_b32_dpp v15, v240 row_shr:7 row_mask:0xf bank_mask:0xf
    v_cndmask_b32 v14, v14, v15, s[30:31]
    v_and_b32 v180, 0xffff0000, v232
    v_lshlrev_b32 v181, 16, v233
    v_and_b32 v188, 0xffff0000, v239
    v_lshlrev_b32 v189, 16, v239
    v_and_b32 v182, 0xffff0000, v233
    v_lshlrev_b32 v183, 16, v234
    v_and_b32 v190, 0xffff0000, v238
    v_lshlrev_b32 v191, 16, v238
    v_and_b32 v184, 0xffff0000, v234
    v_lshlrev_b32 v185, 16, v235
    v_and_b32 v192, 0xffff0000, v237
    v_lshlrev_b32 v193, 16, v237
    v_and_b32 v186, 0xffff0000, v235
    v_lshlrev_b32 v187, 16, v14
    v_and_b32 v194, 0xffff0000, v236
    v_lshlrev_b32 v195, 16, v236
    v_pk_add_f32 v[196:197], v[180:181], v[188:189]
    v_pk_add_f32 v[204:205], v[180:181], v[188:189] neg_lo:[0,1] neg_hi:[0,1]
    v_pk_fma_f32 v[214:215], v[180:181], v[180:181], v[214:215]
    v_pk_add_f32 v[212:213], v[212:213], v[196:197]
    v_pk_fma_f32 v[214:215], v[188:189], v[188:189], v[214:215]
    v_pk_add_f32 v[198:199], v[182:183], v[190:191]
    v_pk_add_f32 v[206:207], v[182:183], v[190:191] neg_lo:[0,1] neg_hi:[0,1]
    v_pk_fma_f32 v[214:215], v[182:183], v[182:183], v[214:215]
    v_pk_add_f32 v[212:213], v[212:213], v[198:199]
    v_pk_fma_f32 v[214:215], v[190:191], v[190:191], v[214:215]
    v_pk_add_f32 v[200:201], v[184:185], v[192:193]
    v_pk_add_f32 v[208:209], v[184:185], v[192:193] neg_lo:[0,1] neg_hi:[0,1]
    v_pk_fma_f32 v[214:215], v[184:185], v[184:185], v[214:215]
    v_pk_add_f32 v[212:213], v[212:213], v[200:201]
    v_pk_fma_f32 v[214:215], v[192:193], v[192:193], v[214:215]
    v_pk_add_f32 v[202:203], v[186:187], v[194:195]
    v_pk_add_f32 v[210:211], v[186:187], v[194:195] neg_lo:[0,1] neg_hi:[0,1]
    v_pk_fma_f32 v[214:215], v[186:187], v[186:187], v[214:215]
    v_pk_add_f32 v[212:213], v[212:213], v[202:203]
    v_pk_fma_f32 v[214:215], v[194:195], v[194:195], v[214:215]
    v_cvt_pk_bf16_f32 v196, v196, v197
    v_cvt_pk_bf16_f32 v197, v198, v199
    v_cvt_pk_bf16_f32 v198, v200, v201
    v_cvt_pk_bf16_f32 v199, v202, v203
    v_cvt_pk_bf16_f32 v204, v204, v205
    v_cvt_pk_bf16_f32 v205, v206, v207
    v_cvt_pk_bf16_f32 v206, v208, v209
    v_cvt_pk_bf16_f32 v207, v210, v211
    ds_write_b128 v6, v[196:199] offset:8448
    ds_write_b128 v6, v[204:207] offset:29568
    v_mov_b32_dpp v14, v240 row_shl:1 row_mask:0xf bank_mask:0xf
    v_mov_b32_dpp v15, v248 row_shr:7 row_mask:0xf bank_mask:0xf
    v_cndmask_b32 v14, v14, v15, s[30:31]
    v_and_b32 v180, 0xffff0000, v240
    v_lshlrev_b32 v181, 16, v241
    v_and_b32 v188, 0xffff0000, v247
    v_lshlrev_b32 v189, 16, v247
    v_and_b32 v182, 0xffff0000, v241
    v_lshlrev_b32 v183, 16, v242
    v_and_b32 v190, 0xffff0000, v246
    v_lshlrev_b32 v191, 16, v246
    v_and_b32 v184, 0xffff0000, v242
    v_lshlrev_b32 v185, 16, v243
    v_and_b32 v192, 0xffff0000, v245
    v_lshlrev_b32 v193, 16, v245
    v_and_b32 v186, 0xffff0000, v243
    v_lshlrev_b32 v187, 16, v14
    v_and_b32 v194, 0xffff0000, v244
    v_lshlrev_b32 v195, 16, v244
    v_pk_add_f32 v[196:197], v[180:181], v[188:189]
    v_pk_add_f32 v[204:205], v[180:181], v[188:189] neg_lo:[0,1] neg_hi:[0,1]
    v_pk_fma_f32 v[214:215], v[180:181], v[180:181], v[214:215]
    v_pk_add_f32 v[212:213], v[212:213], v[196:197]
    v_pk_fma_f32 v[214:215], v[188:189], v[188:189], v[214:215]
    v_pk_add_f32 v[198:199], v[182:183], v[190:191]
    v_pk_add_f32 v[206:207], v[182:183], v[190:191] neg_lo:[0,1] neg_hi:[0,1]
    v_pk_fma_f32 v[214:215], v[182:183], v[182:183], v[214:215]
    v_pk_add_f32 v[212:213], v[212:213], v[198:199]
    v_pk_fma_f32 v[214:215], v[190:191], v[190:191], v[214:215]
    v_pk_add_f32 v[200:201], v[184:185], v[192:193]
    v_pk_add_f32 v[208:209], v[184:185], v[192:193] neg_lo:[0,1] neg_hi:[0,1]
    v_pk_fma_f32 v[214:215], v[184:185], v[184:185], v[214:215]
    v_pk_add_f32 v[212:213], v[212:213], v[200:201]
    v_pk_fma_f32 v[214:215], v[192:193], v[192:193], v[214:215]
    v_pk_add_f32 v[202:203], v[186:187], v[194:195]
    v_pk_add_f32 v[210:211], v[186:187], v[194:195] neg_lo:[0,1] neg_hi:[0,1]
    v_pk_fma_f32 v[214:215], v[186:187], v[186:187], v[214:215]
    v_pk_add_f32 v[212:213], v[212:213], v[202:203]
    v_pk_fma_f32 v[214:215], v[194:195], v[194:195], v[214:215]
    v_cvt_pk_bf16_f32 v196, v196, v197
    v_cvt_pk_bf16_f32 v197, v198, v199
    v_cvt_pk_bf16_f32 v198, v200, v201
    v_cvt_pk_bf16_f32 v199, v202, v203
    v_cvt_pk_bf16_f32 v204, v204, v205
    v_cvt_pk_bf16_f32 v205, v206, v207
    v_cvt_pk_bf16_f32 v206, v208, v209
    v_cvt_pk_bf16_f32 v207, v210, v211
    ds_write_b128 v6, v[196:199] offset:12672
    ds_write_b128 v6, v[204:207] offset:33792
    v_mov_b32_dpp v14, v248 row_shl:1 row_mask:0xf bank_mask:0xf
    v_cndmask_b32 v14, v14, v252, s[30:31]
    v_and_b32 v180, 0xffff0000, v248
    v_lshlrev_b32 v181, 16, v249
    v_and_b32 v188, 0xffff0000, v255
    v_lshlrev_b32 v189, 16, v255
    v_and_b32 v182, 0xffff0000, v249
    v_lshlrev_b32 v183, 16, v250
    v_and_b32 v190, 0xffff0000, v254
    v_lshlrev_b32 v191, 16, v254
    v_and_b32 v184, 0xffff0000, v250
    v_lshlrev_b32 v185, 16, v251
    v_and_b32 v192, 0xffff0000, v253
    v_lshlrev_b32 v193, 16, v253
    v_and_b32 v186, 0xffff0000, v251
    v_lshlrev_b32 v187, 16, v14
    v_and_b32 v194, 0xffff0000, v252
    v_lshlrev_b32 v195, 16, v252
    v_mov_b32_dpp v12, v216 row_shr:7 row_mask:0xf bank_mask:0xf
    v_lshlrev_b32 v12, 16, v12
    v_cndmask_b32 v195, v195, v12, s[30:31]
    v_pk_add_f32 v[196:197], v[180:181], v[188:189]
    v_pk_add_f32 v[204:205], v[180:181], v[188:189] neg_lo:[0,1] neg_hi:[0,1]
    v_pk_fma_f32 v[214:215], v[180:181], v[180:181], v[214:215]
    v_pk_add_f32 v[212:213], v[212:213], v[196:197]
    v_pk_fma_f32 v[214:215], v[188:189], v[188:189], v[214:215]
    v_pk_add_f32 v[198:199], v[182:183], v[190:191]
    v_pk_add_f32 v[206:207], v[182:183], v[190:191] neg_lo:[0,1] neg_hi:[0,1]
    v_pk_fma_f32 v[214:215], v[182:183], v[182:183], v[214:215]
    v_pk_add_f32 v[212:213], v[212:213], v[198:199]
    v_pk_fma_f32 v[214:215], v[190:191], v[190:191], v[214:215]
    v_pk_add_f32 v[200:201], v[184:185], v[192:193]
    v_pk_add_f32 v[208:209], v[184:185], v[192:193] neg_lo:[0,1] neg_hi:[0,1]
    v_pk_fma_f32 v[214:215], v[184:185], v[184:185], v[214:215]
    v_pk_add_f32 v[212:213], v[212:213], v[200:201]
    v_pk_fma_f32 v[214:215], v[192:193], v[192:193], v[214:215]
    v_pk_add_f32 v[202:203], v[186:187], v[194:195]
    v_pk_add_f32 v[210:211], v[186:187], v[194:195] neg_lo:[0,1] neg_hi:[0,1]
    v_pk_fma_f32 v[214:215], v[186:187], v[186:187], v[214:215]
    v_pk_add_f32 v[212:213], v[212:213], v[202:203]
    v_pk_fma_f32 v[214:215], v[194:195], v[194:195], v[214:215]
    v_cndmask_b32 v203, v203, v187, s[30:31]
    v_cndmask_b32 v211, v211, v195, s[30:31]
    v_cvt_pk_bf16_f32 v196, v196, v197
    v_cvt_pk_bf16_f32 v197, v198, v199
    v_cvt_pk_bf16_f32 v198, v200, v201
    v_cvt_pk_bf16_f32 v199, v202, v203
    v_cvt_pk_bf16_f32 v204, v204, v205
    v_cvt_pk_bf16_f32 v205, v206, v207
    v_cvt_pk_bf16_f32 v206, v208, v209
    v_cvt_pk_bf16_f32 v207, v210, v211
    ds_write_b128 v6, v[196:199] offset:16896
    ds_write_b128 v6, v[204:207] offset:38016
    v_add_f32 v212, v212, v213
    v_add_f32 v214, v214, v215
    v_add_u32 v8, 159744, v8
    s_nop 0
    v_add_f32_dpp v212, v212, v212 quad_perm:[1,0,3,2] row_mask:0xf bank_mask:0xf
    v_add_f32_dpp v214, v214, v214 quad_perm:[1,0,3,2] row_mask:0xf bank_mask:0xf
    s_nop 1
    v_add_f32_dpp v212, v212, v212 quad_perm:[2,3,0,1] row_mask:0xf bank_mask:0xf
    v_add_f32_dpp v214, v214, v214 quad_perm:[2,3,0,1] row_mask:0xf bank_mask:0xf
    s_nop 1
    v_add_f32_dpp v212, v212, v212 row_half_mirror row_mask:0xf bank_mask:0xf
    v_add_f32_dpp v214, v214, v214 row_half_mirror row_mask:0xf bank_mask:0xf
    s_nop 1
    v_mul_f32 v212, 0x3acccccd, v212
    v_mul_f32 v214, 0x3acccccd, v214
    v_fma_f32 v214, -v212, v212, v214
    v_max_f32 v214, 0, v214
    v_add_f32 v214, 0x3727c5ac, v214
    v_rsq_f32 v214, v214
    v_lshrrev_b32 v9, 5, v0
    ds_write_b32 v8, v214
    v_lshlrev_b32 v9, 4, v9
    v_add_u32 v9, 159744, v9
    s_cmp_ge_u32 s18, 2
    s_cbranch_scc1 k2_nf1
    s_add_u32 s23, s46, 1
    v_mov_b32 v15, s23
    s_waitcnt vmcnt(0)
    s_mov_b64 exec, 1
    buffer_store_dword v15, off, s[8:11], s98 offset:16 sc1
    s_mov_b64 exec, -1
k2_nf1:
    s_waitcnt lgkmcnt(0)
    s_barrier
    s_cmp_eq_u32 s18, 3
    s_cbranch_scc1 k2_w3a
    s_cmp_ge_u32 s18, s22
    s_cbranch_scc1 k2_nou0
    s_mul_i32 s32, s21, 8192
    s_lshl_b32 s33, s20, 7
    s_add_u32 s32, s32, s33
    s_add_u32 s32, s32, 9699328
    s_cmp_lg_u32 s18, 2
    s_cbranch_scc1 k2_nf2
    s_add_u32 s23, s46, 1
    v_mov_b32 v15, s23
    s_mov_b64 exec, 1
    buffer_store_dword v15, off, s[8:11], s98 offset:16 sc1
    s_mov_b64 exec, -1
k2_nf2:
    v_and_b32 v14, 31, v0
    v_lshlrev_b32 v14, 4, v14
    v_lshrrev_b32 v15, 5, v0
    v_mul_u32_u24 v13, 528, v15
    v_add_u32 v14, v14, v13
    ds_read_b128 v[208:211], v14 offset:0
    ds_read_b128 v[212:215], v14 offset:21120
    ds_read_b128 v[216:219], v14 offset:1056
    ds_read_b128 v[220:223], v14 offset:22176
    v_mov_b32 v240, 0
    v_mov_b32 v241, 0
    v_mov_b32 v242, 0
    v_mul_u32_u24 v243, 0x3f8000, v15
    v_lshlrev_b32 v243, 8, v243
    s_waitcnt lgkmcnt(2)
    v_mfma_f32_32x32x16_bf16 v[176:191], v[208:211], v[16:19], 0
    v_mfma_f32_32x32x16_bf16 v[192:207], v[212:215], v[20:23], 0
    ds_read_b128 v[208:211], v14 offset:2112
    ds_read_b128 v[212:215], v14 offset:23232
    s_waitcnt lgkmcnt(2)
    v_mfma_f32_32x32x16_bf16 v[176:191], v[216:219], v[24:27], v[176:191]
    v_mfma_f32_32x32x16_bf16 v[192:207], v[220:223], v[28:31], v[192:207]
    ds_read_b128 v[216:219], v14 offset:3168
    ds_read_b128 v[220:223], v14 offset:24288
    s_waitcnt lgkmcnt(2)
    v_mfma_f32_32x32x16_bf16 v[176:191], v[208:211], v[32:35], v[176:191]
    v_mfma_f32_32x32x16_bf16 v[192:207], v[212:215], v[36:39], v[192:207]
    ds_read_b128 v[208:211], v14 offset:4224
    ds_read_b128 v[212:215], v14 offset:25344
    s_waitcnt lgkmcnt(2)
    v_mfma_f32_32x32x16_bf16 v[176:191], v[216:219], v[40:43], v[176:191]
    v_mfma_f32_32x32x16_bf16 v[192:207], v[220:223], v[44:47], v[192:207]
    ds_read_b128 v[216:219], v14 offset:5280
    ds_read_b128 v[220:223], v14 offset:26400
    s_waitcnt lgkmcnt(2)
    v_mfma_f32_32x32x16_bf16 v[176:191], v[208:211], v[48:51], v[176:191]
    v_mfma_f32_32x32x16_bf16 v[192:207], v[212:215], v[52:55], v[192:207]
    ds_read_b128 v[208:211], v14 offset:6336
    ds_read_b128 v[212:215], v14 offset:27456
    s_waitcnt lgkmcnt(2)
    v_mfma_f32_32x32x16_bf16 v[176:191], v[216:219], v[56:59], v[176:191]
    v_mfma_f32_32x32x16_bf16 v[192:207], v[220:223], v[60:63], v[192:207]
    ds_read_b128 v[216:219], v14 offset:7392
    ds_read_b128 v[220:223], v14 offset:28512
    s_waitcnt lgkmcnt(2)
    v_mfma_f32_32x32x16_bf16 v[176:191], v[208:211], v[64:67], v[176:191]
    v_mfma_f32_32x32x16_bf16 v[192:207], v[212:215], v[68:71], v[192:207]
    ds_read_b128 v[208:211], v14 offset:8448
    ds_read_b128 v[212:215], v14 offset:29568
    s_waitcnt lgkmcnt(2)
    v_mfma_f32_32x32x16_bf16 v[176:191], v[216:219], v[72:75], v[176:191]
    v_mfma_f32_32x32x16_bf16 v[192:207], v[220:223], v[76:79], v[192:207]
    ds_read_b128 v[216:219], v14 offset:9504
    ds_read_b128 v[220:223], v14 offset:30624
    s_waitcnt lgkmcnt(2)
    v_mfma_f32_32x32x16_bf16 v[176:191], v[208:211], v[80:83], v[176:191]
    v_mfma_f32_32x32x16_bf16 v[192:207], v[212:215], v[84:87], v[192:207]
    ds_read_b128 v[208:211], v14 offset:10560
    ds_read_b128 v[212:215], v14 offset:31680
    s_waitcnt lgkmcnt(2)
    v_mfma_f32_32x32x16_bf16 v[176:191], v[216:219], v[88:91], v[176:191]
    v_mfma_f32_32x32x16_bf16 v[192:207], v[220:223], v[92:95], v[192:207]
    ds_read_b128 v[216:219], v14 offset:11616
    ds_read_b128 v[220:223], v14 offset:32736
    s_waitcnt lgkmcnt(2)
    v_mfma_f32_32x32x16_bf16 v[176:191], v[208:211], v[96:99], v[176:191]
    v_mfma_f32_32x32x16_bf16 v[192:207], v[212:215], v[100:103], v[192:207]
    ds_read_b128 v[208:211], v14 offset:12672
    ds_read_b128 v[212:215], v14 offset:33792
    s_waitcnt lgkmcnt(2)
    v_mfma_f32_32x32x16_bf16 v[176:191], v[216:219], v[104:107], v[176:191]
    v_mfma_f32_32x32x16_bf16 v[192:207], v[220:223], v[108:111], v[192:207]
    ds_read_b128 v[216:219], v14 offset:13728
    ds_read_b128 v[220:223], v14 offset:34848
    s_waitcnt lgkmcnt(2)
    v_mfma_f32_32x32x16_bf16 v[176:191], v[208:211], v[112:115], v[176:191]
    v_mfma_f32_32x32x16_bf16 v[192:207], v[212:215], v[116:119], v[192:207]
    ds_read_b128 v[208:211], v14 offset:14784
    ds_read_b128 v[212:215], v14 offset:35904
    s_waitcnt lgkmcnt(2)
    v_mfma_f32_32x32x16_bf16 v[176:191], v[216:219], v[120:123], v[176:191]
    v_mfma_f32_32x32x16_bf16 v[192:207], v[220:223], v[124:127], v[192:207]
    ds_read_b128 v[216:219], v14 offset:15840
    ds_read_b128 v[220:223], v14 offset:36960
    s_waitcnt lgkmcnt(2)
    v_mfma_f32_32x32x16_bf16 v[176:191], v[208:211], v[128:131], v[176:191]
    v_mfma_f32_32x32x16_bf16 v[192:207], v[212:215], v[132:135], v[192:207]
    ds_read_b128 v[208:211], v14 offset:16896
    ds_read_b128 v[212:215], v14 offset:38016
    s_waitcnt lgkmcnt(2)
    v_mfma_f32_32x32x16_bf16 v[176:191], v[216:219], v[136:139], v[176:191]
    v_mfma_f32_32x32x16_bf16 v[192:207], v[220:223], v[140:143], v[192:207]
    ds_read_b128 v[216:219], v14 offset:17952
    ds_read_b128 v[220:223], v14 offset:39072
    s_waitcnt lgkmcnt(2)
    v_mfma_f32_32x32x16_bf16 v[176:191], v[208:211], v[144:147], v[176:191]
    v_mfma_f32_32x32x16_bf16 v[192:207], v[212:215], v[148:151], v[192:207]
    ds_read_b128 v[208:211], v14 offset:19008
    ds_read_b128 v[212:215], v14 offset:40128
    s_waitcnt lgkmcnt(2)
    v_mfma_f32_32x32x16_bf16 v[176:191], v[216:219], v[152:155], v[176:191]
    v_mfma_f32_32x32x16_bf16 v[192:207], v[220:223], v[156:159], v[192:207]
    ds_read_b128 v[216:219], v14 offset:20064
    ds_read_b128 v[220:223], v14 offset:41184
    ds_read_b128 v[224:227], v9 offset:0
    ds_read_b128 v[228:231], v9 offset:32
    ds_read_b128 v[232:235], v9 offset:64
    ds_read_b128 v[236:239], v9 offset:96
    s_waitcnt lgkmcnt(6)
    v_mfma_f32_32x32x16_bf16 v[176:191], v[208:211], v[160:163], v[176:191]
    v_mfma_f32_32x32x16_bf16 v[192:207], v[212:215], v[164:167], v[192:207]
    s_waitcnt lgkmcnt(4)
    v_mfma_f32_32x32x16_bf16 v[176:191], v[216:219], v[168:171], v[176:191]
    v_mfma_f32_32x32x16_bf16 v[192:207], v[220:223], v[172:175], v[192:207]
    v_mfma_f32_32x32x16_bf16 v[176:191], v[220:223], v[240:243], v[176:191]
    v_lshlrev_b32 v13, 4, v0
    v_add_u32 v13, 143360, v13
    ds_read_b128 v[160:163], v13 offset:0
    ds_read_b128 v[164:167], v13 offset:1024
    ds_read_b128 v[168:171], v13 offset:2048
    ds_read_b128 v[172:175], v13 offset:3072
    s_nop 7
    ds_read_b128 v[208:211], v13 offset:4096
    ds_read_b128 v[212:215], v13 offset:5120
    ds_read_b128 v[216:219], v13 offset:6144
    ds_read_b128 v[220:223], v13 offset:7168
    s_waitcnt lgkmcnt(8)
    v_pk_mul_f32 v[192:193], v[192:193], v[224:225]
    v_pk_mul_f32 v[194:195], v[194:195], v[226:227]
    v_pk_mul_f32 v[196:197], v[196:197], v[228:229]
    v_pk_mul_f32 v[198:199], v[198:199], v[230:231]
    v_pk_mul_f32 v[200:201], v[200:201], v[232:233]
    v_pk_mul_f32 v[202:203], v[202:203], v[234:235]
    v_pk_mul_f32 v[204:205], v[204:205], v[236:237]
    v_pk_mul_f32 v[206:207], v[206:207], v[238:239]
    v_cvt_pk_bf16_f32 v248, v192, v193
    v_cvt_pk_bf16_f32 v249, v194, v195
    v_cvt_pk_bf16_f32 v250, v196, v197
    v_cvt_pk_bf16_f32 v251, v198, v199
    v_cvt_pk_bf16_f32 v252, v200, v201
    v_cvt_pk_bf16_f32 v253, v202, v203
    v_cvt_pk_bf16_f32 v254, v204, v205
    v_cvt_pk_bf16_f32 v255, v206, v207
    v_pk_mul_f32 v[176:177], v[176:177], v[224:225]
    v_pk_mul_f32 v[178:179], v[178:179], v[226:227]
    v_pk_mul_f32 v[180:181], v[180:181], v[228:229]
    v_pk_mul_f32 v[182:183], v[182:183], v[230:231]
    v_pk_mul_f32 v[184:185], v[184:185], v[232:233]
    v_pk_mul_f32 v[186:187], v[186:187], v[234:235]
    v_pk_mul_f32 v[188:189], v[188:189], v[236:237]
    v_pk_mul_f32 v[190:191], v[190:191], v[238:239]
    v_cvt_pk_bf16_f32 v240, v176, v177
    v_cvt_pk_bf16_f32 v241, v178, v179
    v_cvt_pk_bf16_f32 v242, v180, v181
    v_cvt_pk_bf16_f32 v243, v182, v183
    v_cvt_pk_bf16_f32 v244, v184, v185
    v_cvt_pk_bf16_f32 v245, v186, v187
    v_cvt_pk_bf16_f32 v246, v188, v189
    v_cvt_pk_bf16_f32 v247, v190, v191
    s_waitcnt lgkmcnt(0)
    v_and_b32 v14, 15, v0
    v_mul_u32_u24 v14, 81920, v14
    v_bfe_u32 v13, v0, 4, 1
    v_lshl_add_u32 v14, v13, 5, v14
    v_lshl_add_u32 v14, v15, 4, v14
    v_mfma_f32_32x32x16_bf16 v[192:207], v[240:243], v[160:163], 0
    v_mfma_f32_32x32x16_bf16 v[192:207], v[244:247], v[164:167], v[192:207]
    v_mfma_f32_32x32x16_bf16 v[192:207], v[248:251], v[168:171], v[192:207]
    v_mfma_f32_32x32x16_bf16 v[192:207], v[252:255], v[172:175], v[192:207]
    v_mfma_f32_32x32x16_bf16 v[176:191], v[240:243], v[208:211], 0
    v_mfma_f32_32x32x16_bf16 v[176:191], v[244:247], v[212:215], v[176:191]
    v_mfma_f32_32x32x16_bf16 v[176:191], v[248:251], v[216:219], v[176:191]
    v_mfma_f32_32x32x16_bf16 v[176:191], v[252:255], v[220:223], v[176:191]
    s_add_u32 s23, s32, 1310720
    s_nop 6
    v_permlane16_swap_b32 v192, v200
    v_permlane16_swap_b32 v193, v201
    v_permlane16_swap_b32 v194, v202
    v_permlane16_swap_b32 v195, v203
    v_permlane16_swap_b32 v196, v204
    v_permlane16_swap_b32 v197, v205
    v_permlane16_swap_b32 v198, v206
    v_permlane16_swap_b32 v199, v207
    v_cvt_pk_bf16_f32 v224, v192, v200
    v_cvt_pk_bf16_f32 v225, v193, v201
    v_cvt_pk_bf16_f32 v226, v194, v202
    v_cvt_pk_bf16_f32 v227, v195, v203
    buffer_store_dwordx4 v[224:227], v14, s[8:11], s32 offen offset:0 sc1
    v_cvt_pk_bf16_f32 v228, v196, v204
    v_cvt_pk_bf16_f32 v229, v197, v205
    v_cvt_pk_bf16_f32 v230, v198, v206
    v_cvt_pk_bf16_f32 v231, v199, v207
    buffer_store_dwordx4 v[228:231], v14, s[8:11], s32 offen offset:64 sc1
    s_nop 0
    v_permlane16_swap_b32 v176, v184
    v_permlane16_swap_b32 v177, v185
    v_permlane16_swap_b32 v178, v186
    v_permlane16_swap_b32 v179, v187
    v_permlane16_swap_b32 v180, v188
    v_permlane16_swap_b32 v181, v189
    v_permlane16_swap_b32 v182, v190
    v_permlane16_swap_b32 v183, v191
    v_cvt_pk_bf16_f32 v232, v176, v184
    v_cvt_pk_bf16_f32 v233, v177, v185
    v_cvt_pk_bf16_f32 v234, v178, v186
    v_cvt_pk_bf16_f32 v235, v179, v187
    buffer_store_dwordx4 v[232:235], v14, s[8:11], s23 offen offset:0 sc1
    v_cvt_pk_bf16_f32 v236, v180, v188
    v_cvt_pk_bf16_f32 v237, v181, v189
    v_cvt_pk_bf16_f32 v238, v182, v190
    v_cvt_pk_bf16_f32 v239, v183, v191
    buffer_store_dwordx4 v[236:239], v14, s[8:11], s23 offen offset:64 sc1
    s_branch k2_nou1
k2_nou0:
    s_waitcnt vmcnt(0)
    s_mul_i32 s34, s58, 48
    s_add_u32 s34, s34, s57
    s_mul_i32 s34, s34, 5120
    s_add_u32 s34, s34, 2490368
    s_add_u32 s35, s34, 4096
    v_accvgpr_read_b32 v176, a0
    v_accvgpr_read_b32 v177, a1
    v_accvgpr_read_b32 v178, a2
    v_accvgpr_read_b32 v179, a3
    v_accvgpr_read_b32 v180, a4
    v_accvgpr_read_b32 v181, a5
    v_accvgpr_read_b32 v182, a6
    v_accvgpr_read_b32 v183, a7
    v_accvgpr_read_b32 v184, a8
    v_accvgpr_read_b32 v185, a9
    v_accvgpr_read_b32 v186, a10
    v_accvgpr_read_b32 v187, a11
    v_accvgpr_read_b32 v188, a12
    v_accvgpr_read_b32 v189, a13
    v_accvgpr_read_b32 v190, a14
    v_accvgpr_read_b32 v191, a15
    v_accvgpr_read_b32 v192, a16
    v_accvgpr_read_b32 v193, a17
    v_accvgpr_read_b32 v194, a18
    v_accvgpr_read_b32 v195, a19
    v_accvgpr_read_b32 v196, a20
    v_accvgpr_read_b32 v197, a21
    v_accvgpr_read_b32 v198, a22
    v_accvgpr_read_b32 v199, a23
    v_perm_b32 v200, v177, v176, s32
    v_perm_b32 v201, v179, v178, s32
    v_perm_b32 v202, v181, v180, s32
    v_perm_b32 v203, v183, v182, s32
    buffer_store_dwordx4 v[200:203], v3, s[8:11], s34 offen offset:0 sc1
    v_perm_b32 v204, v177, v176, s33
    v_perm_b32 v205, v179, v178, s33
    v_perm_b32 v206, v181, v180, s33
    v_perm_b32 v207, v183, v182, s33
    buffer_store_dwordx4 v[204:207], v3, s[8:11], s34 offen offset:1024 sc1
    v_perm_b32 v208, v185, v184, s33
    v_perm_b32 v209, v187, v186, s33
    v_perm_b32 v210, v189, v188, s33
    v_perm_b32 v211, v191, v190, s33
    buffer_store_dwordx4 v[208:211], v3, s[8:11], s34 offen offset:2048 sc1
    v_perm_b32 v212, v185, v184, s32
    v_perm_b32 v213, v187, v186, s32
    v_perm_b32 v214, v189, v188, s32
    v_perm_b32 v215, v191, v190, s32
    buffer_store_dwordx4 v[212:215], v3, s[8:11], s34 offen offset:3072 sc1
    v_perm_b32 v176, v193, v192, s32
    v_perm_b32 v177, v195, v194, s32
    v_perm_b32 v178, v197, v196, s32
    v_perm_b32 v179, v199, v198, s32
    buffer_store_dwordx4 v[176:179], v3, s[8:11], s35 offen sc1
    s_nop 0
    s_waitcnt vmcnt(0)
    s_add_u32 s23, s46, 1
    v_mov_b32 v15, s23
    s_mov_b64 exec, 1
    buffer_store_dword v15, off, s[8:11], s98 offset:16 sc1
    s_mov_b64 exec, -1
k2_nou1:
    s_waitcnt vmcnt(0)
    s_add_u32 s23, s46, 1
    v_mov_b32 v15, s23
    s_mov_b64 exec, 1
    buffer_store_dword v15, off, s[8:11], s98 offset:0 sc1
    s_mov_b64 exec, -1
    s_cmp_ge_u32 s18, s22
    s_cbranch_scc1 k2_tp1
    s_mul_i32 s40, s21, 8192
    s_lshl_b32 s41, s20, 7
    s_add_u32 s40, s40, s41
    s_add_u32 s40, s40, 12320768
    s_add_u32 s41, s40, 655360
    s_add_u32 s42, s40, 1310720
    s_add_u32 s43, s40, 1966080
    v_lshrrev_b32 v14, 3, v0
    v_mul_u32_u24 v14, 81920, v14
    v_and_b32 v15, 7, v0
    v_lshl_add_u32 v14, v15, 4, v14
    v_mov_b32 v248, -1
    v_mov_b32 v249, -1
    v_mov_b32 v250, -1
    v_mov_b32 v251, -1
    buffer_store_dwordx4 v[248:251], v14, s[8:11], s40 offen sc1
    buffer_store_dwordx4 v[248:251], v14, s[8:11], s41 offen sc1
    buffer_store_dwordx4 v[248:251], v14, s[8:11], s42 offen sc1
    buffer_store_dwordx4 v[248:251], v14, s[8:11], s43 offen sc1
    s_nop 1
k2_tp1:
    s_mul_i32 s24, s16, 81920
    s_and_b32 s25, s20, 31
    s_mul_i32 s25, s25, 10
    s_add_u32 s25, s25, s21
    s_lshl_b32 s25, s25, 13
    s_getreg_b32 s26, hwreg(HW_REG_XCC_ID)
    s_and_b32 s26, s26, 15
    s_add_u32 s26, s26, 16
    s_add_u32 s26, s26, s46
    s_mul_i32 s28, s16, 196608
    s_mul_i32 s29, s17, 5
    s_lshr_b32 s29, s29, 1
    s_mul_i32 s30, s17, 3
    s_lshr_b32 s30, s30, 1
    s_lshl_b32 s39, s17, 2
    s_add_u32 s39, s39, s18
    s_mul_i32 s44, s39, 61440
    s_add_u32 s39, s44, 524288
    s_add_u32 s44, s44, 2490368
    v_lshlrev_b32 v1, 4, v0
    v_and_b32 v14, 31, v0
    v_lshrrev_b32 v15, 5, v0
    v_and_b32 v2, 3, v14
    v_bfe_u32 v3, v14, 2, 1
    v_lshl_add_u32 v2, v3, 4, v2
    v_bfe_u32 v3, v14, 3, 2
    v_lshl_add_u32 v2, v3, 2, v2
    v_lshlrev_b32 v2, 2, v2
    v_lshl_add_u32 v2, v15, 9, v2
    s_lshl_b32 s23, s19, 5
    v_add_u32 v5, s23, v14
    v_sub_u32 v6, 63, v5
    v_sub_u32 v7, 32, v14
    v_and_b32 v7, 31, v7
    v_sub_u32 v8, 95, v5
    s_cmp_eq_u32 s19, 0
    s_cselect_b64 s[36:37], -1, 0
    v_cndmask_b32 v7, v8, v7, s[36:37]
    s_cmp_eq_u32 s16, 0
    s_cselect_b64 s[36:37], -1, 0
    v_cndmask_b32 v6, v6, v7, s[36:37]
    v_lshrrev_b32 v3, 4, v5
    v_lshlrev_b32 v3, 10, v3
    v_and_b32 v7, 15, v5
    v_lshl_add_u32 v3, v7, 4, v3
    v_lshl_add_u32 v3, v15, 8, v3
    v_lshrrev_b32 v4, 4, v6
    v_lshlrev_b32 v4, 10, v4
    v_and_b32 v7, 15, v6
    v_lshl_add_u32 v4, v7, 4, v4
    v_lshl_add_u32 v4, v15, 8, v4
    v_mov_b32 v9, v6
    v_add_u32 v6, 640, v6
    v_cmp_eq_u32 vcc, 0, v15
    s_and_b32 s23, s2, 0xc7
    v_and_b32 v12, 7, v0
    v_cndmask_b32 v5, v6, v5, vcc
    v_lshlrev_b32 v5, 3, v5
    s_lshl_b32 s23, s16, 8
    v_lshl_add_u32 v12, v12, 4, s23
    v_and_b32 v13, 7, v14
    v_lshrrev_b32 v7, 3, v14
    v_lshl_add_u32 v13, v7, 6, v13
    v_lshl_add_u32 v13, v15, 5, v13
    s_and_b32 s23, s17, 3
    s_lshl_b32 s23, s23, 3
    v_add_u32 v13, s23, v13
    v_lshlrev_b32 v13, 7, v13
    s_and_b32 s23, s16, 0
    s_mul_i32 s23, s23, 32896
    s_add_u32 s23, s23, 32768
    v_add_u32 v13, s23, v13
    v_lshrrev_b32 v7, 4, v0
    v_and_b32 v8, 15, v0
    v_and_b32 v6, 1, v7
    s_and_b32 s23, s18, 1
    s_lshl_b32 s23, s23, 1
    v_add_u32 v6, s23, v6
    v_lshlrev_b32 v6, 8, v6
    v_lshl_add_u32 v6, v8, 4, v6
    v_lshl_add_u32 v6, v15, 10, v6
    s_mul_i32 s23, s17, 24576
    s_mul_i32 s38, s18, 6144
    s_add_u32 s23, s23, s38
    s_add_u32 s23, s23, s28
    s_add_u32 s23, s23, 14942208
    s_add_u32 s38, s23, 4096
    v_mov_b32 v248, -1
    v_mov_b32 v249, -1
    v_mov_b32 v250, -1
    v_mov_b32 v251, -1
    buffer_store_dwordx4 v[248:251], v1, s[8:11], s23 offen offset:0
    buffer_store_dwordx4 v[248:251], v1, s[8:11], s23 offen offset:1024
    buffer_store_dwordx4 v[248:251], v1, s[8:11], s23 offen offset:2048
    buffer_store_dwordx4 v[248:251], v1, s[8:11], s23 offen offset:3072
    buffer_store_dwordx4 v[248:251], v1, s[8:11], s38 offen offset:0
    buffer_store_dwordx4 v[248:251], v1, s[8:11], s38 offen offset:1024
    s_nop 1
    s_cmp_ge_u32 s18, s22
    s_cbranch_scc1 k2_nor1
    s_lshl_b32 s33, s21, 12
    s_add_u32 s33, s33, s24
    s_sub_u32 s23, 64, s16
    s_cmp_eq_u32 s16, 0
    s_cselect_b32 s23, 32, s23
    v_mov_b32 v7, s23
    v_mov_b32 v8, s16
    v_cmp_gt_u32 vcc, 32, v9
    v_and_b32 v9, 31, v9
    v_and_b32 v10, 31, v0
    v_cndmask_b32 v7, v7, v8, vcc
    v_lshl_add_u32 v9, v9, 6, v7
    v_mul_u32_u24 v9, 1280, v9
    v_lshl_add_u32 v10, v10, 6, s20
    v_mul_u32_u24 v10, 1280, v10
    v_lshrrev_b32 v7, 5, v0
    v_lshlrev_b32 v7, 4, v7
    s_lshl_b32 s23, s21, 6
    s_add_u32 s38, s23, 2
    v_add3_u32 v10, v10, v7, s38
    s_sub_u32 s38, 1232, s23
    v_sub_u32 v7, s38, v7
    v_add_u32 v7, v7, v9
    buffer_load_dwordx4 v[192:195], v10, s[4:7], 0 offen offset:0
    buffer_load_dwordx4 v[196:199], v10, s[4:7], 0 offen offset:32
    buffer_load_dwordx4 v[200:203], v7, s[4:7], 0 offen offset:32
    buffer_load_dwordx4 v[204:207], v7, s[4:7], 0 offen offset:0
    buffer_load_ushort v8, v9, s[4:7], 0 offen
k2_nor1:
    s_barrier
    s_add_u32 s23, s29, 0
    s_cmp_ge_u32 s23, 20
    s_cselect_b32 s38, 20, 0
    s_sub_u32 s23, s23, s38
    s_mul_i32 s23, s23, 3072
    s_add_u32 s23, s23, s39
    buffer_load_dwordx4 v[16:19], v1, s[8:11], s23 offen offset:0
    buffer_load_dwordx4 v[20:23], v1, s[8:11], s23 offen offset:1024
    buffer_load_dwordx4 v[24:27], v1, s[8:11], s23 offen offset:2048
    s_add_u32 s23, s29, 1
    s_cmp_ge_u32 s23, 20
    s_cselect_b32 s38, 20, 0
    s_sub_u32 s23, s23, s38
    s_mul_i32 s23, s23, 3072
    s_add_u32 s23, s23, s39
    buffer_load_dwordx4 v[28:31], v1, s[8:11], s23 offen offset:0
    buffer_load_dwordx4 v[32:35], v1, s[8:11], s23 offen offset:1024
    buffer_load_dwordx4 v[36:39], v1, s[8:11], s23 offen offset:2048
    s_add_u32 s23, s29, 2
    s_cmp_ge_u32 s23, 20
    s_cselect_b32 s38, 20, 0
    s_sub_u32 s23, s23, s38
    s_mul_i32 s23, s23, 3072
    s_add_u32 s23, s23, s39
    buffer_load_dwordx4 v[40:43], v1, s[8:11], s23 offen offset:0
    buffer_load_dwordx4 v[44:47], v1, s[8:11], s23 offen offset:1024
    buffer_load_dwordx4 v[48:51], v1, s[8:11], s23 offen offset:2048
    s_add_u32 s23, s29, 3
    s_cmp_ge_u32 s23, 20
    s_cselect_b32 s38, 20, 0
    s_sub_u32 s23, s23, s38
    s_mul_i32 s23, s23, 3072
    s_add_u32 s23, s23, s39
    buffer_load_dwordx4 v[52:55], v1, s[8:11], s23 offen offset:0
    buffer_load_dwordx4 v[56:59], v1, s[8:11], s23 offen offset:1024
    buffer_load_dwordx4 v[60:63], v1, s[8:11], s23 offen offset:2048
    s_add_u32 s23, s29, 4
    s_cmp_ge_u32 s23, 20
    s_cselect_b32 s38, 20, 0
    s_sub_u32 s23, s23, s38
    s_mul_i32 s23, s23, 3072
    s_add_u32 s23, s23, s39
    buffer_load_dwordx4 v[64:67], v1, s[8:11], s23 offen offset:0
    buffer_load_dwordx4 v[68:71], v1, s[8:11], s23 offen offset:1024
    buffer_load_dwordx4 v[72:75], v1, s[8:11], s23 offen offset:2048
    s_add_u32 s23, s29, 5
    s_cmp_ge_u32 s23, 20
    s_cselect_b32 s38, 20, 0
    s_sub_u32 s23, s23, s38
    s_mul_i32 s23, s23, 3072
    s_add_u32 s23, s23, s39
    buffer_load_dwordx4 v[76:79], v1, s[8:11], s23 offen offset:0
    buffer_load_dwordx4 v[80:83], v1, s[8:11], s23 offen offset:1024
    buffer_load_dwordx4 v[84:87], v1, s[8:11], s23 offen offset:2048
    s_add_u32 s23, s29, 6
    s_cmp_ge_u32 s23, 20
    s_cselect_b32 s38, 20, 0
    s_sub_u32 s23, s23, s38
    s_mul_i32 s23, s23, 3072
    s_add_u32 s23, s23, s39
    buffer_load_dwordx4 v[88:91], v1, s[8:11], s23 offen offset:0
    buffer_load_dwordx4 v[92:95], v1, s[8:11], s23 offen offset:1024
    buffer_load_dwordx4 v[96:99], v1, s[8:11], s23 offen offset:2048
    s_add_u32 s23, s29, 7
    s_cmp_ge_u32 s23, 20
    s_cselect_b32 s38, 20, 0
    s_sub_u32 s23, s23, s38
    s_mul_i32 s23, s23, 3072
    s_add_u32 s23, s23, s39
    buffer_load_dwordx4 v[100:103], v1, s[8:11], s23 offen offset:0
    buffer_load_dwordx4 v[104:107], v1, s[8:11], s23 offen offset:1024
    buffer_load_dwordx4 v[108:111], v1, s[8:11], s23 offen offset:2048
    v_and_b32 v224, 31, v0
    v_lshlrev_b32 v224, 6, v224
    v_add_u32 v224, s20, v224
    s_lshl_b32 s23, s18, 4
    v_lshrrev_b32 v225, 5, v0
    v_lshl_add_u32 v225, v225, 2, s23
    v_mul_u32_u24 v225, v225, v224
    s_lshl_b32 s23, s18, 11
    s_add_u32 s23, s23, 151552
    v_add_u32 v226, s23, v1
    v_and_b32 v227, 2047, v225
    v_cvt_f32_u32 v227, v227
    v_mul_f32 v227, 0x3a000000, v227
    v_cos_f32 v228, v227
    v_sin_f32 v229, v227
    v_add_u32 v225, v225, v224
    v_cvt_pk_bf16_f32 v232, v228, v229
    v_and_b32 v227, 2047, v225
    v_cvt_f32_u32 v227, v227
    v_mul_f32 v227, 0x3a000000, v227
    v_cos_f32 v228, v227
    v_sin_f32 v229, v227
    v_add_u32 v225, v225, v224
    v_cvt_pk_bf16_f32 v233, v228, v229
    v_and_b32 v227, 2047, v225
    v_cvt_f32_u32 v227, v227
    v_mul_f32 v227, 0x3a000000, v227
    v_cos_f32 v228, v227
    v_sin_f32 v229, v227
    v_add_u32 v225, v225, v224
    v_cvt_pk_bf16_f32 v234, v228, v229
    v_and_b32 v227, 2047, v225
    v_cvt_f32_u32 v227, v227
    v_mul_f32 v227, 0x3a000000, v227
    v_cos_f32 v228, v227
    v_sin_f32 v229, v227
    v_add_u32 v225, v225, v224
    v_cvt_pk_bf16_f32 v235, v228, v229
    v_lshl_add_u32 v225, v224, 2, v225
    ds_write_b128 v226, v[232:235] offset:0
    v_and_b32 v227, 2047, v225
    v_cvt_f32_u32 v227, v227
    v_mul_f32 v227, 0x3a000000, v227
    v_cos_f32 v228, v227
    v_sin_f32 v229, v227
    v_add_u32 v225, v225, v224
    v_cvt_pk_bf16_f32 v236, v228, v229
    v_and_b32 v227, 2047, v225
    v_cvt_f32_u32 v227, v227
    v_mul_f32 v227, 0x3a000000, v227
    v_cos_f32 v228, v227
    v_sin_f32 v229, v227
    v_add_u32 v225, v225, v224
    v_cvt_pk_bf16_f32 v237, v228, v229
    v_and_b32 v227, 2047, v225
    v_cvt_f32_u32 v227, v227
    v_mul_f32 v227, 0x3a000000, v227
    v_cos_f32 v228, v227
    v_sin_f32 v229, v227
    v_add_u32 v225, v225, v224
    v_cvt_pk_bf16_f32 v238, v228, v229
    v_and_b32 v227, 2047, v225
    v_cvt_f32_u32 v227, v227
    v_mul_f32 v227, 0x3a000000, v227
    v_cos_f32 v228, v227
    v_sin_f32 v229, v227
    v_add_u32 v225, v225, v224
    v_cvt_pk_bf16_f32 v239, v228, v229
    ds_write_b128 v226, v[236:239] offset:1024
    s_branch k2_B2
k2_w3a:
    s_waitcnt vmcnt(0)
    s_mul_i32 s34, s58, 48
    s_add_u32 s34, s34, s57
    s_mul_i32 s34, s34, 5120
    s_add_u32 s34, s34, 2490368
    s_add_u32 s35, s34, 4096
    v_accvgpr_read_b32 v176, a0
    v_accvgpr_read_b32 v177, a1
    v_accvgpr_read_b32 v178, a2
    v_accvgpr_read_b32 v179, a3
    v_accvgpr_read_b32 v180, a4
    v_accvgpr_read_b32 v181, a5
    v_accvgpr_read_b32 v182, a6
    v_accvgpr_read_b32 v183, a7
    v_accvgpr_read_b32 v184, a8
    v_accvgpr_read_b32 v185, a9
    v_accvgpr_read_b32 v186, a10
    v_accvgpr_read_b32 v187, a11
    v_accvgpr_read_b32 v188, a12
    v_accvgpr_read_b32 v189, a13
    v_accvgpr_read_b32 v190, a14
    v_accvgpr_read_b32 v191, a15
    v_accvgpr_read_b32 v192, a16
    v_accvgpr_read_b32 v193, a17
    v_accvgpr_read_b32 v194, a18
    v_accvgpr_read_b32 v195, a19
    v_accvgpr_read_b32 v196, a20
    v_accvgpr_read_b32 v197, a21
    v_accvgpr_read_b32 v198, a22
    v_accvgpr_read_b32 v199, a23
    v_perm_b32 v200, v177, v176, s32
    v_perm_b32 v201, v179, v178, s32
    v_perm_b32 v202, v181, v180, s32
    v_perm_b32 v203, v183, v182, s32
    buffer_store_dwordx4 v[200:203], v3, s[8:11], s34 offen offset:0 sc1
    v_perm_b32 v204, v177, v176, s33
    v_perm_b32 v205, v179, v178, s33
    v_perm_b32 v206, v181, v180, s33
    v_perm_b32 v207, v183, v182, s33
    buffer_store_dwordx4 v[204:207], v3, s[8:11], s34 offen offset:1024 sc1
    v_perm_b32 v208, v185, v184, s33
    v_perm_b32 v209, v187, v186, s33
    v_perm_b32 v210, v189, v188, s33
    v_perm_b32 v211, v191, v190, s33
    buffer_store_dwordx4 v[208:211], v3, s[8:11], s34 offen offset:2048 sc1
    v_perm_b32 v212, v185, v184, s32
    v_perm_b32 v213, v187, v186, s32
    v_perm_b32 v214, v189, v188, s32
    v_perm_b32 v215, v191, v190, s32
    buffer_store_dwordx4 v[212:215], v3, s[8:11], s34 offen offset:3072 sc1
    v_perm_b32 v176, v193, v192, s32
    v_perm_b32 v177, v195, v194, s32
    v_perm_b32 v178, v197, v196, s32
    v_perm_b32 v179, v199, v198, s32
    buffer_store_dwordx4 v[176:179], v3, s[8:11], s35 offen sc1
    s_nop 0
    s_mul_i32 s24, s16, 81920
    s_and_b32 s25, s20, 31
    s_mul_i32 s25, s25, 10
    s_add_u32 s25, s25, s21
    s_lshl_b32 s25, s25, 13
    s_getreg_b32 s26, hwreg(HW_REG_XCC_ID)
    s_and_b32 s26, s26, 15
    s_add_u32 s26, s26, 16
    s_add_u32 s26, s26, s46
    s_mul_i32 s28, s16, 196608
    s_mul_i32 s29, s17, 5
    s_lshr_b32 s29, s29, 1
    s_mul_i32 s30, s17, 3
    s_lshr_b32 s30, s30, 1
    s_lshl_b32 s39, s17, 2
    s_add_u32 s39, s39, s18
    s_mul_i32 s44, s39, 61440
    s_add_u32 s39, s44, 524288
    s_add_u32 s44, s44, 2490368
    v_lshlrev_b32 v1, 4, v0
    v_and_b32 v14, 31, v0
    v_lshrrev_b32 v15, 5, v0
    v_and_b32 v2, 3, v14
    v_bfe_u32 v3, v14, 2, 1
    v_lshl_add_u32 v2, v3, 4, v2
    v_bfe_u32 v3, v14, 3, 2
    v_lshl_add_u32 v2, v3, 2, v2
    v_lshlrev_b32 v2, 2, v2
    v_lshl_add_u32 v2, v15, 9, v2
    s_lshl_b32 s23, s19, 5
    v_add_u32 v5, s23, v14
    v_sub_u32 v6, 63, v5
    v_sub_u32 v7, 32, v14
    v_and_b32 v7, 31, v7
    v_sub_u32 v8, 95, v5
    s_cmp_eq_u32 s19, 0
    s_cselect_b64 s[36:37], -1, 0
    v_cndmask_b32 v7, v8, v7, s[36:37]
    s_cmp_eq_u32 s16, 0
    s_cselect_b64 s[36:37], -1, 0
    v_cndmask_b32 v6, v6, v7, s[36:37]
    v_lshrrev_b32 v3, 4, v5
    v_lshlrev_b32 v3, 10, v3
    v_and_b32 v7, 15, v5
    v_lshl_add_u32 v3, v7, 4, v3
    v_lshl_add_u32 v3, v15, 8, v3
    v_lshrrev_b32 v4, 4, v6
    v_lshlrev_b32 v4, 10, v4
    v_and_b32 v7, 15, v6
    v_lshl_add_u32 v4, v7, 4, v4
    v_lshl_add_u32 v4, v15, 8, v4
    v_mov_b32 v9, v6
    v_add_u32 v6, 640, v6
    v_cmp_eq_u32 vcc, 0, v15
    s_and_b32 s23, s2, 0xc7
    v_and_b32 v12, 7, v0
    v_cndmask_b32 v5, v6, v5, vcc
    v_lshlrev_b32 v5, 3, v5
    s_lshl_b32 s23, s16, 8
    v_lshl_add_u32 v12, v12, 4, s23
    v_and_b32 v13, 7, v14
    v_lshrrev_b32 v7, 3, v14
    v_lshl_add_u32 v13, v7, 6, v13
    v_lshl_add_u32 v13, v15, 5, v13
    s_and_b32 s23, s17, 3
    s_lshl_b32 s23, s23, 3
    v_add_u32 v13, s23, v13
    v_lshlrev_b32 v13, 7, v13
    s_and_b32 s23, s16, 0
    s_mul_i32 s23, s23, 32896
    s_add_u32 s23, s23, 32768
    v_add_u32 v13, s23, v13
    v_lshrrev_b32 v7, 4, v0
    v_and_b32 v8, 15, v0
    v_and_b32 v6, 1, v7
    s_and_b32 s23, s18, 1
    s_lshl_b32 s23, s23, 1
    v_add_u32 v6, s23, v6
    v_lshlrev_b32 v6, 8, v6
    v_lshl_add_u32 v6, v8, 4, v6
    v_lshl_add_u32 v6, v15, 10, v6
    v_mov_b32 v14, s45
    v_mov_b32 v15, s26
    s_mov_b64 exec, 1
    buffer_store_dword v15, v14, s[8:11], 0 offen offset:116 sc1
    s_mov_b64 exec, -1
    v_and_b32 v224, 31, v0
    v_lshlrev_b32 v224, 6, v224
    v_add_u32 v224, s20, v224
    s_lshl_b32 s23, s18, 4
    v_lshrrev_b32 v225, 5, v0
    v_lshl_add_u32 v225, v225, 2, s23
    v_mul_u32_u24 v225, v225, v224
    s_lshl_b32 s23, s18, 11
    s_add_u32 s23, s23, 151552
    v_add_u32 v226, s23, v1
    v_and_b32 v227, 2047, v225
    v_cvt_f32_u32 v227, v227
    v_mul_f32 v227, 0x3a000000, v227
    v_cos_f32 v228, v227
    v_sin_f32 v229, v227
    v_add_u32 v225, v225, v224
    v_cvt_pk_bf16_f32 v232, v228, v229
    v_and_b32 v227, 2047, v225
    v_cvt_f32_u32 v227, v227
    v_mul_f32 v227, 0x3a000000, v227
    v_cos_f32 v228, v227
    v_sin_f32 v229, v227
    v_add_u32 v225, v225, v224
    v_cvt_pk_bf16_f32 v233, v228, v229
    v_and_b32 v227, 2047, v225
    v_cvt_f32_u32 v227, v227
    v_mul_f32 v227, 0x3a000000, v227
    v_cos_f32 v228, v227
    v_sin_f32 v229, v227
    v_add_u32 v225, v225, v224
    v_cvt_pk_bf16_f32 v234, v228, v229
    v_and_b32 v227, 2047, v225
    v_cvt_f32_u32 v227, v227
    v_mul_f32 v227, 0x3a000000, v227
    v_cos_f32 v228, v227
    v_sin_f32 v229, v227
    v_add_u32 v225, v225, v224
    v_cvt_pk_bf16_f32 v235, v228, v229
    v_lshl_add_u32 v225, v224, 2, v225
    ds_write_b128 v226, v[232:235] offset:0
    v_and_b32 v227, 2047, v225
    v_cvt_f32_u32 v227, v227
    v_mul_f32 v227, 0x3a000000, v227
    v_cos_f32 v228, v227
    v_sin_f32 v229, v227
    v_add_u32 v225, v225, v224
    v_cvt_pk_bf16_f32 v236, v228, v229
    v_and_b32 v227, 2047, v225
    v_cvt_f32_u32 v227, v227
    v_mul_f32 v227, 0x3a000000, v227
    v_cos_f32 v228, v227
    v_sin_f32 v229, v227
    v_add_u32 v225, v225, v224
    v_cvt_pk_bf16_f32 v237, v228, v229
    v_and_b32 v227, 2047, v225
    v_cvt_f32_u32 v227, v227
    v_mul_f32 v227, 0x3a000000, v227
    v_cos_f32 v228, v227
    v_sin_f32 v229, v227
    v_add_u32 v225, v225, v224
    v_cvt_pk_bf16_f32 v238, v228, v229
    v_and_b32 v227, 2047, v225
    v_cvt_f32_u32 v227, v227
    v_mul_f32 v227, 0x3a000000, v227
    v_cos_f32 v228, v227
    v_sin_f32 v229, v227
    v_add_u32 v225, v225, v224
    v_cvt_pk_bf16_f32 v239, v228, v229
    ds_write_b128 v226, v[236:239] offset:1024
    s_waitcnt vmcnt(0)
    s_add_u32 s23, s46, 1
    v_mov_b32 v15, s23
    s_mov_b64 exec, 1
    buffer_store_dword v15, off, s[8:11], s98 offset:16 sc1
    s_mov_b64 exec, -1
    s_mul_i32 s23, s17, 24576
    s_mul_i32 s38, s18, 6144
    s_add_u32 s23, s23, s38
    s_add_u32 s23, s23, s28
    s_add_u32 s23, s23, 14942208
    s_add_u32 s38, s23, 4096
    v_mov_b32 v248, -1
    v_mov_b32 v249, -1
    v_mov_b32 v250, -1
    v_mov_b32 v251, -1
    buffer_store_dwordx4 v[248:251], v1, s[8:11], s23 offen offset:0
    buffer_store_dwordx4 v[248:251], v1, s[8:11], s23 offen offset:1024
    buffer_store_dwordx4 v[248:251], v1, s[8:11], s23 offen offset:2048
    buffer_store_dwordx4 v[248:251], v1, s[8:11], s23 offen offset:3072
    buffer_store_dwordx4 v[248:251], v1, s[8:11], s38 offen offset:0
    buffer_store_dwordx4 v[248:251], v1, s[8:11], s38 offen offset:1024
    s_nop 1
    v_and_b32 v10, 31, v0
    s_lshl_b32 s23, s17, 5
    v_add_u32 v10, s23, v10
    v_lshlrev_b32 v10, 7, v10
    v_add_u32 v10, 32784, v10
    s_mov_b32 s38, 0
    s_add_u32 s23, s46, 1
k2_poll2:
    buffer_load_dwordx2 v[252:253], v10, s[8:11], 0 offen offset:0 sc1
    s_add_u32 s38, s38, 1
    s_cmp_gt_u32 s38, 60000
    s_cbranch_scc1 k2_pout3
    s_waitcnt vmcnt(0)
    v_subrev_u32 v252, s23, v252
    v_subrev_u32 v253, s23, v253
    v_max_u32 v252, v252, v253
    v_cmp_lt_u32 vcc, 15, v252
    s_cbranch_vccz k2_pout3
    s_mov_b64 exec, vcc
    s_branch k2_poll2
k2_pout3:
    s_mov_b64 exec, -1
    s_add_u32 s23, s29, 0
    s_cmp_ge_u32 s23, 20
    s_cselect_b32 s38, 20, 0
    s_sub_u32 s23, s23, s38
    s_mul_i32 s23, s23, 3072
    s_add_u32 s23, s23, s39
    buffer_load_dwordx4 v[16:19], v1, s[8:11], s23 offen offset:0
    buffer_load_dwordx4 v[20:23], v1, s[8:11], s23 offen offset:1024
    buffer_load_dwordx4 v[24:27], v1, s[8:11], s23 offen offset:2048
    s_add_u32 s23, s29, 1
    s_cmp_ge_u32 s23, 20
    s_cselect_b32 s38, 20, 0
    s_sub_u32 s23, s23, s38
    s_mul_i32 s23, s23, 3072
    s_add_u32 s23, s23, s39
    buffer_load_dwordx4 v[28:31], v1, s[8:11], s23 offen offset:0
    buffer_load_dwordx4 v[32:35], v1, s[8:11], s23 offen offset:1024
    buffer_load_dwordx4 v[36:39], v1, s[8:11], s23 offen offset:2048
    s_add_u32 s23, s29, 2
    s_cmp_ge_u32 s23, 20
    s_cselect_b32 s38, 20, 0
    s_sub_u32 s23, s23, s38
    s_mul_i32 s23, s23, 3072
    s_add_u32 s23, s23, s39
    buffer_load_dwordx4 v[40:43], v1, s[8:11], s23 offen offset:0
    buffer_load_dwordx4 v[44:47], v1, s[8:11], s23 offen offset:1024
    buffer_load_dwordx4 v[48:51], v1, s[8:11], s23 offen offset:2048
    s_add_u32 s23, s29, 3
    s_cmp_ge_u32 s23, 20
    s_cselect_b32 s38, 20, 0
    s_sub_u32 s23, s23, s38
    s_mul_i32 s23, s23, 3072
    s_add_u32 s23, s23, s39
    buffer_load_dwordx4 v[52:55], v1, s[8:11], s23 offen offset:0
    buffer_load_dwordx4 v[56:59], v1, s[8:11], s23 offen offset:1024
    buffer_load_dwordx4 v[60:63], v1, s[8:11], s23 offen offset:2048
    s_add_u32 s23, s29, 4
    s_cmp_ge_u32 s23, 20
    s_cselect_b32 s38, 20, 0
    s_sub_u32 s23, s23, s38
    s_mul_i32 s23, s23, 3072
    s_add_u32 s23, s23, s39
    buffer_load_dwordx4 v[64:67], v1, s[8:11], s23 offen offset:0
    buffer_load_dwordx4 v[68:71], v1, s[8:11], s23 offen offset:1024
    buffer_load_dwordx4 v[72:75], v1, s[8:11], s23 offen offset:2048
    s_barrier
    s_mov_b32 s38, 0
    s_add_u32 s23, s46, 1
k2_poll4:
    buffer_load_dwordx2 v[252:253], v10, s[8:11], 0 offen offset:8 sc1
    s_add_u32 s38, s38, 1
    s_cmp_gt_u32 s38, 60000
    s_cbranch_scc1 k2_pout5
    s_waitcnt vmcnt(0)
    v_subrev_u32 v252, s23, v252
    v_subrev_u32 v253, s23, v253
    v_max_u32 v252, v252, v253
    v_cmp_lt_u32 vcc, 15, v252
    s_cbranch_vccz k2_pout5
    s_mov_b64 exec, vcc
    s_branch k2_poll4
k2_pout5:
    s_mov_b64 exec, -1
    s_mov_b32 s38, 0
    s_add_u32 s23, s46, 1
k2_poll6:
    buffer_load_dwordx3 v[252:254], v13, s[8:11], 0 offen sc1
    s_add_u32 s38, s38, 1
    s_cmp_gt_u32 s38, 60000
    s_cbranch_scc1 k2_pout7
    s_waitcnt vmcnt(0)
    v_subrev_u32 v252, s23, v252
    v_subrev_u32 v253, s23, v253
    v_subrev_u32 v254, s23, v254
    v_max3_u32 v252, v252, v253, v254
    v_cmp_lt_u32 vcc, 15, v252
    s_cbranch_vccz k2_pout7
    s_mov_b64 exec, vcc
    s_branch k2_poll6
k2_pout7:
    s_mov_b64 exec, -1
k2_B2:
    s_waitcnt lgkmcnt(0)
    s_barrier
    s_cmp_eq_u32 s18, 3
    s_cbranch_scc1 k2_w3b
    s_cmp_ge_u32 s18, s22
    s_cbranch_scc1 k2_nou8
    s_add_u32 s31, s25, 9699328
    s_add_u32 s32, s31, 4096
    buffer_load_dword v160, v2, s[8:11], s31 offen offset:0 sc1
    buffer_load_dword v161, v2, s[8:11], s31 offen offset:128 sc1
    buffer_load_dword v162, v2, s[8:11], s31 offen offset:256 sc1
    buffer_load_dword v163, v2, s[8:11], s31 offen offset:384 sc1
    buffer_load_dword v164, v2, s[8:11], s31 offen offset:1024 sc1
    buffer_load_dword v165, v2, s[8:11], s31 offen offset:1152 sc1
    buffer_load_dword v166, v2, s[8:11], s31 offen offset:1280 sc1
    buffer_load_dword v167, v2, s[8:11], s31 offen offset:1408 sc1
    buffer_load_dword v168, v2, s[8:11], s31 offen offset:2048 sc1
    buffer_load_dword v169, v2, s[8:11], s31 offen offset:2176 sc1
    buffer_load_dword v170, v2, s[8:11], s31 offen offset:2304 sc1
    buffer_load_dword v171, v2, s[8:11], s31 offen offset:2432 sc1
    buffer_load_dword v172, v2, s[8:11], s31 offen offset:3072 sc1
    buffer_load_dword v173, v2, s[8:11], s31 offen offset:3200 sc1
    buffer_load_dword v174, v2, s[8:11], s31 offen offset:3328 sc1
    buffer_load_dword v175, v2, s[8:11], s31 offen offset:3456 sc1
    buffer_load_dword v176, v2, s[8:11], s32 offen offset:0 sc1
    buffer_load_dword v177, v2, s[8:11], s32 offen offset:128 sc1
    buffer_load_dword v178, v2, s[8:11], s32 offen offset:256 sc1
    buffer_load_dword v179, v2, s[8:11], s32 offen offset:384 sc1
    buffer_load_dword v180, v2, s[8:11], s32 offen offset:1024 sc1
    buffer_load_dword v181, v2, s[8:11], s32 offen offset:1152 sc1
    buffer_load_dword v182, v2, s[8:11], s32 offen offset:1280 sc1
    buffer_load_dword v183, v2, s[8:11], s32 offen offset:1408 sc1
    buffer_load_dword v184, v2, s[8:11], s32 offen offset:2048 sc1
    buffer_load_dword v185, v2, s[8:11], s32 offen offset:2176 sc1
    buffer_load_dword v186, v2, s[8:11], s32 offen offset:2304 sc1
    buffer_load_dword v187, v2, s[8:11], s32 offen offset:2432 sc1
    buffer_load_dword v188, v2, s[8:11], s32 offen offset:3072 sc1
    buffer_load_dword v189, v2, s[8:11], s32 offen offset:3200 sc1
    buffer_load_dword v190, v2, s[8:11], s32 offen offset:3328 sc1
    buffer_load_dword v191, v2, s[8:11], s32 offen offset:3456 sc1
    v_add_u32 v14, 151552, v1
    ds_read_b128 v[224:227], v14 offset:0
    ds_read_b128 v[228:231], v14 offset:1024
    ds_read_b128 v[232:235], v14 offset:2048
    ds_read_b128 v[236:239], v14 offset:3072
    ds_read_b128 v[240:243], v14 offset:4096
    ds_read_b128 v[244:247], v14 offset:5120
    ds_read_b128 v[248:251], v14 offset:6144
    ds_read_b128 v[252:255], v14 offset:7168
    s_cmp_eq_u32 s21, 9
    s_cselect_b32 s37, -1, 0
    s_mov_b32 s36, 0
    s_waitcnt vmcnt(28)
    s_waitcnt lgkmcnt(7)
    v_mfma_f32_32x32x16_bf16 v[208:223], v[160:163], v[224:227], 0
    s_waitcnt vmcnt(24)
    s_waitcnt lgkmcnt(6)
    v_mfma_f32_32x32x16_bf16 v[208:223], v[164:167], v[228:231], v[208:223]
    s_waitcnt vmcnt(20)
    s_waitcnt lgkmcnt(5)
    v_mfma_f32_32x32x16_bf16 v[208:223], v[168:171], v[232:235], v[208:223]
    s_waitcnt vmcnt(16)
    s_waitcnt lgkmcnt(4)
    v_mfma_f32_32x32x16_bf16 v[208:223], v[172:175], v[236:239], v[208:223]
    s_waitcnt vmcnt(12)
    s_waitcnt lgkmcnt(3)
    v_mfma_f32_32x32x16_bf16 v[208:223], v[176:179], v[240:243], v[208:223]
    s_waitcnt vmcnt(8)
    s_waitcnt lgkmcnt(2)
    v_mfma_f32_32x32x16_bf16 v[208:223], v[180:183], v[244:247], v[208:223]
    s_waitcnt vmcnt(4)
    s_waitcnt lgkmcnt(1)
    v_mfma_f32_32x32x16_bf16 v[208:223], v[184:187], v[248:251], v[208:223]
    s_waitcnt vmcnt(0)
    s_waitcnt lgkmcnt(0)
    v_mfma_f32_32x32x16_bf16 v[208:223], v[188:191], v[252:255], v[208:223]
    buffer_load_dword v11, v12, s[8:11], 0 offen offset:128 sc1
    v_lshlrev_b32 v160, 16, v192
    v_and_b32 v161, 0xffff0000, v192
    v_and_b32 v176, 0xffff0000, v203
    v_lshlrev_b32 v177, 16, v203
    v_lshlrev_b32 v162, 16, v193
    v_and_b32 v163, 0xffff0000, v193
    v_and_b32 v178, 0xffff0000, v202
    v_lshlrev_b32 v179, 16, v202
    v_lshlrev_b32 v164, 16, v194
    v_and_b32 v165, 0xffff0000, v194
    v_and_b32 v180, 0xffff0000, v201
    v_lshlrev_b32 v181, 16, v201
    v_lshlrev_b32 v166, 16, v195
    v_and_b32 v167, 0xffff0000, v195
    v_and_b32 v182, 0xffff0000, v200
    v_lshlrev_b32 v183, 16, v200
    v_lshlrev_b32 v168, 16, v196
    v_and_b32 v169, 0xffff0000, v196
    v_and_b32 v184, 0xffff0000, v207
    v_lshlrev_b32 v185, 16, v207
    v_lshlrev_b32 v170, 16, v197
    v_and_b32 v171, 0xffff0000, v197
    v_and_b32 v186, 0xffff0000, v206
    v_lshlrev_b32 v187, 16, v206
    v_lshlrev_b32 v172, 16, v198
    v_and_b32 v173, 0xffff0000, v198
    v_and_b32 v188, 0xffff0000, v205
    v_lshlrev_b32 v189, 16, v205
    v_lshlrev_b32 v174, 16, v199
    v_and_b32 v175, 0xffff0000, v199
    v_and_b32 v190, 0xffff0000, v204
    v_lshlrev_b32 v191, 16, v204
    v_lshlrev_b32 v8, 16, v8
    v_cndmask_b32 v191, v191, v8, s[36:37]
    v_pk_add_f32 v[160:161], v[160:161], v[208:209]
    v_pk_add_f32 v[162:163], v[162:163], v[210:211]
    v_pk_add_f32 v[164:165], v[164:165], v[212:213]
    v_pk_add_f32 v[166:167], v[166:167], v[214:215]
    v_pk_add_f32 v[168:169], v[168:169], v[216:217]
    v_pk_add_f32 v[170:171], v[170:171], v[218:219]
    v_pk_add_f32 v[172:173], v[172:173], v[220:221]
    v_pk_add_f32 v[174:175], v[174:175], v[222:223]
    v_cndmask_b32 v223, v223, 0, s[36:37]
    v_cvt_pk_bf16_f32 v192, v160, v161
    v_cvt_pk_bf16_f32 v193, v162, v163
    v_cvt_pk_bf16_f32 v194, v164, v165
    v_cvt_pk_bf16_f32 v195, v166, v167
    v_cvt_pk_bf16_f32 v196, v168, v169
    v_cvt_pk_bf16_f32 v197, v170, v171
    v_cvt_pk_bf16_f32 v198, v172, v173
    v_cvt_pk_bf16_f32 v199, v174, v175
    s_add_u32 s34, s33, 7077888
    s_add_u32 s35, s34, 40960
    buffer_store_dwordx4 v[192:195], v3, s[8:11], s34 offen offset:0
    buffer_store_dwordx4 v[196:199], v3, s[8:11], s34 offen offset:512
    v_pk_add_f32 v[176:177], v[176:177], v[208:209]
    v_pk_add_f32 v[178:179], v[178:179], v[210:211]
    v_pk_add_f32 v[180:181], v[180:181], v[212:213]
    v_pk_add_f32 v[182:183], v[182:183], v[214:215]
    v_pk_add_f32 v[184:185], v[184:185], v[216:217]
    v_pk_add_f32 v[186:187], v[186:187], v[218:219]
    v_pk_add_f32 v[188:189], v[188:189], v[220:221]
    v_pk_add_f32 v[190:191], v[190:191], v[222:223]
    v_cvt_pk_bf16_f32 v200, v176, v177
    v_cvt_pk_bf16_f32 v201, v178, v179
    v_cvt_pk_bf16_f32 v202, v180, v181
    v_cvt_pk_bf16_f32 v203, v182, v183
    v_cvt_pk_bf16_f32 v204, v184, v185
    v_cvt_pk_bf16_f32 v205, v186, v187
    v_cvt_pk_bf16_f32 v206, v188, v189
    v_cvt_pk_bf16_f32 v207, v190, v191
    buffer_store_dwordx4 v[200:203], v4, s[8:11], s35 offen offset:0
    buffer_store_dwordx4 v[204:207], v4, s[8:11], s35 offen offset:512
    v_pk_mul_f32 v[226:227], v[160:161], v[160:161]
    v_pk_add_f32 v[224:225], v[160:161], v[162:163]
    v_pk_fma_f32 v[226:227], v[162:163], v[162:163], v[226:227]
    v_pk_add_f32 v[224:225], v[224:225], v[164:165]
    v_pk_fma_f32 v[226:227], v[164:165], v[164:165], v[226:227]
    v_pk_add_f32 v[224:225], v[224:225], v[166:167]
    v_pk_fma_f32 v[226:227], v[166:167], v[166:167], v[226:227]
    v_pk_add_f32 v[224:225], v[224:225], v[168:169]
    v_pk_fma_f32 v[226:227], v[168:169], v[168:169], v[226:227]
    v_pk_add_f32 v[224:225], v[224:225], v[170:171]
    v_pk_fma_f32 v[226:227], v[170:171], v[170:171], v[226:227]
    v_pk_add_f32 v[224:225], v[224:225], v[172:173]
    v_pk_fma_f32 v[226:227], v[172:173], v[172:173], v[226:227]
    v_pk_add_f32 v[224:225], v[224:225], v[174:175]
    v_pk_fma_f32 v[226:227], v[174:175], v[174:175], v[226:227]
    v_pk_mul_f32 v[230:231], v[176:177], v[176:177]
    v_pk_add_f32 v[228:229], v[176:177], v[178:179]
    v_pk_fma_f32 v[230:231], v[178:179], v[178:179], v[230:231]
    v_pk_add_f32 v[228:229], v[228:229], v[180:181]
    v_pk_fma_f32 v[230:231], v[180:181], v[180:181], v[230:231]
    v_pk_add_f32 v[228:229], v[228:229], v[182:183]
    v_pk_fma_f32 v[230:231], v[182:183], v[182:183], v[230:231]
    v_pk_add_f32 v[228:229], v[228:229], v[184:185]
    v_pk_fma_f32 v[230:231], v[184:185], v[184:185], v[230:231]
    v_pk_add_f32 v[228:229], v[228:229], v[186:187]
    v_pk_fma_f32 v[230:231], v[186:187], v[186:187], v[230:231]
    v_pk_add_f32 v[228:229], v[228:229], v[188:189]
    v_pk_fma_f32 v[230:231], v[188:189], v[188:189], v[230:231]
    v_pk_add_f32 v[228:229], v[228:229], v[190:191]
    v_pk_fma_f32 v[230:231], v[190:191], v[190:191], v[230:231]
    v_add_f32 v224, v224, v225
    v_add_f32 v225, v226, v227
    v_add_f32 v228, v228, v229
    v_add_f32 v229, v230, v231
    s_mul_i32 s23, s16, 10240
    s_lshl_b32 s38, s21, 9
    v_permlane32_swap_b32 v224, v228
    v_permlane32_swap_b32 v225, v229
    s_add_u32 s23, s23, s38
    s_add_u32 s23, s23, 21233664
    v_pk_add_f32 v[224:225], v[224:225], v[228:229]
    buffer_store_dwordx2 v[224:225], v5, s[8:11], s23 offen
k2_nou8x:
    s_waitcnt vmcnt(0)
    v_cmp_ne_u32 vcc, s26, v11
    s_mov_b32 s27, 0
    s_cbranch_vccnz k2_idv11
k2_idd10:
    s_add_u32 s23, s46, 1
    v_mov_b32 v14, s45
    v_mov_b32 v15, s23
    s_cmp_lg_u32 s27, 0
    s_cbranch_scc1 k2_pubs13
    s_mov_b64 exec, 1
    buffer_store_dword v15, v14, s[8:11], 0 offen offset:0
    s_mov_b64 exec, -1
k2_pub12:
    s_add_u32 s23, s46, 2
    v_mov_b32 v15, s23
    s_mov_b64 exec, 1
    buffer_store_dword v15, off, s[8:11], s98 offset:0 sc1
    s_mov_b64 exec, -1
    s_add_u32 s23, s29, 8
    s_cmp_ge_u32 s23, 20
    s_cselect_b32 s38, 20, 0
    s_sub_u32 s23, s23, s38
    s_mul_i32 s23, s23, 3072
    s_add_u32 s23, s23, s39
    buffer_load_dwordx4 v[112:115], v1, s[8:11], s23 offen offset:0
    buffer_load_dwordx4 v[116:119], v1, s[8:11], s23 offen offset:1024
    buffer_load_dwordx4 v[120:123], v1, s[8:11], s23 offen offset:2048
    s_add_u32 s23, s29, 9
    s_cmp_ge_u32 s23, 20
    s_cselect_b32 s38, 20, 0
    s_sub_u32 s23, s23, s38
    s_mul_i32 s23, s23, 3072
    s_add_u32 s23, s23, s39
    buffer_load_dwordx4 v[124:127], v1, s[8:11], s23 offen offset:0
    buffer_load_dwordx4 v[128:131], v1, s[8:11], s23 offen offset:1024
    buffer_load_dwordx4 v[132:135], v1, s[8:11], s23 offen offset:2048
    s_add_u32 s23, s29, 10
    s_cmp_ge_u32 s23, 20
    s_cselect_b32 s38, 20, 0
    s_sub_u32 s23, s23, s38
    s_mul_i32 s23, s23, 3072
    s_add_u32 s23, s23, s39
    buffer_load_dwordx4 v[136:139], v1, s[8:11], s23 offen offset:0
    buffer_load_dwordx4 v[140:143], v1, s[8:11], s23 offen offset:1024
    buffer_load_dwordx4 v[144:147], v1, s[8:11], s23 offen offset:2048
    s_add_u32 s23, s30, 0
    s_cmp_ge_u32 s23, 12
    s_cselect_b32 s38, 12, 0
    s_sub_u32 s23, s23, s38
    s_mul_i32 s23, s23, 5120
    s_add_u32 s23, s23, s44
    s_add_u32 s38, s23, 4096
    buffer_load_dwordx4 a[0:3], v1, s[8:11], s23 offen offset:0
    buffer_load_dwordx4 a[4:7], v1, s[8:11], s23 offen offset:1024
    buffer_load_dwordx4 a[8:11], v1, s[8:11], s23 offen offset:2048
    buffer_load_dwordx4 a[12:15], v1, s[8:11], s23 offen offset:3072
    buffer_load_dwordx4 a[16:19], v1, s[8:11], s38 offen offset:0
    s_add_u32 s23, s30, 1
    s_cmp_ge_u32 s23, 12
    s_cselect_b32 s38, 12, 0
    s_sub_u32 s23, s23, s38
    s_mul_i32 s23, s23, 5120
    s_add_u32 s23, s23, s44
    s_add_u32 s38, s23, 4096
    buffer_load_dwordx4 a[20:23], v1, s[8:11], s23 offen offset:0
    buffer_load_dwordx4 a[24:27], v1, s[8:11], s23 offen offset:1024
    buffer_load_dwordx4 a[28:31], v1, s[8:11], s23 offen offset:2048
    buffer_load_dwordx4 a[32:35], v1, s[8:11], s23 offen offset:3072
    buffer_load_dwordx4 a[36:39], v1, s[8:11], s38 offen offset:0
    s_add_u32 s41, s24, 7077888
    s_add_u32 s42, s29, s18
    s_lshl_b32 s40, s18, 12
    s_add_u32 s48, s42, 0
    s_cmp_ge_u32 s48, 20
    s_cselect_b32 s38, 20, 0
    s_sub_u32 s48, s48, s38
    s_mul_i32 s48, s48, 4096
    s_add_u32 s48, s48, s41
    s_add_u32 s49, s42, 4
    s_cmp_ge_u32 s49, 20
    s_cselect_b32 s38, 20, 0
    s_sub_u32 s49, s49, s38
    s_mul_i32 s49, s49, 4096
    s_add_u32 s49, s49, s41
    s_add_u32 s50, s42, 8
    s_cmp_ge_u32 s50, 20
    s_cselect_b32 s38, 20, 0
    s_sub_u32 s50, s50, s38
    s_mul_i32 s50, s50, 4096
    s_add_u32 s50, s50, s41
    s_add_u32 s51, s42, 12
    s_cmp_ge_u32 s51, 20
    s_cselect_b32 s38, 20, 0
    s_sub_u32 s51, s51, s38
    s_mul_i32 s51, s51, 4096
    s_add_u32 s51, s51, s41
    s_add_u32 s52, s42, 16
    s_cmp_ge_u32 s52, 20
    s_cselect_b32 s38, 20, 0
    s_sub_u32 s52, s52, s38
    s_mul_i32 s52, s52, 4096
    s_add_u32 s52, s52, s41
    s_add_u32 s53, s29, 11
    s_cmp_ge_u32 s53, 20
    s_cselect_b32 s38, 20, 0
    s_sub_u32 s53, s53, s38
    s_mul_i32 s53, s53, 3072
    s_add_u32 s53, s53, s39
    s_add_u32 s54, s29, 12
    s_cmp_ge_u32 s54, 20
    s_cselect_b32 s38, 20, 0
    s_sub_u32 s54, s54, s38
    s_mul_i32 s54, s54, 3072
    s_add_u32 s54, s54, s39
    s_add_u32 s55, s29, 13
    s_cmp_ge_u32 s55, 20
    s_cselect_b32 s38, 20, 0
    s_sub_u32 s55, s55, s38
    s_mul_i32 s55, s55, 3072
    s_add_u32 s55, s55, s39
    s_add_u32 s56, s29, 14
    s_cmp_ge_u32 s56, 20
    s_cselect_b32 s38, 20, 0
    s_sub_u32 s56, s56, s38
    s_mul_i32 s56, s56, 3072
    s_add_u32 s56, s56, s39
    s_add_u32 s57, s29, 15
    s_cmp_ge_u32 s57, 20
    s_cselect_b32 s38, 20, 0
    s_sub_u32 s57, s57, s38
    s_mul_i32 s57, s57, 3072
    s_add_u32 s57, s57, s39
    s_add_u32 s58, s29, 16
    s_cmp_ge_u32 s58, 20
    s_cselect_b32 s38, 20, 0
    s_sub_u32 s58, s58, s38
    s_mul_i32 s58, s58, 3072
    s_add_u32 s58, s58, s39
    s_add_u32 s59, s29, 17
    s_cmp_ge_u32 s59, 20
    s_cselect_b32 s38, 20, 0
    s_sub_u32 s59, s59, s38
    s_mul_i32 s59, s59, 3072
    s_add_u32 s59, s59, s39
    s_add_u32 s60, s29, 18
    s_cmp_ge_u32 s60, 20
    s_cselect_b32 s38, 20, 0
    s_sub_u32 s60, s60, s38
    s_mul_i32 s60, s60, 3072
    s_add_u32 s60, s60, s39
    s_add_u32 s61, s29, 19
    s_cmp_ge_u32 s61, 20
    s_cselect_b32 s38, 20, 0
    s_sub_u32 s61, s61, s38
    s_mul_i32 s61, s61, 3072
    s_add_u32 s61, s61, s39
    s_add_u32 s31, s30, 2
    s_cmp_ge_u32 s31, 12
    s_cselect_b32 s38, 12, 0
    s_sub_u32 s31, s31, s38
    s_mul_i32 s31, s31, 5120
    s_add_u32 s31, s31, s44
    s_add_u32 s32, s30, 3
    s_cmp_ge_u32 s32, 12
    s_cselect_b32 s38, 12, 0
    s_sub_u32 s32, s32, s38
    s_mul_i32 s32, s32, 5120
    s_add_u32 s32, s32, s44
    s_add_u32 s33, s30, 4
    s_cmp_ge_u32 s33, 12
    s_cselect_b32 s38, 12, 0
    s_sub_u32 s33, s33, s38
    s_mul_i32 s33, s33, 5120
    s_add_u32 s33, s33, s44
    s_add_u32 s34, s30, 5
    s_cmp_ge_u32 s34, 12
    s_cselect_b32 s38, 12, 0
    s_sub_u32 s34, s34, s38
    s_mul_i32 s34, s34, 5120
    s_add_u32 s34, s34, s44
    s_add_u32 s35, s30, 6
    s_cmp_ge_u32 s35, 12
    s_cselect_b32 s38, 12, 0
    s_sub_u32 s35, s35, s38
    s_mul_i32 s35, s35, 5120
    s_add_u32 s35, s35, s44
    s_add_u32 s36, s30, 7
    s_cmp_ge_u32 s36, 12
    s_cselect_b32 s38, 12, 0
    s_sub_u32 s36, s36, s38
    s_mul_i32 s36, s36, 5120
    s_add_u32 s36, s36, s44
    s_mul_i32 s42, s18, 3072
    s_min_u32 s42, s42, 7168
    s_mul_i32 s63, s16, 10240
    s_add_u32 s63, s63, s42
    s_add_u32 s63, s63, 21233664
    s_add_u32 s42, s42, 81920
    s_add_u32 m0, s40, 0
    s_branch k2_sb1
k2_w3b:
    buffer_load_dword v11, v12, s[8:11], 0 offen offset:128 sc1
    s_waitcnt vmcnt(0)
    v_cmp_ne_u32 vcc, s26, v11
    s_mov_b32 s27, 0
    s_cbranch_vccnz k2_idv15
k2_idd14:
    s_add_u32 s23, s46, 1
    v_mov_b32 v14, s45
    v_mov_b32 v15, s23
    s_cmp_lg_u32 s27, 0
    s_cbranch_scc1 k2_pubs17
    s_mov_b64 exec, 1
    buffer_store_dword v15, v14, s[8:11], 0 offen offset:0
    s_mov_b64 exec, -1
k2_pub16:
    s_add_u32 s23, s29, 5
    s_cmp_ge_u32 s23, 20
    s_cselect_b32 s38, 20, 0
    s_sub_u32 s23, s23, s38
    s_mul_i32 s23, s23, 3072
    s_add_u32 s23, s23, s39
    buffer_load_dwordx4 v[76:79], v1, s[8:11], s23 offen offset:0
    buffer_load_dwordx4 v[80:83], v1, s[8:11], s23 offen offset:1024
    buffer_load_dwordx4 v[84:87], v1, s[8:11], s23 offen offset:2048
    s_add_u32 s23, s29, 6
    s_cmp_ge_u32 s23, 20
    s_cselect_b32 s38, 20, 0
    s_sub_u32 s23, s23, s38
    s_mul_i32 s23, s23, 3072
    s_add_u32 s23, s23, s39
    buffer_load_dwordx4 v[88:91], v1, s[8:11], s23 offen offset:0
    buffer_load_dwordx4 v[92:95], v1, s[8:11], s23 offen offset:1024
    buffer_load_dwordx4 v[96:99], v1, s[8:11], s23 offen offset:2048
    s_add_u32 s23, s29, 7
    s_cmp_ge_u32 s23, 20
    s_cselect_b32 s38, 20, 0
    s_sub_u32 s23, s23, s38
    s_mul_i32 s23, s23, 3072
    s_add_u32 s23, s23, s39
    buffer_load_dwordx4 v[100:103], v1, s[8:11], s23 offen offset:0
    buffer_load_dwordx4 v[104:107], v1, s[8:11], s23 offen offset:1024
    buffer_load_dwordx4 v[108:111], v1, s[8:11], s23 offen offset:2048
    s_add_u32 s23, s29, 8
    s_cmp_ge_u32 s23, 20
    s_cselect_b32 s38, 20, 0
    s_sub_u32 s23, s23, s38
    s_mul_i32 s23, s23, 3072
    s_add_u32 s23, s23, s39
    buffer_load_dwordx4 v[112:115], v1, s[8:11], s23 offen offset:0
    buffer_load_dwordx4 v[116:119], v1, s[8:11], s23 offen offset:1024
    buffer_load_dwordx4 v[120:123], v1, s[8:11], s23 offen offset:2048
    s_add_u32 s23, s29, 9
    s_cmp_ge_u32 s23, 20
    s_cselect_b32 s38, 20, 0
    s_sub_u32 s23, s23, s38
    s_mul_i32 s23, s23, 3072
    s_add_u32 s23, s23, s39
    buffer_load_dwordx4 v[124:127], v1, s[8:11], s23 offen offset:0
    buffer_load_dwordx4 v[128:131], v1, s[8:11], s23 offen offset:1024
    buffer_load_dwordx4 v[132:135], v1, s[8:11], s23 offen offset:2048
    s_add_u32 s23, s29, 10
    s_cmp_ge_u32 s23, 20
    s_cselect_b32 s38, 20, 0
    s_sub_u32 s23, s23, s38
    s_mul_i32 s23, s23, 3072
    s_add_u32 s23, s23, s39
    buffer_load_dwordx4 v[136:139], v1, s[8:11], s23 offen offset:0
    buffer_load_dwordx4 v[140:143], v1, s[8:11], s23 offen offset:1024
    buffer_load_dwordx4 v[144:147], v1, s[8:11], s23 offen offset:2048
    s_add_u32 s23, s30, 0
    s_cmp_ge_u32 s23, 12
    s_cselect_b32 s38, 12, 0
    s_sub_u32 s23, s23, s38
    s_mul_i32 s23, s23, 5120
    s_add_u32 s23, s23, s44
    s_add_u32 s38, s23, 4096
    buffer_load_dwordx4 a[0:3], v1, s[8:11], s23 offen offset:0
    buffer_load_dwordx4 a[4:7], v1, s[8:11], s23 offen offset:1024
    buffer_load_dwordx4 a[8:11], v1, s[8:11], s23 offen offset:2048
    buffer_load_dwordx4 a[12:15], v1, s[8:11], s23 offen offset:3072
    buffer_load_dwordx4 a[16:19], v1, s[8:11], s38 offen offset:0
    s_add_u32 s23, s30, 1
    s_cmp_ge_u32 s23, 12
    s_cselect_b32 s38, 12, 0
    s_sub_u32 s23, s23, s38
    s_mul_i32 s23, s23, 5120
    s_add_u32 s23, s23, s44
    s_add_u32 s38, s23, 4096
    buffer_load_dwordx4 a[20:23], v1, s[8:11], s23 offen offset:0
    buffer_load_dwordx4 a[24:27], v1, s[8:11], s23 offen offset:1024
    buffer_load_dwordx4 a[28:31], v1, s[8:11], s23 offen offset:2048
    buffer_load_dwordx4 a[32:35], v1, s[8:11], s23 offen offset:3072
    buffer_load_dwordx4 a[36:39], v1, s[8:11], s38 offen offset:0
    s_add_u32 s23, s30, 8
    s_cmp_ge_u32 s23, 12
    s_cselect_b32 s38, 12, 0
    s_sub_u32 s23, s23, s38
    s_mul_i32 s23, s23, 5120
    s_add_u32 s23, s23, s44
    s_add_u32 s38, s23, 4096
    buffer_load_dwordx4 a[160:163], v1, s[8:11], s23 offen offset:0
    buffer_load_dwordx4 a[164:167], v1, s[8:11], s23 offen offset:1024
    buffer_load_dwordx4 a[168:171], v1, s[8:11], s23 offen offset:2048
    buffer_load_dwordx4 a[172:175], v1, s[8:11], s23 offen offset:3072
    buffer_load_dwordx4 a[176:179], v1, s[8:11], s38 offen offset:0
    s_add_u32 s23, s30, 9
    s_cmp_ge_u32 s23, 12
    s_cselect_b32 s38, 12, 0
    s_sub_u32 s23, s23, s38
    s_mul_i32 s23, s23, 5120
    s_add_u32 s23, s23, s44
    s_add_u32 s38, s23, 4096
    buffer_load_dwordx4 a[180:183], v1, s[8:11], s23 offen offset:0
    buffer_load_dwordx4 a[184:187], v1, s[8:11], s23 offen offset:1024
    buffer_load_dwordx4 a[188:191], v1, s[8:11], s23 offen offset:2048
    buffer_load_dwordx4 a[192:195], v1, s[8:11], s23 offen offset:3072
    buffer_load_dwordx4 a[196:199], v1, s[8:11], s38 offen offset:0
    s_add_u32 s23, s30, 10
    s_cmp_ge_u32 s23, 12
    s_cselect_b32 s38, 12, 0
    s_sub_u32 s23, s23, s38
    s_mul_i32 s23, s23, 5120
    s_add_u32 s23, s23, s44
    s_add_u32 s38, s23, 4096
    buffer_load_dwordx4 a[200:203], v1, s[8:11], s23 offen offset:0
    buffer_load_dwordx4 a[204:207], v1, s[8:11], s23 offen offset:1024
    buffer_load_dwordx4 a[208:211], v1, s[8:11], s23 offen offset:2048
    buffer_load_dwordx4 a[212:215], v1, s[8:11], s23 offen offset:3072
    buffer_load_dwordx4 a[216:219], v1, s[8:11], s38 offen offset:0
    s_add_u32 s23, s30, 11
    s_cmp_ge_u32 s23, 12
    s_cselect_b32 s38, 12, 0
    s_sub_u32 s23, s23, s38
    s_mul_i32 s23, s23, 5120
    s_add_u32 s23, s23, s44
    s_add_u32 s38, s23, 4096
    buffer_load_dwordx4 a[220:223], v1, s[8:11], s23 offen offset:0
    buffer_load_dwordx4 a[224:227], v1, s[8:11], s23 offen offset:1024
    buffer_load_dwordx4 a[228:231], v1, s[8:11], s23 offen offset:2048
    buffer_load_dwordx4 a[232:235], v1, s[8:11], s23 offen offset:3072
    buffer_load_dwordx4 a[236:239], v1, s[8:11], s38 offen offset:0
    s_add_u32 s41, s24, 7077888
    s_add_u32 s42, s29, s18
    s_lshl_b32 s40, s18, 12
    s_add_u32 s48, s42, 0
    s_cmp_ge_u32 s48, 20
    s_cselect_b32 s38, 20, 0
    s_sub_u32 s48, s48, s38
    s_mul_i32 s48, s48, 4096
    s_add_u32 s48, s48, s41
    s_add_u32 s49, s42, 4
    s_cmp_ge_u32 s49, 20
    s_cselect_b32 s38, 20, 0
    s_sub_u32 s49, s49, s38
    s_mul_i32 s49, s49, 4096
    s_add_u32 s49, s49, s41
    s_add_u32 s50, s42, 8
    s_cmp_ge_u32 s50, 20
    s_cselect_b32 s38, 20, 0
    s_sub_u32 s50, s50, s38
    s_mul_i32 s50, s50, 4096
    s_add_u32 s50, s50, s41
    s_add_u32 s51, s42, 12
    s_cmp_ge_u32 s51, 20
    s_cselect_b32 s38, 20, 0
    s_sub_u32 s51, s51, s38
    s_mul_i32 s51, s51, 4096
    s_add_u32 s51, s51, s41
    s_add_u32 s52, s42, 16
    s_cmp_ge_u32 s52, 20
    s_cselect_b32 s38, 20, 0
    s_sub_u32 s52, s52, s38
    s_mul_i32 s52, s52, 4096
    s_add_u32 s52, s52, s41
    s_add_u32 s53, s29, 11
    s_cmp_ge_u32 s53, 20
    s_cselect_b32 s38, 20, 0
    s_sub_u32 s53, s53, s38
    s_mul_i32 s53, s53, 3072
    s_add_u32 s53, s53, s39
    s_add_u32 s54, s29, 12
    s_cmp_ge_u32 s54, 20
    s_cselect_b32 s38, 20, 0
    s_sub_u32 s54, s54, s38
    s_mul_i32 s54, s54, 3072
    s_add_u32 s54, s54, s39
    s_add_u32 s55, s29, 13
    s_cmp_ge_u32 s55, 20
    s_cselect_b32 s38, 20, 0
    s_sub_u32 s55, s55, s38
    s_mul_i32 s55, s55, 3072
    s_add_u32 s55, s55, s39
    s_add_u32 s56, s29, 14
    s_cmp_ge_u32 s56, 20
    s_cselect_b32 s38, 20, 0
    s_sub_u32 s56, s56, s38
    s_mul_i32 s56, s56, 3072
    s_add_u32 s56, s56, s39
    s_add_u32 s57, s29, 15
    s_cmp_ge_u32 s57, 20
    s_cselect_b32 s38, 20, 0
    s_sub_u32 s57, s57, s38
    s_mul_i32 s57, s57, 3072
    s_add_u32 s57, s57, s39
    s_add_u32 s58, s29, 16
    s_cmp_ge_u32 s58, 20
    s_cselect_b32 s38, 20, 0
    s_sub_u32 s58, s58, s38
    s_mul_i32 s58, s58, 3072
    s_add_u32 s58, s58, s39
    s_add_u32 s59, s29, 17
    s_cmp_ge_u32 s59, 20
    s_cselect_b32 s38, 20, 0
    s_sub_u32 s59, s59, s38
    s_mul_i32 s59, s59, 3072
    s_add_u32 s59, s59, s39
    s_add_u32 s60, s29, 18
    s_cmp_ge_u32 s60, 20
    s_cselect_b32 s38, 20, 0
    s_sub_u32 s60, s60, s38
    s_mul_i32 s60, s60, 3072
    s_add_u32 s60, s60, s39
    s_add_u32 s61, s29, 19
    s_cmp_ge_u32 s61, 20
    s_cselect_b32 s38, 20, 0
    s_sub_u32 s61, s61, s38
    s_mul_i32 s61, s61, 3072
    s_add_u32 s61, s61, s39
    s_add_u32 s31, s30, 2
    s_cmp_ge_u32 s31, 12
    s_cselect_b32 s38, 12, 0
    s_sub_u32 s31, s31, s38
    s_mul_i32 s31, s31, 5120
    s_add_u32 s31, s31, s44
    s_add_u32 s32, s30, 3
    s_cmp_ge_u32 s32, 12
    s_cselect_b32 s38, 12, 0
    s_sub_u32 s32, s32, s38
    s_mul_i32 s32, s32, 5120
    s_add_u32 s32, s32, s44
    s_add_u32 s33, s30, 4
    s_cmp_ge_u32 s33, 12
    s_cselect_b32 s38, 12, 0
    s_sub_u32 s33, s33, s38
    s_mul_i32 s33, s33, 5120
    s_add_u32 s33, s33, s44
    s_add_u32 s34, s30, 5
    s_cmp_ge_u32 s34, 12
    s_cselect_b32 s38, 12, 0
    s_sub_u32 s34, s34, s38
    s_mul_i32 s34, s34, 5120
    s_add_u32 s34, s34, s44
    s_add_u32 s35, s30, 6
    s_cmp_ge_u32 s35, 12
    s_cselect_b32 s38, 12, 0
    s_sub_u32 s35, s35, s38
    s_mul_i32 s35, s35, 5120
    s_add_u32 s35, s35, s44
    s_add_u32 s36, s30, 7
    s_cmp_ge_u32 s36, 12
    s_cselect_b32 s38, 12, 0
    s_sub_u32 s36, s36, s38
    s_mul_i32 s36, s36, 5120
    s_add_u32 s36, s36, s44
    s_mul_i32 s42, s18, 3072
    s_min_u32 s42, s42, 7168
    s_mul_i32 s63, s16, 10240
    s_add_u32 s63, s63, s42
    s_add_u32 s63, s63, 21233664
    s_add_u32 s42, s42, 81920
    s_add_u32 m0, s40, 0
    s_mov_b32 s38, 0
    s_add_u32 s23, s46, 1
k2_poll18:
    buffer_load_dwordx4 v[252:255], v12, s[8:11], 0 offen offset:0 sc1
    s_add_u32 s38, s38, 1
    s_cmp_gt_u32 s38, 60000
    s_cbranch_scc1 k2_pout19
    s_waitcnt vmcnt(0)
    v_subrev_u32 v252, s23, v252
    v_subrev_u32 v253, s23, v253
    v_subrev_u32 v254, s23, v254
    v_subrev_u32 v255, s23, v255
    v_max3_u32 v252, v252, v253, v254
    v_max_u32 v252, v252, v255
    v_cmp_lt_u32 vcc, 15, v252
    s_cbranch_vccnz k2_poll18
k2_pout19:
k2_sb1:
    s_barrier
    s_cmp_lg_u32 s27, 0
    s_cbranch_scc1 k2_acqs21
k2_acq20:
    buffer_load_dwordx4 v1, s[8:11], s48 offen offset:0 sc1 lds
    buffer_load_dwordx4 v1, s[8:11], s48 offen offset:1024 sc1 lds
    buffer_load_dwordx4 v1, s[8:11], s48 offen offset:2048 sc1 lds
    buffer_load_dwordx4 v1, s[8:11], s48 offen offset:3072 sc1 lds
    s_mov_b32 m0, s42
    v_add_u32 v15, 0x10000, v1
    buffer_load_dwordx4 v1, s[8:11], s63 offen offset:0 sc1 lds
    buffer_load_dwordx4 v1, s[8:11], s63 offen offset:1024 sc1 lds
    buffer_load_dwordx4 v1, s[8:11], s63 offen offset:2048 sc1 lds
    s_add_u32 m0, s40, 16384
    v_lshlrev_b32 v14, 3, v0
    buffer_load_dwordx4 v1, s[8:11], s49 offen offset:0 sc1 lds
    buffer_load_dwordx4 v1, s[8:11], s49 offen offset:1024 sc1 lds
    buffer_load_dwordx4 v1, s[8:11], s49 offen offset:2048 sc1 lds
    buffer_load_dwordx4 v1, s[8:11], s49 offen offset:3072 sc1 lds
    v_add_u32 v14, 81920, v14
    v_add_u32 v10, 4096, v1
    v_mov_b32 v240, 0x3f803f80
    v_mov_b32 v241, 0x3f803f80
    v_mov_b32 v242, 0x3f803f80
    v_mov_b32 v243, 0x3f803f80
    s_nop 0
    s_waitcnt vmcnt(21)
    s_nop 0
    v_mfma_f32_16x16x32_bf16 a[240:243], v[16:19], v[240:243], 0
    v_mfma_f32_16x16x32_bf16 a[244:247], v[20:23], v[240:243], 0
    v_mfma_f32_16x16x32_bf16 a[248:251], v[24:27], v[240:243], 0
    v_mfma_f32_16x16x32_bf16 a[240:243], v[28:31], v[240:243], a[240:243]
    v_mfma_f32_16x16x32_bf16 a[244:247], v[32:35], v[240:243], a[244:247]
    v_mfma_f32_16x16x32_bf16 a[248:251], v[36:39], v[240:243], a[248:251]
    v_mfma_f32_16x16x32_bf16 a[240:243], v[40:43], v[240:243], a[240:243]
    v_mfma_f32_16x16x32_bf16 a[244:247], v[44:47], v[240:243], a[244:247]
    v_mfma_f32_16x16x32_bf16 a[248:251], v[48:51], v[240:243], a[248:251]
    v_mfma_f32_16x16x32_bf16 a[240:243], v[52:55], v[240:243], a[240:243]
    v_mfma_f32_16x16x32_bf16 a[244:247], v[56:59], v[240:243], a[244:247]
    v_mfma_f32_16x16x32_bf16 a[248:251], v[60:63], v[240:243], a[248:251]
    v_mfma_f32_16x16x32_bf16 a[240:243], v[64:67], v[240:243], a[240:243]
    v_mfma_f32_16x16x32_bf16 a[244:247], v[68:71], v[240:243], a[244:247]
    v_mfma_f32_16x16x32_bf16 a[248:251], v[72:75], v[240:243], a[248:251]
    v_mfma_f32_16x16x32_bf16 a[240:243], v[76:79], v[240:243], a[240:243]
    v_mfma_f32_16x16x32_bf16 a[244:247], v[80:83], v[240:243], a[244:247]
    v_mfma_f32_16x16x32_bf16 a[248:251], v[84:87], v[240:243], a[248:251]
    v_mfma_f32_16x16x32_bf16 a[240:243], v[88:91], v[240:243], a[240:243]
    v_mfma_f32_16x16x32_bf16 a[244:247], v[92:95], v[240:243], a[244:247]
    v_mfma_f32_16x16x32_bf16 a[248:251], v[96:99], v[240:243], a[248:251]
    v_mfma_f32_16x16x32_bf16 a[240:243], v[100:103], v[240:243], a[240:243]
    v_mfma_f32_16x16x32_bf16 a[244:247], v[104:107], v[240:243], a[244:247]
    v_mfma_f32_16x16x32_bf16 a[248:251], v[108:111], v[240:243], a[248:251]
    v_mfma_f32_16x16x32_bf16 a[240:243], v[112:115], v[240:243], a[240:243]
    v_mfma_f32_16x16x32_bf16 a[244:247], v[116:119], v[240:243], a[244:247]
    v_mfma_f32_16x16x32_bf16 a[248:251], v[120:123], v[240:243], a[248:251]
    v_mfma_f32_16x16x32_bf16 a[240:243], v[124:127], v[240:243], a[240:243]
    v_mfma_f32_16x16x32_bf16 a[244:247], v[128:131], v[240:243], a[244:247]
    v_mfma_f32_16x16x32_bf16 a[248:251], v[132:135], v[240:243], a[248:251]
    v_mfma_f32_16x16x32_bf16 a[240:243], v[136:139], v[240:243], a[240:243]
    v_mfma_f32_16x16x32_bf16 a[244:247], v[140:143], v[240:243], a[244:247]
    v_mfma_f32_16x16x32_bf16 a[248:251], v[144:147], v[240:243], a[248:251]
    s_waitcnt vmcnt(7)
    s_barrier
    ds_read_b128 v[208:211], v1 offset:0
    ds_read_b128 v[212:215], v1 offset:1024
    ds_read_b128 v[216:219], v1 offset:2048
    ds_read_b128 v[220:223], v1 offset:3072
    s_waitcnt lgkmcnt(3)
    v_mfma_f32_16x16x32_bf16 v[160:163], v[16:19], v[208:211], 0
    v_mfma_f32_16x16x32_bf16 v[176:179], v[20:23], v[208:211], 0
    ds_read_b128 v[224:227], v1 offset:4096
    v_mfma_f32_16x16x32_bf16 v[192:195], v[24:27], v[208:211], 0
    s_waitcnt lgkmcnt(3)
    v_mfma_f32_16x16x32_bf16 v[164:167], v[16:19], v[212:215], 0
    ds_read_b128 v[228:231], v1 offset:5120
    s_add_u32 m0, s40, 32768
    v_mfma_f32_16x16x32_bf16 v[180:183], v[20:23], v[212:215], 0
    buffer_load_dwordx4 v1, s[8:11], s50 offen offset:0 sc1 lds
    v_mfma_f32_16x16x32_bf16 v[196:199], v[24:27], v[212:215], 0
    ds_read_b128 v[232:235], v1 offset:6144
    s_waitcnt lgkmcnt(4)
    v_mfma_f32_16x16x32_bf16 v[168:171], v[16:19], v[216:219], 0
    buffer_load_dwordx4 v1, s[8:11], s50 offen offset:1024 sc1 lds
    v_mfma_f32_16x16x32_bf16 v[184:187], v[20:23], v[216:219], 0
    ds_read_b128 v[236:239], v1 offset:7168
    v_mfma_f32_16x16x32_bf16 v[200:203], v[24:27], v[216:219], 0
    buffer_load_dwordx4 v1, s[8:11], s50 offen offset:2048 sc1 lds
    s_waitcnt lgkmcnt(4)
    v_mfma_f32_16x16x32_bf16 v[172:175], v[16:19], v[220:223], 0
    v_mfma_f32_16x16x32_bf16 v[188:191], v[20:23], v[220:223], 0
    v_mfma_f32_16x16x32_bf16 v[204:207], v[24:27], v[220:223], 0
    s_waitcnt lgkmcnt(3)
    v_mfma_f32_16x16x32_bf16 v[160:163], v[28:31], v[224:227], v[160:163]
    v_mfma_f32_16x16x32_bf16 v[176:179], v[32:35], v[224:227], v[176:179]
    ds_read_b128 v[208:211], v1 offset:8192
    v_mfma_f32_16x16x32_bf16 v[192:195], v[36:39], v[224:227], v[192:195]
    s_waitcnt lgkmcnt(3)
    v_mfma_f32_16x16x32_bf16 v[164:167], v[28:31], v[228:231], v[164:167]
    ds_read_b128 v[212:215], v1 offset:9216
    v_mfma_f32_16x16x32_bf16 v[180:183], v[32:35], v[228:231], v[180:183]
    buffer_load_dwordx4 v1, s[8:11], s50 offen offset:3072 sc1 lds
    v_mfma_f32_16x16x32_bf16 v[196:199], v[36:39], v[228:231], v[196:199]
    ds_read_b128 v[216:219], v1 offset:10240
    s_waitcnt lgkmcnt(4)
    v_mfma_f32_16x16x32_bf16 v[168:171], v[28:31], v[232:235], v[168:171]
    buffer_load_dwordx4 v[148:151], v1, s[8:11], s53 offen offset:0
    v_mfma_f32_16x16x32_bf16 v[184:187], v[32:35], v[232:235], v[184:187]
    ds_read_b128 v[220:223], v1 offset:11264
    v_mfma_f32_16x16x32_bf16 v[200:203], v[36:39], v[232:235], v[200:203]
    buffer_load_dwordx4 v[152:155], v1, s[8:11], s53 offen offset:1024
    s_waitcnt lgkmcnt(4)
    v_mfma_f32_16x16x32_bf16 v[172:175], v[28:31], v[236:239], v[172:175]
    v_mfma_f32_16x16x32_bf16 v[188:191], v[32:35], v[236:239], v[188:191]
    v_mfma_f32_16x16x32_bf16 v[204:207], v[36:39], v[236:239], v[204:207]
    s_waitcnt lgkmcnt(3)
    v_mfma_f32_16x16x32_bf16 v[160:163], v[40:43], v[208:211], v[160:163]
    v_mfma_f32_16x16x32_bf16 v[176:179], v[44:47], v[208:211], v[176:179]
    ds_read_b128 v[224:227], v1 offset:12288
    v_mfma_f32_16x16x32_bf16 v[192:195], v[48:51], v[208:211], v[192:195]
    s_waitcnt lgkmcnt(3)
    v_mfma_f32_16x16x32_bf16 v[164:167], v[40:43], v[212:215], v[164:167]
    ds_read_b128 v[228:231], v1 offset:13312
    v_mfma_f32_16x16x32_bf16 v[180:183], v[44:47], v[212:215], v[180:183]
    buffer_load_dwordx4 v[156:159], v1, s[8:11], s53 offen offset:2048
    v_mfma_f32_16x16x32_bf16 v[196:199], v[48:51], v[212:215], v[196:199]
    ds_read_b128 v[232:235], v1 offset:14336
    s_add_u32 m0, s40, 49152
    s_waitcnt lgkmcnt(4)
    v_mfma_f32_16x16x32_bf16 v[168:171], v[40:43], v[216:219], v[168:171]
    buffer_load_dwordx4 v1, s[8:11], s51 offen offset:0 sc1 lds
    v_mfma_f32_16x16x32_bf16 v[184:187], v[44:47], v[216:219], v[184:187]
    ds_read_b128 v[236:239], v1 offset:15360
    v_mfma_f32_16x16x32_bf16 v[200:203], v[48:51], v[216:219], v[200:203]
    buffer_load_dwordx4 v1, s[8:11], s51 offen offset:1024 sc1 lds
    s_waitcnt lgkmcnt(4)
    v_mfma_f32_16x16x32_bf16 v[172:175], v[40:43], v[220:223], v[172:175]
    v_mfma_f32_16x16x32_bf16 v[188:191], v[44:47], v[220:223], v[188:191]
    v_mfma_f32_16x16x32_bf16 v[204:207], v[48:51], v[220:223], v[204:207]
    s_waitcnt lgkmcnt(3)
    v_mfma_f32_16x16x32_bf16 v[160:163], v[52:55], v[224:227], v[160:163]
    s_waitcnt vmcnt(9)
    s_barrier
    v_mfma_f32_16x16x32_bf16 v[176:179], v[56:59], v[224:227], v[176:179]
    ds_read_b128 v[208:211], v1 offset:16384
    v_mfma_f32_16x16x32_bf16 v[192:195], v[60:63], v[224:227], v[192:195]
    s_waitcnt lgkmcnt(3)
    v_mfma_f32_16x16x32_bf16 v[164:167], v[52:55], v[228:231], v[164:167]
    ds_read_b128 v[212:215], v1 offset:17408
    v_mfma_f32_16x16x32_bf16 v[180:183], v[56:59], v[228:231], v[180:183]
    buffer_load_dwordx4 v1, s[8:11], s51 offen offset:2048 sc1 lds
    v_mfma_f32_16x16x32_bf16 v[196:199], v[60:63], v[228:231], v[196:199]
    ds_read_b128 v[216:219], v1 offset:18432
    s_waitcnt lgkmcnt(4)
    v_mfma_f32_16x16x32_bf16 v[168:171], v[52:55], v[232:235], v[168:171]
    buffer_load_dwordx4 v1, s[8:11], s51 offen offset:3072 sc1 lds
    v_mfma_f32_16x16x32_bf16 v[184:187], v[56:59], v[232:235], v[184:187]
    ds_read_b128 v[220:223], v1 offset:19456
    v_mfma_f32_16x16x32_bf16 v[200:203], v[60:63], v[232:235], v[200:203]
    buffer_load_dwordx4 v[16:19], v1, s[8:11], s54 offen offset:0
    s_waitcnt lgkmcnt(4)
    v_mfma_f32_16x16x32_bf16 v[172:175], v[52:55], v[236:239], v[172:175]
    v_mfma_f32_16x16x32_bf16 v[188:191], v[56:59], v[236:239], v[188:191]
    v_mfma_f32_16x16x32_bf16 v[204:207], v[60:63], v[236:239], v[204:207]
    s_waitcnt lgkmcnt(3)
    v_mfma_f32_16x16x32_bf16 v[160:163], v[64:67], v[208:211], v[160:163]
    ds_read2st64_b64 v[248:251], v14 offset0:0 offset1:1
    v_mfma_f32_16x16x32_bf16 v[176:179], v[68:71], v[208:211], v[176:179]
    ds_read_b128 v[224:227], v1 offset:20480
    v_mfma_f32_16x16x32_bf16 v[192:195], v[72:75], v[208:211], v[192:195]
    ds_read2st64_b64 v[252:255], v14 offset0:2 offset1:3
    s_waitcnt lgkmcnt(5)
    v_mfma_f32_16x16x32_bf16 v[164:167], v[64:67], v[212:215], v[164:167]
    ds_read_b128 v[228:231], v1 offset:21504
    v_mfma_f32_16x16x32_bf16 v[180:183], v[68:71], v[212:215], v[180:183]
    buffer_load_dwordx4 v[20:23], v1, s[8:11], s54 offen offset:1024
    v_mfma_f32_16x16x32_bf16 v[196:199], v[72:75], v[212:215], v[196:199]
    ds_read_b128 v[232:235], v1 offset:22528
    s_waitcnt lgkmcnt(6)
    v_mfma_f32_16x16x32_bf16 v[168:171], v[64:67], v[216:219], v[168:171]
    buffer_load_dwordx4 v[24:27], v1, s[8:11], s54 offen offset:2048
    v_mfma_f32_16x16x32_bf16 v[184:187], v[68:71], v[216:219], v[184:187]
    ds_read_b128 v[236:239], v1 offset:23552
    v_mfma_f32_16x16x32_bf16 v[200:203], v[72:75], v[216:219], v[200:203]
    buffer_load_dwordx4 v[28:31], v1, s[8:11], s55 offen offset:0
    s_waitcnt lgkmcnt(6)
    v_mfma_f32_16x16x32_bf16 v[172:175], v[64:67], v[220:223], v[172:175]
    s_waitcnt lgkmcnt(3)
    v_add_f32 v248, v248, v250
    v_add_f32 v249, v249, v251
    v_mfma_f32_16x16x32_bf16 v[188:191], v[68:71], v[220:223], v[188:191]
    v_add_f32 v252, v252, v254
    v_add_f32 v253, v253, v255
    v_mfma_f32_16x16x32_bf16 v[204:207], v[72:75], v[220:223], v[204:207]
    v_add_f32 v244, v248, v252
    v_add_f32 v245, v249, v253
    v_mfma_f32_16x16x32_bf16 v[160:163], v[76:79], v[224:227], v[160:163]
    ds_read2st64_b64 v[248:251], v14 offset0:4 offset1:5
    v_mfma_f32_16x16x32_bf16 v[176:179], v[80:83], v[224:227], v[176:179]
    ds_read_b128 v[208:211], v1 offset:24576
    v_mfma_f32_16x16x32_bf16 v[192:195], v[84:87], v[224:227], v[192:195]
    ds_read2st64_b64 v[252:255], v14 offset0:6 offset1:7
    s_waitcnt lgkmcnt(5)
    v_mfma_f32_16x16x32_bf16 v[164:167], v[76:79], v[228:231], v[164:167]
    ds_read_b128 v[212:215], v1 offset:25600
    v_mfma_f32_16x16x32_bf16 v[180:183], v[80:83], v[228:231], v[180:183]
    buffer_load_dwordx4 v[32:35], v1, s[8:11], s55 offen offset:1024
    v_mfma_f32_16x16x32_bf16 v[196:199], v[84:87], v[228:231], v[196:199]
    ds_read_b128 v[216:219], v1 offset:26624
    s_waitcnt lgkmcnt(6)
    v_mfma_f32_16x16x32_bf16 v[168:171], v[76:79], v[232:235], v[168:171]
    buffer_load_dwordx4 v[36:39], v1, s[8:11], s55 offen offset:2048
    v_mfma_f32_16x16x32_bf16 v[184:187], v[80:83], v[232:235], v[184:187]
    ds_read_b128 v[220:223], v1 offset:27648
    v_mfma_f32_16x16x32_bf16 v[200:203], v[84:87], v[232:235], v[200:203]
    buffer_load_dwordx4 v[40:43], v1, s[8:11], s56 offen offset:0
    s_waitcnt lgkmcnt(6)
    v_mfma_f32_16x16x32_bf16 v[172:175], v[76:79], v[236:239], v[172:175]
    s_waitcnt lgkmcnt(3)
    v_add_f32 v248, v248, v250
    v_add_f32 v249, v249, v251
    v_mfma_f32_16x16x32_bf16 v[188:191], v[80:83], v[236:239], v[188:191]
    v_add_f32 v252, v252, v254
    v_add_f32 v253, v253, v255
    v_mfma_f32_16x16x32_bf16 v[204:207], v[84:87], v[236:239], v[204:207]
    v_add_f32 v244, v244, v248
    v_add_f32 v245, v245, v249
    v_add_f32 v244, v244, v252
    v_add_f32 v245, v245, v253
    v_mfma_f32_16x16x32_bf16 v[160:163], v[88:91], v[208:211], v[160:163]
    ds_read2st64_b64 v[248:251], v14 offset0:8 offset1:9
    v_mfma_f32_16x16x32_bf16 v[176:179], v[92:95], v[208:211], v[176:179]
    ds_read_b128 v[224:227], v1 offset:28672
    v_mfma_f32_16x16x32_bf16 v[192:195], v[96:99], v[208:211], v[192:195]
    ds_read2st64_b64 v[252:255], v14 offset0:10 offset1:11
    s_waitcnt lgkmcnt(5)
    v_mfma_f32_16x16x32_bf16 v[164:167], v[88:91], v[212:215], v[164:167]
    ds_read_b128 v[228:231], v1 offset:29696
    v_mfma_f32_16x16x32_bf16 v[180:183], v[92:95], v[212:215], v[180:183]
    buffer_load_dwordx4 v[44:47], v1, s[8:11], s56 offen offset:1024
    v_mfma_f32_16x16x32_bf16 v[196:199], v[96:99], v[212:215], v[196:199]
    ds_read_b128 v[232:235], v1 offset:30720
    s_waitcnt lgkmcnt(6)
    v_mfma_f32_16x16x32_bf16 v[168:171], v[88:91], v[216:219], v[168:171]
    buffer_load_dwordx4 v[48:51], v1, s[8:11], s56 offen offset:2048
    v_mfma_f32_16x16x32_bf16 v[184:187], v[92:95], v[216:219], v[184:187]
    ds_read_b128 v[236:239], v1 offset:31744
    v_mfma_f32_16x16x32_bf16 v[200:203], v[96:99], v[216:219], v[200:203]
    buffer_load_dwordx4 v[52:55], v1, s[8:11], s57 offen offset:0
    s_waitcnt lgkmcnt(6)
    v_mfma_f32_16x16x32_bf16 v[172:175], v[88:91], v[220:223], v[172:175]
    s_waitcnt lgkmcnt(3)
    v_add_f32 v248, v248, v250
    v_add_f32 v249, v249, v251
    v_mfma_f32_16x16x32_bf16 v[188:191], v[92:95], v[220:223], v[188:191]
    v_add_f32 v252, v252, v254
    v_add_f32 v253, v253, v255
    v_mfma_f32_16x16x32_bf16 v[204:207], v[96:99], v[220:223], v[204:207]
    v_add_f32 v244, v244, v248
    v_add_f32 v245, v245, v249
    v_add_f32 v244, v244, v252
    v_add_f32 v245, v245, v253
    v_mfma_f32_16x16x32_bf16 v[160:163], v[100:103], v[224:227], v[160:163]
    s_waitcnt vmcnt(17)
    s_barrier
    ds_read2st64_b64 v[248:251], v14 offset0:12 offset1:13
    v_mfma_f32_16x16x32_bf16 v[176:179], v[104:107], v[224:227], v[176:179]
    ds_read_b128 v[208:211], v1 offset:32768
    v_mfma_f32_16x16x32_bf16 v[192:195], v[108:111], v[224:227], v[192:195]
    ds_read2st64_b64 v[252:255], v14 offset0:14 offset1:15
    s_waitcnt lgkmcnt(5)
    v_mfma_f32_16x16x32_bf16 v[164:167], v[100:103], v[228:231], v[164:167]
    ds_read_b128 v[212:215], v1 offset:33792
    v_mfma_f32_16x16x32_bf16 v[180:183], v[104:107], v[228:231], v[180:183]
    buffer_load_dwordx4 v[56:59], v1, s[8:11], s57 offen offset:1024
    v_mfma_f32_16x16x32_bf16 v[196:199], v[108:111], v[228:231], v[196:199]
    ds_read_b128 v[216:219], v1 offset:34816
    s_waitcnt lgkmcnt(6)
    v_mfma_f32_16x16x32_bf16 v[168:171], v[100:103], v[232:235], v[168:171]
    buffer_load_dwordx4 v[60:63], v1, s[8:11], s57 offen offset:2048
    v_mfma_f32_16x16x32_bf16 v[184:187], v[104:107], v[232:235], v[184:187]
    ds_read_b128 v[220:223], v1 offset:35840
    s_add_u32 m0, s40, 65536
    v_mfma_f32_16x16x32_bf16 v[200:203], v[108:111], v[232:235], v[200:203]
    buffer_load_dwordx4 v1, s[8:11], s52 offen offset:0 sc1 lds
    s_waitcnt lgkmcnt(6)
    v_mfma_f32_16x16x32_bf16 v[172:175], v[100:103], v[236:239], v[172:175]
    s_waitcnt lgkmcnt(3)
    v_add_f32 v248, v248, v250
    v_add_f32 v249, v249, v251
    v_mfma_f32_16x16x32_bf16 v[188:191], v[104:107], v[236:239], v[188:191]
    v_add_f32 v252, v252, v254
    v_add_f32 v253, v253, v255
    v_mfma_f32_16x16x32_bf16 v[204:207], v[108:111], v[236:239], v[204:207]
    v_add_f32 v244, v244, v248
    v_add_f32 v245, v245, v249
    v_add_f32 v244, v244, v252
    v_add_f32 v245, v245, v253
    v_mfma_f32_16x16x32_bf16 v[160:163], v[112:115], v[208:211], v[160:163]
    ds_read2st64_b64 v[248:251], v14 offset0:16 offset1:17
    v_mfma_f32_16x16x32_bf16 v[176:179], v[116:119], v[208:211], v[176:179]
    ds_read_b128 v[224:227], v1 offset:36864
    v_mfma_f32_16x16x32_bf16 v[192:195], v[120:123], v[208:211], v[192:195]
    ds_read2st64_b64 v[252:255], v14 offset0:18 offset1:19
    s_waitcnt lgkmcnt(5)
    v_mfma_f32_16x16x32_bf16 v[164:167], v[112:115], v[212:215], v[164:167]
    ds_read_b128 v[228:231], v1 offset:37888
    v_mfma_f32_16x16x32_bf16 v[180:183], v[116:119], v[212:215], v[180:183]
    buffer_load_dwordx4 v1, s[8:11], s52 offen offset:1024 sc1 lds
    v_mfma_f32_16x16x32_bf16 v[196:199], v[120:123], v[212:215], v[196:199]
    ds_read_b128 v[232:235], v1 offset:38912
    s_waitcnt lgkmcnt(6)
    v_mfma_f32_16x16x32_bf16 v[168:171], v[112:115], v[216:219], v[168:171]
    buffer_load_dwordx4 v1, s[8:11], s52 offen offset:2048 sc1 lds
    v_mfma_f32_16x16x32_bf16 v[184:187], v[116:119], v[216:219], v[184:187]
    ds_read_b128 v[236:239], v1 offset:39936
    v_mfma_f32_16x16x32_bf16 v[200:203], v[120:123], v[216:219], v[200:203]
    buffer_load_dwordx4 v1, s[8:11], s52 offen offset:3072 sc1 lds
    s_waitcnt lgkmcnt(6)
    v_mfma_f32_16x16x32_bf16 v[172:175], v[112:115], v[220:223], v[172:175]
    s_waitcnt lgkmcnt(3)
    v_add_f32 v248, v248, v250
    v_add_f32 v249, v249, v251
    v_mfma_f32_16x16x32_bf16 v[188:191], v[116:119], v[220:223], v[188:191]
    v_add_f32 v252, v252, v254
    v_add_f32 v253, v253, v255
    v_mfma_f32_16x16x32_bf16 v[204:207], v[120:123], v[220:223], v[204:207]
    v_add_f32 v244, v244, v248
    v_add_f32 v245, v245, v249
    v_add_f32 v244, v244, v252
    v_add_f32 v245, v245, v253
    v_mfma_f32_16x16x32_bf16 v[160:163], v[124:127], v[224:227], v[160:163]
    v_mul_f32 v244, 0x3acccccd, v244
    v_mfma_f32_16x16x32_bf16 v[176:179], v[128:131], v[224:227], v[176:179]
    ds_read_b128 v[208:211], v1 offset:40960
    v_mul_f32 v245, 0x3acccccd, v245
    v_mfma_f32_16x16x32_bf16 v[192:195], v[132:135], v[224:227], v[192:195]
    v_fma_f32 v245, -v244, v244, v245
    s_waitcnt lgkmcnt(3)
    v_mfma_f32_16x16x32_bf16 v[164:167], v[124:127], v[228:231], v[164:167]
    ds_read_b128 v[212:215], v1 offset:41984
    v_max_f32 v245, 0, v245
    v_mfma_f32_16x16x32_bf16 v[180:183], v[128:131], v[228:231], v[180:183]
    buffer_load_dwordx4 v[64:67], v1, s[8:11], s58 offen offset:0
    v_add_f32 v245, 0x3727c5ac, v245
    v_mfma_f32_16x16x32_bf16 v[196:199], v[132:135], v[228:231], v[196:199]
    ds_read_b128 v[216:219], v1 offset:43008
    v_rsq_f32 v245, v245
    s_waitcnt lgkmcnt(4)
    v_mfma_f32_16x16x32_bf16 v[168:171], v[124:127], v[232:235], v[168:171]
    buffer_load_dwordx4 v[68:71], v1, s[8:11], s58 offen offset:1024
    v_and_b32 v246, 15, v0
    v_mfma_f32_16x16x32_bf16 v[184:187], v[128:131], v[232:235], v[184:187]
    ds_read_b128 v[220:223], v1 offset:44032
    v_lshlrev_b32 v246, 2, v246
    v_mfma_f32_16x16x32_bf16 v[200:203], v[132:135], v[232:235], v[200:203]
    buffer_load_dwordx4 v[72:75], v1, s[8:11], s58 offen offset:2048
    s_lshl_b32 s23, s18, 6
    s_waitcnt lgkmcnt(4)
    v_mfma_f32_16x16x32_bf16 v[172:175], v[124:127], v[236:239], v[172:175]
    v_add_u32 v247, s23, v246
    v_mfma_f32_16x16x32_bf16 v[188:191], v[128:131], v[236:239], v[188:191]
    v_sub_f32 v244, 0, v244
    v_mfma_f32_16x16x32_bf16 v[204:207], v[132:135], v[236:239], v[204:207]
    s_waitcnt lgkmcnt(3)
    v_mfma_f32_16x16x32_bf16 v[160:163], v[136:139], v[208:211], v[160:163]
    ds_bpermute_b32 v248, v246, v244 offset:0
    v_mfma_f32_16x16x32_bf16 v[176:179], v[140:143], v[208:211], v[176:179]
    ds_read_b128 v[224:227], v1 offset:45056
    v_mfma_f32_16x16x32_bf16 v[192:195], v[144:147], v[208:211], v[192:195]
    ds_bpermute_b32 v250, v246, v244 offset:64
    s_waitcnt lgkmcnt(5)
    v_mfma_f32_16x16x32_bf16 v[164:167], v[136:139], v[212:215], v[164:167]
    ds_read_b128 v[228:231], v1 offset:46080
    v_mfma_f32_16x16x32_bf16 v[180:183], v[140:143], v[212:215], v[180:183]
    buffer_load_dwordx4 v[76:79], v1, s[8:11], s59 offen offset:0
    v_mfma_f32_16x16x32_bf16 v[196:199], v[144:147], v[212:215], v[196:199]
    ds_read_b128 v[232:235], v1 offset:47104
    s_waitcnt lgkmcnt(6)
    v_mfma_f32_16x16x32_bf16 v[168:171], v[136:139], v[216:219], v[168:171]
    buffer_load_dwordx4 v[80:83], v1, s[8:11], s59 offen offset:1024
    v_mfma_f32_16x16x32_bf16 v[184:187], v[140:143], v[216:219], v[184:187]
    ds_read_b128 v[236:239], v1 offset:48128
    v_mfma_f32_16x16x32_bf16 v[200:203], v[144:147], v[216:219], v[200:203]
    buffer_load_dwordx4 v[84:87], v1, s[8:11], s59 offen offset:2048
    s_waitcnt lgkmcnt(6)
    v_mfma_f32_16x16x32_bf16 v[172:175], v[136:139], v[220:223], v[172:175]
    ds_bpermute_b32 v252, v246, v244 offset:128
    v_mfma_f32_16x16x32_bf16 v[188:191], v[140:143], v[220:223], v[188:191]
    ds_bpermute_b32 v254, v246, v244 offset:192
    v_mfma_f32_16x16x32_bf16 v[204:207], v[144:147], v[220:223], v[204:207]
    ds_bpermute_b32 v7, v247, v245
    s_waitcnt vmcnt(26)
    s_waitcnt lgkmcnt(7)
    v_mfma_f32_16x16x32_bf16 v[160:163], v[148:151], v[224:227], v[160:163]
    s_waitcnt vmcnt(22)
    s_barrier
    v_mfma_f32_16x16x32_bf16 v[176:179], v[152:155], v[224:227], v[176:179]
    ds_read_b128 v[208:211], v1 offset:49152
    v_mfma_f32_16x16x32_bf16 v[192:195], v[156:159], v[224:227], v[192:195]
    s_waitcnt lgkmcnt(6)
    v_mfma_f32_16x16x32_bf16 v[164:167], v[148:151], v[228:231], v[164:167]
    ds_read_b128 v[212:215], v1 offset:50176
    buffer_load_dwordx4 v[88:91], v1, s[8:11], s60 offen offset:0
    v_mfma_f32_16x16x32_bf16 v[180:183], v[152:155], v[228:231], v[180:183]
    v_mfma_f32_16x16x32_bf16 v[196:199], v[156:159], v[228:231], v[196:199]
    ds_read_b128 v[216:219], v1 offset:51200
    buffer_load_dwordx4 v[92:95], v1, s[8:11], s60 offen offset:1024
    s_waitcnt lgkmcnt(7)
    v_mfma_f32_16x16x32_bf16 v[168:171], v[148:151], v[232:235], v[168:171]
    v_mfma_f32_16x16x32_bf16 v[184:187], v[152:155], v[232:235], v[184:187]
    ds_read_b128 v[220:223], v1 offset:52224
    buffer_load_dwordx4 v[96:99], v1, s[8:11], s60 offen offset:2048
    v_mfma_f32_16x16x32_bf16 v[200:203], v[156:159], v[232:235], v[200:203]
    s_waitcnt lgkmcnt(7)
    v_mfma_f32_16x16x32_bf16 v[172:175], v[148:151], v[236:239], v[172:175]
    buffer_load_dwordx4 v[100:103], v1, s[8:11], s61 offen offset:0
    v_mfma_f32_16x16x32_bf16 v[188:191], v[152:155], v[236:239], v[188:191]
    v_mfma_f32_16x16x32_bf16 v[204:207], v[156:159], v[236:239], v[204:207]
    v_mfma_f32_16x16x32_bf16 a[240:243], v[148:151], v[240:243], a[240:243]
    v_mfma_f32_16x16x32_bf16 a[244:247], v[152:155], v[240:243], a[244:247]
    v_mfma_f32_16x16x32_bf16 a[248:251], v[156:159], v[240:243], a[248:251]
    s_waitcnt vmcnt(23)
    s_waitcnt lgkmcnt(3)
    v_mfma_f32_16x16x32_bf16 v[160:163], v[16:19], v[208:211], v[160:163]
    v_mfma_f32_16x16x32_bf16 v[176:179], v[20:23], v[208:211], v[176:179]
    ds_read_b128 v[224:227], v1 offset:53248
    v_mfma_f32_16x16x32_bf16 v[192:195], v[24:27], v[208:211], v[192:195]
    s_waitcnt lgkmcnt(3)
    v_mfma_f32_16x16x32_bf16 v[164:167], v[16:19], v[212:215], v[164:167]
    ds_read_b128 v[228:231], v1 offset:54272
    buffer_load_dwordx4 v[104:107], v1, s[8:11], s61 offen offset:1024
    v_mfma_f32_16x16x32_bf16 v[180:183], v[20:23], v[212:215], v[180:183]
    v_mfma_f32_16x16x32_bf16 v[196:199], v[24:27], v[212:215], v[196:199]
    ds_read_b128 v[232:235], v1 offset:55296
    buffer_load_dwordx4 v[108:111], v1, s[8:11], s61 offen offset:2048
    s_waitcnt lgkmcnt(4)
    v_mfma_f32_16x16x32_bf16 v[168:171], v[16:19], v[216:219], v[168:171]
    s_mul_i32 s23, s17, 6
    v_mfma_f32_16x16x32_bf16 v[184:187], v[20:23], v[216:219], v[184:187]
    ds_read_b128 v[236:239], v1 offset:56320
    buffer_load_dwordx4 a[40:43], v1, s[8:11], s31 offen offset:0
    v_mfma_f32_16x16x32_bf16 v[200:203], v[24:27], v[216:219], v[200:203]
    s_add_u32 s41, s23, s18
    s_waitcnt lgkmcnt(4)
    v_mfma_f32_16x16x32_bf16 v[172:175], v[16:19], v[220:223], v[172:175]
    buffer_load_dwordx4 a[44:47], v1, s[8:11], s31 offen offset:1024
    v_mfma_f32_16x16x32_bf16 v[188:191], v[20:23], v[220:223], v[188:191]
    s_lshl_b32 s41, s41, 12
    v_mfma_f32_16x16x32_bf16 v[204:207], v[24:27], v[220:223], v[204:207]
    s_add_u32 s41, s41, s28
    v_mfma_f32_16x16x32_bf16 a[240:243], v[16:19], v[240:243], a[240:243]
    v_mfma_f32_16x16x32_bf16 a[244:247], v[20:23], v[240:243], a[244:247]
    v_mfma_f32_16x16x32_bf16 a[248:251], v[24:27], v[240:243], a[248:251]
    s_waitcnt vmcnt(24)
    s_waitcnt lgkmcnt(3)
    v_mfma_f32_16x16x32_bf16 v[160:163], v[28:31], v[224:227], v[160:163]
    s_add_u32 s41, s41, 14942208
    v_mfma_f32_16x16x32_bf16 v[176:179], v[32:35], v[224:227], v[176:179]
    ds_read_b128 v[208:211], v1 offset:57344
    s_lshr_b32 s42, s18, 1
    v_mfma_f32_16x16x32_bf16 v[192:195], v[36:39], v[224:227], v[192:195]
    s_add_u32 s42, s42, s23
    s_waitcnt lgkmcnt(3)
    v_mfma_f32_16x16x32_bf16 v[164:167], v[28:31], v[228:231], v[164:167]
    ds_read_b128 v[212:215], v1 offset:58368
    buffer_load_dwordx4 a[48:51], v1, s[8:11], s31 offen offset:2048
    v_mfma_f32_16x16x32_bf16 v[180:183], v[32:35], v[228:231], v[180:183]
    s_add_u32 s42, s42, 4
    v_mfma_f32_16x16x32_bf16 v[196:199], v[36:39], v[228:231], v[196:199]
    ds_read_b128 v[216:219], v1 offset:59392
    buffer_load_dwordx4 a[52:55], v1, s[8:11], s31 offen offset:3072
    s_waitcnt lgkmcnt(4)
    v_mfma_f32_16x16x32_bf16 v[168:171], v[28:31], v[232:235], v[168:171]
    s_lshl_b32 s42, s42, 12
    v_mfma_f32_16x16x32_bf16 v[184:187], v[32:35], v[232:235], v[184:187]
    ds_read_b128 v[220:223], v1 offset:60416
    buffer_load_dwordx4 a[56:59], v10, s[8:11], s31 offen offset:0
    v_mfma_f32_16x16x32_bf16 v[200:203], v[36:39], v[232:235], v[200:203]
    s_add_u32 s42, s42, s28
    s_waitcnt lgkmcnt(4)
    v_mfma_f32_16x16x32_bf16 v[172:175], v[28:31], v[236:239], v[172:175]
    buffer_load_dwordx4 a[60:63], v1, s[8:11], s32 offen offset:0
    v_mfma_f32_16x16x32_bf16 v[188:191], v[32:35], v[236:239], v[188:191]
    s_add_u32 s42, s42, 14942208
    v_mfma_f32_16x16x32_bf16 v[204:207], v[36:39], v[236:239], v[204:207]
    s_mul_i32 s43, s18, 49152
    v_mfma_f32_16x16x32_bf16 a[240:243], v[28:31], v[240:243], a[240:243]
    v_mfma_f32_16x16x32_bf16 a[244:247], v[32:35], v[240:243], a[244:247]
    v_mfma_f32_16x16x32_bf16 a[248:251], v[36:39], v[240:243], a[248:251]
    s_waitcnt vmcnt(25)
    s_waitcnt lgkmcnt(3)
    v_mfma_f32_16x16x32_bf16 v[160:163], v[40:43], v[208:211], v[160:163]
    s_add_u32 s43, s43, s28
    v_mfma_f32_16x16x32_bf16 v[176:179], v[44:47], v[208:211], v[176:179]
    ds_read_b128 v[224:227], v1 offset:61440
    s_add_u32 s43, s43, 14942208
    v_mfma_f32_16x16x32_bf16 v[192:195], v[48:51], v[208:211], v[192:195]
    s_lshl_b32 s47, s30, 12
    s_waitcnt lgkmcnt(3)
    v_mfma_f32_16x16x32_bf16 v[164:167], v[40:43], v[212:215], v[164:167]
    ds_read_b128 v[228:231], v1 offset:62464
    buffer_load_dwordx4 a[64:67], v1, s[8:11], s32 offen offset:1024
    v_mfma_f32_16x16x32_bf16 v[180:183], v[44:47], v[212:215], v[180:183]
    s_add_u32 s52, s47, s43
    v_mfma_f32_16x16x32_bf16 v[196:199], v[48:51], v[212:215], v[196:199]
    ds_read_b128 v[232:235], v1 offset:63488
    buffer_load_dwordx4 a[68:71], v1, s[8:11], s32 offen offset:2048
    s_waitcnt lgkmcnt(4)
    v_mfma_f32_16x16x32_bf16 v[168:171], v[40:43], v[216:219], v[168:171]
    s_add_u32 s43, s43, 49152
    v_mfma_f32_16x16x32_bf16 v[184:187], v[44:47], v[216:219], v[184:187]
    ds_read_b128 v[236:239], v1 offset:64512
    buffer_load_dwordx4 a[72:75], v1, s[8:11], s32 offen offset:3072
    v_mfma_f32_16x16x32_bf16 v[200:203], v[48:51], v[216:219], v[200:203]
    s_add_u32 s53, s52, 4096
    s_waitcnt lgkmcnt(4)
    v_mfma_f32_16x16x32_bf16 v[172:175], v[40:43], v[220:223], v[172:175]
    buffer_load_dwordx4 a[76:79], v10, s[8:11], s32 offen offset:0
    v_mfma_f32_16x16x32_bf16 v[188:191], v[44:47], v[220:223], v[188:191]
    s_cmp_ge_u32 s53, s43
    s_cselect_b32 s38, 49152, 0
    v_mfma_f32_16x16x32_bf16 v[204:207], v[48:51], v[220:223], v[204:207]
    s_sub_u32 s53, s53, s38
    v_mfma_f32_16x16x32_bf16 a[240:243], v[40:43], v[240:243], a[240:243]
    v_mfma_f32_16x16x32_bf16 a[244:247], v[44:47], v[240:243], a[244:247]
    v_mfma_f32_16x16x32_bf16 a[248:251], v[48:51], v[240:243], a[248:251]
    s_waitcnt vmcnt(26)
    s_waitcnt lgkmcnt(3)
    v_mfma_f32_16x16x32_bf16 v[160:163], v[52:55], v[224:227], v[160:163]
    s_waitcnt vmcnt(22)
    s_barrier
    s_add_u32 s54, s53, 4096
    v_mfma_f32_16x16x32_bf16 v[176:179], v[56:59], v[224:227], v[176:179]
    ds_read_b128 v[208:211], v15 offset:0
    s_cmp_ge_u32 s54, s43
    s_cselect_b32 s38, 49152, 0
    v_mfma_f32_16x16x32_bf16 v[192:195], v[60:63], v[224:227], v[192:195]
    s_sub_u32 s54, s54, s38
    s_waitcnt lgkmcnt(3)
    v_mfma_f32_16x16x32_bf16 v[164:167], v[52:55], v[228:231], v[164:167]
    ds_read_b128 v[212:215], v15 offset:1024
    buffer_load_dwordx4 a[80:83], v1, s[8:11], s33 offen offset:0
    v_mfma_f32_16x16x32_bf16 v[180:183], v[56:59], v[228:231], v[180:183]
    s_add_u32 s55, s54, 4096
    v_mfma_f32_16x16x32_bf16 v[196:199], v[60:63], v[228:231], v[196:199]
    ds_read_b128 v[216:219], v15 offset:2048
    buffer_load_dwordx4 a[84:87], v1, s[8:11], s33 offen offset:1024
    s_waitcnt lgkmcnt(4)
    v_mfma_f32_16x16x32_bf16 v[168:171], v[52:55], v[232:235], v[168:171]
    s_cmp_ge_u32 s55, s43
    s_cselect_b32 s38, 49152, 0
    v_mfma_f32_16x16x32_bf16 v[184:187], v[56:59], v[232:235], v[184:187]
    ds_read_b128 v[220:223], v15 offset:3072
    buffer_load_dwordx4 a[88:91], v1, s[8:11], s33 offen offset:2048
    v_mfma_f32_16x16x32_bf16 v[200:203], v[60:63], v[232:235], v[200:203]
    s_sub_u32 s55, s55, s38
    s_waitcnt lgkmcnt(4)
    v_mfma_f32_16x16x32_bf16 v[172:175], v[52:55], v[236:239], v[172:175]
    buffer_load_dwordx4 a[92:95], v1, s[8:11], s33 offen offset:3072
    v_mfma_f32_16x16x32_bf16 v[188:191], v[56:59], v[236:239], v[188:191]
    s_add_u32 s56, s55, 4096
    v_mfma_f32_16x16x32_bf16 v[204:207], v[60:63], v[236:239], v[204:207]
    s_cmp_ge_u32 s56, s43
    s_cselect_b32 s38, 49152, 0
    v_mfma_f32_16x16x32_bf16 a[240:243], v[52:55], v[240:243], a[240:243]
    v_mfma_f32_16x16x32_bf16 a[244:247], v[56:59], v[240:243], a[244:247]
    v_mfma_f32_16x16x32_bf16 a[248:251], v[60:63], v[240:243], a[248:251]
    s_waitcnt vmcnt(23)
    s_waitcnt lgkmcnt(3)
    v_mfma_f32_16x16x32_bf16 v[160:163], v[64:67], v[208:211], v[160:163]
    s_sub_u32 s56, s56, s38
    v_mfma_f32_16x16x32_bf16 v[176:179], v[68:71], v[208:211], v[176:179]
    ds_read_b128 v[224:227], v15 offset:4096
    s_add_u32 s57, s56, 4096
    v_mfma_f32_16x16x32_bf16 v[192:195], v[72:75], v[208:211], v[192:195]
    s_cmp_ge_u32 s57, s43
    s_cselect_b32 s38, 49152, 0
    s_waitcnt lgkmcnt(3)
    v_mfma_f32_16x16x32_bf16 v[164:167], v[64:67], v[212:215], v[164:167]
    ds_read_b128 v[228:231], v15 offset:5120
    buffer_load_dwordx4 a[96:99], v10, s[8:11], s33 offen offset:0
    v_mfma_f32_16x16x32_bf16 v[180:183], v[68:71], v[212:215], v[180:183]
    s_sub_u32 s57, s57, s38
    v_mfma_f32_16x16x32_bf16 v[196:199], v[72:75], v[212:215], v[196:199]
    ds_read_b128 v[232:235], v15 offset:6144
    buffer_load_dwordx4 a[100:103], v1, s[8:11], s34 offen offset:0
    s_waitcnt lgkmcnt(4)
    v_mfma_f32_16x16x32_bf16 v[168:171], v[64:67], v[216:219], v[168:171]
    s_add_u32 s58, s57, 4096
    v_mfma_f32_16x16x32_bf16 v[184:187], v[68:71], v[216:219], v[184:187]
    ds_read_b128 v[236:239], v15 offset:7168
    buffer_load_dwordx4 a[104:107], v1, s[8:11], s34 offen offset:1024
    v_mfma_f32_16x16x32_bf16 v[200:203], v[72:75], v[216:219], v[200:203]
    s_cmp_ge_u32 s58, s43
    s_cselect_b32 s38, 49152, 0
    s_waitcnt lgkmcnt(4)
    v_mfma_f32_16x16x32_bf16 v[172:175], v[64:67], v[220:223], v[172:175]
    buffer_load_dwordx4 a[108:111], v1, s[8:11], s34 offen offset:2048
    v_mfma_f32_16x16x32_bf16 v[188:191], v[68:71], v[220:223], v[188:191]
    s_sub_u32 s58, s58, s38
    v_mfma_f32_16x16x32_bf16 v[204:207], v[72:75], v[220:223], v[204:207]
    s_add_u32 s59, s58, 4096
    v_mfma_f32_16x16x32_bf16 a[240:243], v[64:67], v[240:243], a[240:243]
    v_mfma_f32_16x16x32_bf16 a[244:247], v[68:71], v[240:243], a[244:247]
    v_mfma_f32_16x16x32_bf16 a[248:251], v[72:75], v[240:243], a[248:251]
    s_waitcnt vmcnt(24)
    s_waitcnt lgkmcnt(3)
    v_mfma_f32_16x16x32_bf16 v[160:163], v[76:79], v[224:227], v[160:163]
    s_cmp_ge_u32 s59, s43
    s_cselect_b32 s38, 49152, 0
    v_mfma_f32_16x16x32_bf16 v[176:179], v[80:83], v[224:227], v[176:179]
    ds_read_b128 v[208:211], v15 offset:8192
    s_sub_u32 s59, s59, s38
    v_mfma_f32_16x16x32_bf16 v[192:195], v[84:87], v[224:227], v[192:195]
    s_add_u32 s60, s59, 4096
    s_waitcnt lgkmcnt(3)
    v_mfma_f32_16x16x32_bf16 v[164:167], v[76:79], v[228:231], v[164:167]
    ds_read_b128 v[212:215], v15 offset:9216
    buffer_load_dwordx4 a[112:115], v1, s[8:11], s34 offen offset:3072
    v_mfma_f32_16x16x32_bf16 v[180:183], v[80:83], v[228:231], v[180:183]
    s_cmp_ge_u32 s60, s43
    s_cselect_b32 s38, 49152, 0
    v_mfma_f32_16x16x32_bf16 v[196:199], v[84:87], v[228:231], v[196:199]
    ds_read_b128 v[216:219], v15 offset:10240
    buffer_load_dwordx4 a[116:119], v10, s[8:11], s34 offen offset:0
    s_waitcnt lgkmcnt(4)
    v_mfma_f32_16x16x32_bf16 v[168:171], v[76:79], v[232:235], v[168:171]
    s_sub_u32 s60, s60, s38
    v_mfma_f32_16x16x32_bf16 v[184:187], v[80:83], v[232:235], v[184:187]
    ds_read_b128 v[220:223], v15 offset:11264
    buffer_load_dwordx4 a[120:123], v1, s[8:11], s35 offen offset:0
    v_mfma_f32_16x16x32_bf16 v[200:203], v[84:87], v[232:235], v[200:203]
    s_add_u32 s61, s60, 4096
    s_waitcnt lgkmcnt(4)
    v_mfma_f32_16x16x32_bf16 v[172:175], v[76:79], v[236:239], v[172:175]
    buffer_load_dwordx4 a[124:127], v1, s[8:11], s35 offen offset:1024
    v_mfma_f32_16x16x32_bf16 v[188:191], v[80:83], v[236:239], v[188:191]
    s_cmp_ge_u32 s61, s43
    s_cselect_b32 s38, 49152, 0
    v_mfma_f32_16x16x32_bf16 v[204:207], v[84:87], v[236:239], v[204:207]
    s_sub_u32 s61, s61, s38
    v_mfma_f32_16x16x32_bf16 a[240:243], v[76:79], v[240:243], a[240:243]
    v_mfma_f32_16x16x32_bf16 a[244:247], v[80:83], v[240:243], a[244:247]
    v_mfma_f32_16x16x32_bf16 a[248:251], v[84:87], v[240:243], a[248:251]
    s_waitcnt vmcnt(25)
    s_waitcnt lgkmcnt(3)
    v_mfma_f32_16x16x32_bf16 v[160:163], v[88:91], v[208:211], v[160:163]
    s_add_u32 s62, s61, 4096
    v_mfma_f32_16x16x32_bf16 v[176:179], v[92:95], v[208:211], v[176:179]
    ds_read_b128 v[224:227], v15 offset:12288
    s_cmp_ge_u32 s62, s43
    s_cselect_b32 s38, 49152, 0
    v_mfma_f32_16x16x32_bf16 v[192:195], v[96:99], v[208:211], v[192:195]
    s_sub_u32 s62, s62, s38
    s_waitcnt lgkmcnt(3)
    v_mfma_f32_16x16x32_bf16 v[164:167], v[88:91], v[212:215], v[164:167]
    ds_read_b128 v[228:231], v15 offset:13312
    buffer_load_dwordx4 a[128:131], v1, s[8:11], s35 offen offset:2048
    v_mfma_f32_16x16x32_bf16 v[180:183], v[92:95], v[212:215], v[180:183]
    s_add_u32 s63, s62, 4096
    v_mfma_f32_16x16x32_bf16 v[196:199], v[96:99], v[212:215], v[196:199]
    ds_read_b128 v[232:235], v15 offset:14336
    buffer_load_dwordx4 a[132:135], v1, s[8:11], s35 offen offset:3072
    s_waitcnt lgkmcnt(4)
    v_mfma_f32_16x16x32_bf16 v[168:171], v[88:91], v[216:219], v[168:171]
    s_cmp_ge_u32 s63, s43
    s_cselect_b32 s38, 49152, 0
    v_mfma_f32_16x16x32_bf16 v[184:187], v[92:95], v[216:219], v[184:187]
    ds_read_b128 v[236:239], v15 offset:15360
    buffer_load_dwordx4 a[136:139], v10, s[8:11], s35 offen offset:0
    v_mfma_f32_16x16x32_bf16 v[200:203], v[96:99], v[216:219], v[200:203]
    s_sub_u32 s63, s63, s38
    s_waitcnt lgkmcnt(4)
    v_mfma_f32_16x16x32_bf16 v[172:175], v[88:91], v[220:223], v[172:175]
    buffer_load_dwordx4 a[140:143], v1, s[8:11], s36 offen offset:0
    v_mfma_f32_16x16x32_bf16 v[188:191], v[92:95], v[220:223], v[188:191]
    s_add_u32 s48, s18, 1
    v_mfma_f32_16x16x32_bf16 v[204:207], v[96:99], v[220:223], v[204:207]
    s_and_b32 s48, s48, 3
    v_mfma_f32_16x16x32_bf16 a[240:243], v[88:91], v[240:243], a[240:243]
    v_mfma_f32_16x16x32_bf16 a[244:247], v[92:95], v[240:243], a[244:247]
    v_mfma_f32_16x16x32_bf16 a[248:251], v[96:99], v[240:243], a[248:251]
    s_waitcnt vmcnt(26)
    s_waitcnt lgkmcnt(3)
    v_mfma_f32_16x16x32_bf16 v[160:163], v[100:103], v[224:227], v[160:163]
    s_lshl_b32 s48, s48, 10
    v_mfma_f32_16x16x32_bf16 v[176:179], v[104:107], v[224:227], v[176:179]
    s_add_u32 s49, s18, 2
    v_mfma_f32_16x16x32_bf16 v[192:195], v[108:111], v[224:227], v[192:195]
    s_and_b32 s49, s49, 3
    s_waitcnt lgkmcnt(2)
    v_mfma_f32_16x16x32_bf16 v[164:167], v[100:103], v[228:231], v[164:167]
    buffer_load_dwordx4 a[144:147], v1, s[8:11], s36 offen offset:1024
    v_mfma_f32_16x16x32_bf16 v[180:183], v[104:107], v[228:231], v[180:183]
    s_lshl_b32 s49, s49, 10
    v_mfma_f32_16x16x32_bf16 v[196:199], v[108:111], v[228:231], v[196:199]
    buffer_load_dwordx4 a[148:151], v1, s[8:11], s36 offen offset:2048
    s_waitcnt lgkmcnt(1)
    v_mfma_f32_16x16x32_bf16 v[168:171], v[100:103], v[232:235], v[168:171]
    s_add_u32 s50, s18, 3
    v_mfma_f32_16x16x32_bf16 v[184:187], v[104:107], v[232:235], v[184:187]
    buffer_load_dwordx4 a[152:155], v1, s[8:11], s36 offen offset:3072
    v_mfma_f32_16x16x32_bf16 v[200:203], v[108:111], v[232:235], v[200:203]
    s_and_b32 s50, s50, 3
    s_waitcnt lgkmcnt(0)
    v_mfma_f32_16x16x32_bf16 v[172:175], v[100:103], v[236:239], v[172:175]
    buffer_load_dwordx4 a[156:159], v10, s[8:11], s36 offen offset:0
    v_mfma_f32_16x16x32_bf16 v[188:191], v[104:107], v[236:239], v[188:191]
    s_lshl_b32 s50, s50, 10
    v_mfma_f32_16x16x32_bf16 v[204:207], v[108:111], v[236:239], v[204:207]
    s_add_u32 s51, s18, 4
    v_mfma_f32_16x16x32_bf16 a[240:243], v[100:103], v[240:243], a[240:243]
    v_mfma_f32_16x16x32_bf16 a[244:247], v[104:107], v[240:243], a[244:247]
    v_mfma_f32_16x16x32_bf16 a[248:251], v[108:111], v[240:243], a[248:251]
    s_and_b32 s51, s51, 3
    s_lshl_b32 s51, s51, 10
    s_nop 5
    v_accvgpr_read_b32 v128, a240
    v_accvgpr_read_b32 v129, a241
    v_accvgpr_read_b32 v130, a242
    v_accvgpr_read_b32 v131, a243
    v_accvgpr_read_b32 v132, a244
    v_accvgpr_read_b32 v133, a245
    v_accvgpr_read_b32 v134, a246
    v_accvgpr_read_b32 v135, a247
    v_accvgpr_read_b32 v136, a248
    v_accvgpr_read_b32 v137, a249
    v_accvgpr_read_b32 v138, a250
    v_accvgpr_read_b32 v139, a251
    s_waitcnt lgkmcnt(0)
    v_pk_fma_f32 v[160:161], v[128:129], v[248:249], v[160:161] op_sel_hi:[1,0,1]
    v_pk_fma_f32 v[162:163], v[130:131], v[248:249], v[162:163] op_sel_hi:[1,0,1]
    v_pk_fma_f32 v[176:177], v[132:133], v[248:249], v[176:177] op_sel_hi:[1,0,1]
    v_pk_fma_f32 v[178:179], v[134:135], v[248:249], v[178:179] op_sel_hi:[1,0,1]
    v_pk_fma_f32 v[192:193], v[136:137], v[248:249], v[192:193] op_sel_hi:[1,0,1]
    v_pk_fma_f32 v[194:195], v[138:139], v[248:249], v[194:195] op_sel_hi:[1,0,1]
    v_cvt_pk_bf16_f32 v16, v160, v161
    v_cvt_pk_bf16_f32 v17, v162, v163
    v_cvt_pk_bf16_f32 v18, v176, v177
    v_cvt_pk_bf16_f32 v19, v178, v179
    v_cvt_pk_bf16_f32 v32, v192, v193
    v_cvt_pk_bf16_f32 v33, v194, v195
    v_pk_max_i16 v16, v16, 0
    v_pk_max_i16 v17, v17, 0
    v_pk_max_i16 v18, v18, 0
    v_pk_max_i16 v19, v19, 0
    v_pk_max_i16 v32, v32, 0
    v_pk_max_i16 v33, v33, 0
    buffer_store_dwordx4 v[16:19], v1, s[8:11], s41 offen offset:0
    v_pk_fma_f32 v[164:165], v[128:129], v[250:251], v[164:165] op_sel_hi:[1,0,1]
    v_pk_fma_f32 v[166:167], v[130:131], v[250:251], v[166:167] op_sel_hi:[1,0,1]
    v_pk_fma_f32 v[180:181], v[132:133], v[250:251], v[180:181] op_sel_hi:[1,0,1]
    v_pk_fma_f32 v[182:183], v[134:135], v[250:251], v[182:183] op_sel_hi:[1,0,1]
    v_pk_fma_f32 v[196:197], v[136:137], v[250:251], v[196:197] op_sel_hi:[1,0,1]
    v_pk_fma_f32 v[198:199], v[138:139], v[250:251], v[198:199] op_sel_hi:[1,0,1]
    v_cvt_pk_bf16_f32 v20, v164, v165
    v_cvt_pk_bf16_f32 v21, v166, v167
    v_cvt_pk_bf16_f32 v22, v180, v181
    v_cvt_pk_bf16_f32 v23, v182, v183
    v_cvt_pk_bf16_f32 v34, v196, v197
    v_cvt_pk_bf16_f32 v35, v198, v199
    v_pk_max_i16 v20, v20, 0
    v_pk_max_i16 v21, v21, 0
    v_pk_max_i16 v22, v22, 0
    v_pk_max_i16 v23, v23, 0
    v_pk_max_i16 v34, v34, 0
    v_pk_max_i16 v35, v35, 0
    buffer_store_dwordx4 v[20:23], v1, s[8:11], s41 offen offset:1024
    s_nop 0
    v_permlane32_swap_b32 v32, v34
    v_permlane32_swap_b32 v33, v35
    buffer_store_dwordx4 v[32:35], v6, s[8:11], s42 offen offset:0
    v_pk_fma_f32 v[168:169], v[128:129], v[252:253], v[168:169] op_sel_hi:[1,0,1]
    v_pk_fma_f32 v[170:171], v[130:131], v[252:253], v[170:171] op_sel_hi:[1,0,1]
    v_pk_fma_f32 v[184:185], v[132:133], v[252:253], v[184:185] op_sel_hi:[1,0,1]
    v_pk_fma_f32 v[186:187], v[134:135], v[252:253], v[186:187] op_sel_hi:[1,0,1]
    v_pk_fma_f32 v[200:201], v[136:137], v[252:253], v[200:201] op_sel_hi:[1,0,1]
    v_pk_fma_f32 v[202:203], v[138:139], v[252:253], v[202:203] op_sel_hi:[1,0,1]
    v_cvt_pk_bf16_f32 v24, v168, v169
    v_cvt_pk_bf16_f32 v25, v170, v171
    v_cvt_pk_bf16_f32 v26, v184, v185
    v_cvt_pk_bf16_f32 v27, v186, v187
    v_cvt_pk_bf16_f32 v36, v200, v201
    v_cvt_pk_bf16_f32 v37, v202, v203
    v_pk_max_i16 v24, v24, 0
    v_pk_max_i16 v25, v25, 0
    v_pk_max_i16 v26, v26, 0
    v_pk_max_i16 v27, v27, 0
    v_pk_max_i16 v36, v36, 0
    v_pk_max_i16 v37, v37, 0
    buffer_store_dwordx4 v[24:27], v1, s[8:11], s41 offen offset:2048
    v_pk_fma_f32 v[172:173], v[128:129], v[254:255], v[172:173] op_sel_hi:[1,0,1]
    v_pk_fma_f32 v[174:175], v[130:131], v[254:255], v[174:175] op_sel_hi:[1,0,1]
    v_pk_fma_f32 v[188:189], v[132:133], v[254:255], v[188:189] op_sel_hi:[1,0,1]
    v_pk_fma_f32 v[190:191], v[134:135], v[254:255], v[190:191] op_sel_hi:[1,0,1]
    v_pk_fma_f32 v[204:205], v[136:137], v[254:255], v[204:205] op_sel_hi:[1,0,1]
    v_pk_fma_f32 v[206:207], v[138:139], v[254:255], v[206:207] op_sel_hi:[1,0,1]
    v_cvt_pk_bf16_f32 v28, v172, v173
    v_cvt_pk_bf16_f32 v29, v174, v175
    v_cvt_pk_bf16_f32 v30, v188, v189
    v_cvt_pk_bf16_f32 v31, v190, v191
    v_cvt_pk_bf16_f32 v38, v204, v205
    v_cvt_pk_bf16_f32 v39, v206, v207
    v_pk_max_i16 v28, v28, 0
    v_pk_max_i16 v29, v29, 0
    v_pk_max_i16 v30, v30, 0
    v_pk_max_i16 v31, v31, 0
    v_pk_max_i16 v38, v38, 0
    v_pk_max_i16 v39, v39, 0
    buffer_store_dwordx4 v[28:31], v1, s[8:11], s41 offen offset:3072
    s_nop 0
    v_permlane32_swap_b32 v36, v38
    v_permlane32_swap_b32 v37, v39
    buffer_store_dwordx4 v[36:39], v6, s[8:11], s42 offen offset:2048
    v_add_u32 v248, s48, v1
    v_add_u32 v249, s49, v1
    v_add_u32 v250, s50, v1
    v_add_u32 v251, s51, v1
    s_cmp_lg_u32 s27, 0
    s_cbranch_scc1 k2_hs22
k2_hs22b:
    s_cmp_eq_u32 s18, 3
    s_cbranch_scc1 k2_w2s33
    s_add_u32 s23, s30, 8
    s_cmp_ge_u32 s23, 12
    s_cselect_b32 s38, 12, 0
    s_sub_u32 s23, s23, s38
    s_mul_i32 s23, s23, 5120
    s_add_u32 s23, s23, s44
    s_add_u32 s38, s23, 4096
    buffer_load_dwordx4 a[160:163], v1, s[8:11], s23 offen offset:0
    buffer_load_dwordx4 a[164:167], v1, s[8:11], s23 offen offset:1024
    buffer_load_dwordx4 a[168:171], v1, s[8:11], s23 offen offset:2048
    buffer_load_dwordx4 a[172:175], v1, s[8:11], s23 offen offset:3072
    buffer_load_dwordx4 a[176:179], v1, s[8:11], s38 offen offset:0
    s_add_u32 s23, s30, 9
    s_cmp_ge_u32 s23, 12
    s_cselect_b32 s38, 12, 0
    s_sub_u32 s23, s23, s38
    s_mul_i32 s23, s23, 5120
    s_add_u32 s23, s23, s44
    s_add_u32 s38, s23, 4096
    buffer_load_dwordx4 a[180:183], v1, s[8:11], s23 offen offset:0
    buffer_load_dwordx4 a[184:187], v1, s[8:11], s23 offen offset:1024
    buffer_load_dwordx4 a[188:191], v1, s[8:11], s23 offen offset:2048
    buffer_load_dwordx4 a[192:195], v1, s[8:11], s23 offen offset:3072
    buffer_load_dwordx4 a[196:199], v1, s[8:11], s38 offen offset:0
    s_add_u32 s23, s30, 10
    s_cmp_ge_u32 s23, 12
    s_cselect_b32 s38, 12, 0
    s_sub_u32 s23, s23, s38
    s_mul_i32 s23, s23, 5120
    s_add_u32 s23, s23, s44
    s_add_u32 s38, s23, 4096
    buffer_load_dwordx4 a[200:203], v1, s[8:11], s23 offen offset:0
    buffer_load_dwordx4 a[204:207], v1, s[8:11], s23 offen offset:1024
    buffer_load_dwordx4 a[208:211], v1, s[8:11], s23 offen offset:2048
    buffer_load_dwordx4 a[212:215], v1, s[8:11], s23 offen offset:3072
    buffer_load_dwordx4 a[216:219], v1, s[8:11], s38 offen offset:0
    s_add_u32 s23, s30, 11
    s_cmp_ge_u32 s23, 12
    s_cselect_b32 s38, 12, 0
    s_sub_u32 s23, s23, s38
    s_mul_i32 s23, s23, 5120
    s_add_u32 s23, s23, s44
    s_add_u32 s38, s23, 4096
    buffer_load_dwordx4 a[220:223], v1, s[8:11], s23 offen offset:0
    buffer_load_dwordx4 a[224:227], v1, s[8:11], s23 offen offset:1024
    buffer_load_dwordx4 a[228:231], v1, s[8:11], s23 offen offset:2048
    buffer_load_dwordx4 a[232:235], v1, s[8:11], s23 offen offset:3072
    buffer_load_dwordx4 a[236:239], v1, s[8:11], s38 offen offset:0
    s_branch k2_w2s33x
k2_w2s33:
    s_mov_b32 s38, 0
    s_add_u32 s23, s46, 2
k2_poll34:
    buffer_load_dwordx3 v[252:254], v13, s[8:11], 0 offen sc1
    s_add_u32 s38, s38, 1
    s_cmp_gt_u32 s38, 60000
    s_cbranch_scc1 k2_pout35
    s_waitcnt vmcnt(0)
    v_subrev_u32 v252, s23, v252
    v_subrev_u32 v253, s23, v253
    v_subrev_u32 v254, s23, v254
    v_max3_u32 v252, v252, v253, v254
    v_cmp_lt_u32 vcc, 15, v252
    s_cbranch_vccz k2_pout35
    s_mov_b64 exec, vcc
    s_branch k2_poll34
k2_pout35:
    s_mov_b64 exec, -1
k2_w2s33x:
    buffer_load_dwordx4 v[16:19], v248, s[8:11], s52 offen sc1
    buffer_load_dwordx4 v[20:23], v248, s[8:11], s53 offen sc1
    buffer_load_dwordx4 v[24:27], v248, s[8:11], s54 offen sc1
    buffer_load_dwordx4 v[28:31], v248, s[8:11], s55 offen sc1
    buffer_load_dwordx4 v[32:35], v248, s[8:11], s56 offen sc1
    buffer_load_dwordx4 v[36:39], v248, s[8:11], s57 offen sc1
    buffer_load_dwordx4 v[40:43], v248, s[8:11], s58 offen sc1
    buffer_load_dwordx4 v[44:47], v248, s[8:11], s59 offen sc1
    buffer_load_dwordx4 v[48:51], v248, s[8:11], s60 offen sc1
    buffer_load_dwordx4 v[52:55], v248, s[8:11], s61 offen sc1
    v_lshrrev_b32 v14, 4, v0
    v_and_b32 v15, 15, v0
    s_mul_i32 s23, s17, 5
    v_add_u32 v8, s23, v14
    v_lshrrev_b32 v9, 2, v8
    v_lshlrev_b32 v9, 12, v9
    v_and_b32 v10, 3, v8
    v_lshl_add_u32 v9, v10, 8, v9
    v_lshlrev_b32 v10, 9, v8
    s_lshl_b32 s38, s18, 10
    v_lshl_add_u32 v11, v15, 4, s38
    v_add_u32 v8, v9, v11
    s_add_u32 s23, s23, 4
    s_lshr_b32 s35, s23, 2
    s_lshl_b32 s35, s35, 12
    s_and_b32 s36, s23, 3
    s_lshl_b32 s36, s36, 8
    s_add_u32 s35, s35, s36
    v_lshl_add_u32 v9, v14, 2, v11
    v_add_u32 v9, s35, v9
    s_lshr_b32 s35, s18, 1
    s_mul_i32 s35, s35, 40960
    s_and_b32 s36, s18, 1
    s_lshl_b32 s36, s36, 8
    s_add_u32 s35, s35, s36
    v_lshl_add_u32 v11, v15, 4, s35
    v_add_u32 v10, v10, v11
    s_lshl_b32 s23, s23, 9
    v_lshl_add_u32 v11, v14, 2, v11
    v_add_u32 v11, s23, v11
    s_add_u32 s34, s24, 4456448
    s_add_u32 s35, s34, 20480
    s_lshl_b32 s23, s16, 12
    s_lshl_b32 s38, s17, 9
    s_add_u32 s23, s23, s38
    s_lshl_b32 s38, s18, 7
    s_add_u32 s23, s23, s38
    s_add_u32 s23, s23, 262144
    v_and_b32 v14, 31, v0
    v_lshlrev_b32 v14, 2, v14
    buffer_store_dwordx4 v[0:3], v10, s[8:11], s34 offen
    buffer_store_dwordx4 v[0:3], v10, s[8:11], s35 offen
    buffer_store_dword v0, v11, s[8:11], s34 offen
    buffer_store_dword v0, v11, s[8:11], s35 offen
    buffer_store_dword v0, v14, s[8:11], s23 offen
    s_waitcnt vmcnt(15)
    s_waitcnt vmcnt(14)
    v_cmp_gt_i32 vcc, 0, v19
    s_cbranch_vccnz k2_hr36
k2_hr36b:
    v_mfma_f32_16x16x32_bf16 v[208:211], a[0:3], v[16:19], 0
    v_mfma_f32_16x16x32_bf16 v[212:215], a[4:7], v[16:19], 0
    buffer_load_dwordx4 v[56:59], v248, s[8:11], s62 offen sc1
    v_mfma_f32_16x16x32_bf16 v[216:219], a[8:11], v[16:19], 0
    s_waitcnt vmcnt(14)
    v_cmp_gt_i32 vcc, 0, v23
    v_mfma_f32_16x16x32_bf16 v[220:223], a[12:15], v[16:19], 0
    v_mfma_f32_16x16x32_bf16 v[224:227], a[16:19], v[16:19], 0
    s_cbranch_vccnz k2_hr37
k2_hr37b:
    v_mfma_f32_16x16x32_bf16 v[208:211], a[20:23], v[20:23], v[208:211]
    v_mfma_f32_16x16x32_bf16 v[212:215], a[24:27], v[20:23], v[212:215]
    buffer_load_dwordx4 v[60:63], v248, s[8:11], s63 offen sc1
    v_mfma_f32_16x16x32_bf16 v[216:219], a[28:31], v[20:23], v[216:219]
    s_waitcnt vmcnt(14)
    v_cmp_gt_i32 vcc, 0, v27
    v_mfma_f32_16x16x32_bf16 v[220:223], a[32:35], v[20:23], v[220:223]
    v_mfma_f32_16x16x32_bf16 v[224:227], a[36:39], v[20:23], v[224:227]
    s_cbranch_vccnz k2_hr38
k2_hr38b:
    v_mfma_f32_16x16x32_bf16 v[208:211], a[40:43], v[24:27], v[208:211]
    v_mfma_f32_16x16x32_bf16 v[212:215], a[44:47], v[24:27], v[212:215]
    buffer_load_dwordx4 v[64:67], v249, s[8:11], s52 offen sc1
    v_mfma_f32_16x16x32_bf16 v[216:219], a[48:51], v[24:27], v[216:219]
    s_waitcnt vmcnt(14)
    v_cmp_gt_i32 vcc, 0, v31
    v_mfma_f32_16x16x32_bf16 v[220:223], a[52:55], v[24:27], v[220:223]
    v_mfma_f32_16x16x32_bf16 v[224:227], a[56:59], v[24:27], v[224:227]
    s_cbranch_vccnz k2_hr39
k2_hr39b:
    v_mfma_f32_16x16x32_bf16 v[208:211], a[60:63], v[28:31], v[208:211]
    v_mfma_f32_16x16x32_bf16 v[212:215], a[64:67], v[28:31], v[212:215]
    buffer_load_dwordx4 v[68:71], v249, s[8:11], s53 offen sc1
    v_mfma_f32_16x16x32_bf16 v[216:219], a[68:71], v[28:31], v[216:219]
    s_waitcnt vmcnt(14)
    v_cmp_gt_i32 vcc, 0, v35
    v_mfma_f32_16x16x32_bf16 v[220:223], a[72:75], v[28:31], v[220:223]
    v_mfma_f32_16x16x32_bf16 v[224:227], a[76:79], v[28:31], v[224:227]
    s_cbranch_vccnz k2_hr40
k2_hr40b:
    v_mfma_f32_16x16x32_bf16 v[208:211], a[80:83], v[32:35], v[208:211]
    v_mfma_f32_16x16x32_bf16 v[212:215], a[84:87], v[32:35], v[212:215]
    buffer_load_dwordx4 v[72:75], v249, s[8:11], s54 offen sc1
    v_mfma_f32_16x16x32_bf16 v[216:219], a[88:91], v[32:35], v[216:219]
    s_waitcnt vmcnt(14)
    v_cmp_gt_i32 vcc, 0, v39
    v_mfma_f32_16x16x32_bf16 v[220:223], a[92:95], v[32:35], v[220:223]
    v_mfma_f32_16x16x32_bf16 v[224:227], a[96:99], v[32:35], v[224:227]
    s_cbranch_vccnz k2_hr41
k2_hr41b:
    v_mfma_f32_16x16x32_bf16 v[208:211], a[100:103], v[36:39], v[208:211]
    v_mfma_f32_16x16x32_bf16 v[212:215], a[104:107], v[36:39], v[212:215]
    buffer_load_dwordx4 v[76:79], v249, s[8:11], s55 offen sc1
    v_mfma_f32_16x16x32_bf16 v[216:219], a[108:111], v[36:39], v[216:219]
    s_waitcnt vmcnt(14)
    v_cmp_gt_i32 vcc, 0, v43
    v_mfma_f32_16x16x32_bf16 v[220:223], a[112:115], v[36:39], v[220:223]
    v_mfma_f32_16x16x32_bf16 v[224:227], a[116:119], v[36:39], v[224:227]
    s_cbranch_vccnz k2_hr42
k2_hr42b:
    v_mfma_f32_16x16x32_bf16 v[208:211], a[120:123], v[40:43], v[208:211]
    v_mfma_f32_16x16x32_bf16 v[212:215], a[124:127], v[40:43], v[212:215]
    buffer_load_dwordx4 v[80:83], v249, s[8:11], s56 offen sc1
    v_mfma_f32_16x16x32_bf16 v[216:219], a[128:131], v[40:43], v[216:219]
    s_waitcnt vmcnt(14)
    v_cmp_gt_i32 vcc, 0, v47
    v_mfma_f32_16x16x32_bf16 v[220:223], a[132:135], v[40:43], v[220:223]
    v_mfma_f32_16x16x32_bf16 v[224:227], a[136:139], v[40:43], v[224:227]
    s_cbranch_vccnz k2_hr43
k2_hr43b:
    v_mfma_f32_16x16x32_bf16 v[208:211], a[140:143], v[44:47], v[208:211]
    v_mfma_f32_16x16x32_bf16 v[212:215], a[144:147], v[44:47], v[212:215]
    buffer_load_dwordx4 v[84:87], v249, s[8:11], s57 offen sc1
    v_mfma_f32_16x16x32_bf16 v[216:219], a[148:151], v[44:47], v[216:219]
    s_waitcnt vmcnt(14)
    v_cmp_gt_i32 vcc, 0, v51
    v_mfma_f32_16x16x32_bf16 v[220:223], a[152:155], v[44:47], v[220:223]
    v_mfma_f32_16x16x32_bf16 v[224:227], a[156:159], v[44:47], v[224:227]
    s_cbranch_vccnz k2_hr44
k2_hr44b:
    v_mfma_f32_16x16x32_bf16 v[208:211], a[160:163], v[48:51], v[208:211]
    v_mfma_f32_16x16x32_bf16 v[212:215], a[164:167], v[48:51], v[212:215]
    buffer_load_dwordx4 v[88:91], v249, s[8:11], s58 offen sc1
    v_mfma_f32_16x16x32_bf16 v[216:219], a[168:171], v[48:51], v[216:219]
    s_waitcnt vmcnt(14)
    v_cmp_gt_i32 vcc, 0, v55
    v_mfma_f32_16x16x32_bf16 v[220:223], a[172:175], v[48:51], v[220:223]
    v_mfma_f32_16x16x32_bf16 v[224:227], a[176:179], v[48:51], v[224:227]
    s_cbranch_vccnz k2_hr45
k2_hr45b:
    v_mfma_f32_16x16x32_bf16 v[208:211], a[180:183], v[52:55], v[208:211]
    v_mfma_f32_16x16x32_bf16 v[212:215], a[184:187], v[52:55], v[212:215]
    buffer_load_dwordx4 v[92:95], v249, s[8:11], s59 offen sc1
    v_mfma_f32_16x16x32_bf16 v[216:219], a[188:191], v[52:55], v[216:219]
    s_waitcnt vmcnt(9)
    v_cmp_gt_i32 vcc, 0, v59
    v_mfma_f32_16x16x32_bf16 v[220:223], a[192:195], v[52:55], v[220:223]
    v_mfma_f32_16x16x32_bf16 v[224:227], a[196:199], v[52:55], v[224:227]
    s_cbranch_vccnz k2_hr46
k2_hr46b:
    v_mfma_f32_16x16x32_bf16 v[208:211], a[200:203], v[56:59], v[208:211]
    v_mfma_f32_16x16x32_bf16 v[212:215], a[204:207], v[56:59], v[212:215]
    buffer_load_dwordx4 v[96:99], v249, s[8:11], s60 offen sc1
    v_mfma_f32_16x16x32_bf16 v[216:219], a[208:211], v[56:59], v[216:219]
    s_waitcnt vmcnt(9)
    v_cmp_gt_i32 vcc, 0, v63
    v_mfma_f32_16x16x32_bf16 v[220:223], a[212:215], v[56:59], v[220:223]
    v_mfma_f32_16x16x32_bf16 v[224:227], a[216:219], v[56:59], v[224:227]
    s_cbranch_vccnz k2_hr47
k2_hr47b:
    v_mfma_f32_16x16x32_bf16 v[208:211], a[220:223], v[60:63], v[208:211]
    v_mfma_f32_16x16x32_bf16 v[212:215], a[224:227], v[60:63], v[212:215]
    buffer_load_dwordx4 v[100:103], v249, s[8:11], s61 offen sc1
    v_mfma_f32_16x16x32_bf16 v[216:219], a[228:231], v[60:63], v[216:219]
    s_waitcnt vmcnt(9)
    v_cmp_gt_i32 vcc, 0, v67
    v_mfma_f32_16x16x32_bf16 v[220:223], a[232:235], v[60:63], v[220:223]
    v_mfma_f32_16x16x32_bf16 v[224:227], a[236:239], v[60:63], v[224:227]
    s_cbranch_vccnz k2_hr48
k2_hr48b:
    v_mfma_f32_16x16x32_bf16 v[228:231], a[0:3], v[64:67], 0
    v_mfma_f32_16x16x32_bf16 v[232:235], a[4:7], v[64:67], 0
    buffer_load_dwordx4 v[104:107], v249, s[8:11], s62 offen sc1
    v_mfma_f32_16x16x32_bf16 v[236:239], a[8:11], v[64:67], 0
    s_waitcnt vmcnt(9)
    v_cmp_gt_i32 vcc, 0, v71
    v_mfma_f32_16x16x32_bf16 v[240:243], a[12:15], v[64:67], 0
    v_mfma_f32_16x16x32_bf16 v[244:247], a[16:19], v[64:67], 0
    s_cbranch_vccnz k2_hr49
k2_hr49b:
    v_mfma_f32_16x16x32_bf16 v[228:231], a[20:23], v[68:71], v[228:231]
    v_mfma_f32_16x16x32_bf16 v[232:235], a[24:27], v[68:71], v[232:235]
    buffer_load_dwordx4 v[108:111], v249, s[8:11], s63 offen sc1
    v_mfma_f32_16x16x32_bf16 v[236:239], a[28:31], v[68:71], v[236:239]
    s_waitcnt vmcnt(9)
    v_cmp_gt_i32 vcc, 0, v75
    v_mfma_f32_16x16x32_bf16 v[240:243], a[32:35], v[68:71], v[240:243]
    s_add_u32 s23, s18, 1
    s_and_b32 s23, s23, 3
    s_mul_i32 s23, s23, 15360
    s_add_u32 s23, s23, 81920
    v_add_u32 v14, s23, v1
    v_mfma_f32_16x16x32_bf16 v[244:247], a[36:39], v[68:71], v[244:247]
    s_cbranch_vccnz k2_hr50
k2_hr50b:
    v_mfma_f32_16x16x32_bf16 v[228:231], a[40:43], v[72:75], v[228:231]
    ds_write_b128 v14, v[208:211] offset:0
    v_mfma_f32_16x16x32_bf16 v[232:235], a[44:47], v[72:75], v[232:235]
    buffer_load_dwordx4 v[112:115], v250, s[8:11], s52 offen sc1
    v_mfma_f32_16x16x32_bf16 v[236:239], a[48:51], v[72:75], v[236:239]
    s_waitcnt vmcnt(9)
    v_cmp_gt_i32 vcc, 0, v79
    ds_write_b128 v14, v[212:215] offset:1024
    v_mfma_f32_16x16x32_bf16 v[240:243], a[52:55], v[72:75], v[240:243]
    v_mfma_f32_16x16x32_bf16 v[244:247], a[56:59], v[72:75], v[244:247]
    s_cbranch_vccnz k2_hr51
k2_hr51b:
    ds_write_b128 v14, v[216:219] offset:2048
    v_mfma_f32_16x16x32_bf16 v[228:231], a[60:63], v[76:79], v[228:231]
    v_mfma_f32_16x16x32_bf16 v[232:235], a[64:67], v[76:79], v[232:235]
    buffer_load_dwordx4 v[116:119], v250, s[8:11], s53 offen sc1
    ds_write_b128 v14, v[220:223] offset:3072
    v_mfma_f32_16x16x32_bf16 v[236:239], a[68:71], v[76:79], v[236:239]
    s_waitcnt vmcnt(9)
    v_cmp_gt_i32 vcc, 0, v83
    v_mfma_f32_16x16x32_bf16 v[240:243], a[72:75], v[76:79], v[240:243]
    ds_write_b128 v14, v[224:227] offset:4096
    v_mfma_f32_16x16x32_bf16 v[244:247], a[76:79], v[76:79], v[244:247]
    s_cbranch_vccnz k2_hr52
k2_hr52b:
    v_mfma_f32_16x16x32_bf16 v[228:231], a[80:83], v[80:83], v[228:231]
    v_mfma_f32_16x16x32_bf16 v[232:235], a[84:87], v[80:83], v[232:235]
    buffer_load_dwordx4 v[120:123], v250, s[8:11], s54 offen sc1
    v_mfma_f32_16x16x32_bf16 v[236:239], a[88:91], v[80:83], v[236:239]
    s_waitcnt vmcnt(9)
    v_cmp_gt_i32 vcc, 0, v87
    v_mfma_f32_16x16x32_bf16 v[240:243], a[92:95], v[80:83], v[240:243]
    v_mfma_f32_16x16x32_bf16 v[244:247], a[96:99], v[80:83], v[244:247]
    s_cbranch_vccnz k2_hr53
k2_hr53b:
    s_add_u32 s34, s24, 7077888
    s_add_u32 s35, s34, 40960
    buffer_load_dwordx4 v[16:19], v8, s[8:11], s34 offen sc1
    buffer_load_dwordx4 v[20:23], v8, s[8:11], s35 offen sc1
    buffer_load_dword v24, v9, s[8:11], s34 offen sc1
    buffer_load_dword v25, v9, s[8:11], s35 offen sc1
    v_mfma_f32_16x16x32_bf16 v[228:231], a[100:103], v[84:87], v[228:231]
    v_mfma_f32_16x16x32_bf16 v[232:235], a[104:107], v[84:87], v[232:235]
    buffer_load_dwordx4 v[124:127], v250, s[8:11], s55 offen sc1
    v_mfma_f32_16x16x32_bf16 v[236:239], a[108:111], v[84:87], v[236:239]
    s_waitcnt vmcnt(13)
    v_cmp_gt_i32 vcc, 0, v91
    v_mfma_f32_16x16x32_bf16 v[240:243], a[112:115], v[84:87], v[240:243]
    v_mfma_f32_16x16x32_bf16 v[244:247], a[116:119], v[84:87], v[244:247]
    s_cbranch_vccnz k2_hr54
k2_hr54b:
    v_mfma_f32_16x16x32_bf16 v[228:231], a[120:123], v[88:91], v[228:231]
    v_mfma_f32_16x16x32_bf16 v[232:235], a[124:127], v[88:91], v[232:235]
    buffer_load_dwordx4 v[128:131], v250, s[8:11], s56 offen sc1
    v_mfma_f32_16x16x32_bf16 v[236:239], a[128:131], v[88:91], v[236:239]
    s_waitcnt vmcnt(13)
    v_cmp_gt_i32 vcc, 0, v95
    v_mfma_f32_16x16x32_bf16 v[240:243], a[132:135], v[88:91], v[240:243]
    v_mfma_f32_16x16x32_bf16 v[244:247], a[136:139], v[88:91], v[244:247]
    s_cbranch_vccnz k2_hr55
k2_hr55b:
    v_mfma_f32_16x16x32_bf16 v[228:231], a[140:143], v[92:95], v[228:231]
    v_mfma_f32_16x16x32_bf16 v[232:235], a[144:147], v[92:95], v[232:235]
    buffer_load_dwordx4 v[132:135], v250, s[8:11], s57 offen sc1
    v_mfma_f32_16x16x32_bf16 v[236:239], a[148:151], v[92:95], v[236:239]
    s_waitcnt vmcnt(13)
    v_cmp_gt_i32 vcc, 0, v99
    v_mfma_f32_16x16x32_bf16 v[240:243], a[152:155], v[92:95], v[240:243]
    v_mfma_f32_16x16x32_bf16 v[244:247], a[156:159], v[92:95], v[244:247]
    s_cbranch_vccnz k2_hr56
k2_hr56b:
    v_mfma_f32_16x16x32_bf16 v[228:231], a[160:163], v[96:99], v[228:231]
    v_mfma_f32_16x16x32_bf16 v[232:235], a[164:167], v[96:99], v[232:235]
    buffer_load_dwordx4 v[136:139], v250, s[8:11], s58 offen sc1
    v_mfma_f32_16x16x32_bf16 v[236:239], a[168:171], v[96:99], v[236:239]
    s_waitcnt vmcnt(13)
    v_cmp_gt_i32 vcc, 0, v103
    v_mfma_f32_16x16x32_bf16 v[240:243], a[172:175], v[96:99], v[240:243]
    v_mfma_f32_16x16x32_bf16 v[244:247], a[176:179], v[96:99], v[244:247]
    s_cbranch_vccnz k2_hr57
k2_hr57b:
    v_mfma_f32_16x16x32_bf16 v[228:231], a[180:183], v[100:103], v[228:231]
    v_mfma_f32_16x16x32_bf16 v[232:235], a[184:187], v[100:103], v[232:235]
    buffer_load_dwordx4 v[140:143], v250, s[8:11], s59 offen sc1
    v_mfma_f32_16x16x32_bf16 v[236:239], a[188:191], v[100:103], v[236:239]
    s_waitcnt vmcnt(13)
    v_cmp_gt_i32 vcc, 0, v107
    v_mfma_f32_16x16x32_bf16 v[240:243], a[192:195], v[100:103], v[240:243]
    v_mfma_f32_16x16x32_bf16 v[244:247], a[196:199], v[100:103], v[244:247]
    s_cbranch_vccnz k2_hr58
k2_hr58b:
    v_mfma_f32_16x16x32_bf16 v[228:231], a[200:203], v[104:107], v[228:231]
    v_mfma_f32_16x16x32_bf16 v[232:235], a[204:207], v[104:107], v[232:235]
    buffer_load_dwordx4 v[144:147], v250, s[8:11], s60 offen sc1
    v_mfma_f32_16x16x32_bf16 v[236:239], a[208:211], v[104:107], v[236:239]
    s_waitcnt vmcnt(13)
    v_cmp_gt_i32 vcc, 0, v111
    v_mfma_f32_16x16x32_bf16 v[240:243], a[212:215], v[104:107], v[240:243]
    v_mfma_f32_16x16x32_bf16 v[244:247], a[216:219], v[104:107], v[244:247]
    s_cbranch_vccnz k2_hr59
k2_hr59b:
    v_mfma_f32_16x16x32_bf16 v[228:231], a[220:223], v[108:111], v[228:231]
    v_mfma_f32_16x16x32_bf16 v[232:235], a[224:227], v[108:111], v[232:235]
    buffer_load_dwordx4 v[148:151], v250, s[8:11], s61 offen sc1
    v_mfma_f32_16x16x32_bf16 v[236:239], a[228:231], v[108:111], v[236:239]
    s_waitcnt vmcnt(13)
    v_cmp_gt_i32 vcc, 0, v115
    v_mfma_f32_16x16x32_bf16 v[240:243], a[232:235], v[108:111], v[240:243]
    v_mfma_f32_16x16x32_bf16 v[244:247], a[236:239], v[108:111], v[244:247]
    s_cbranch_vccnz k2_hr60
k2_hr60b:
    v_mfma_f32_16x16x32_bf16 v[208:211], a[0:3], v[112:115], 0
    v_mfma_f32_16x16x32_bf16 v[212:215], a[4:7], v[112:115], 0
    buffer_load_dwordx4 v[152:155], v250, s[8:11], s62 offen sc1
    v_mfma_f32_16x16x32_bf16 v[216:219], a[8:11], v[112:115], 0
    s_waitcnt vmcnt(13)
    v_cmp_gt_i32 vcc, 0, v119
    v_mfma_f32_16x16x32_bf16 v[220:223], a[12:15], v[112:115], 0
    v_mfma_f32_16x16x32_bf16 v[224:227], a[16:19], v[112:115], 0
    s_cbranch_vccnz k2_hr61
k2_hr61b:
    v_mfma_f32_16x16x32_bf16 v[208:211], a[20:23], v[116:119], v[208:211]
    v_mfma_f32_16x16x32_bf16 v[212:215], a[24:27], v[116:119], v[212:215]
    buffer_load_dwordx4 v[156:159], v250, s[8:11], s63 offen sc1
    v_mfma_f32_16x16x32_bf16 v[216:219], a[28:31], v[116:119], v[216:219]
    s_waitcnt vmcnt(13)
    v_cmp_gt_i32 vcc, 0, v123
    v_mfma_f32_16x16x32_bf16 v[220:223], a[32:35], v[116:119], v[220:223]
    s_add_u32 s23, s18, 2
    s_and_b32 s23, s23, 3
    s_mul_i32 s23, s23, 15360
    s_add_u32 s23, s23, 87040
    v_add_u32 v14, s23, v1
    v_mfma_f32_16x16x32_bf16 v[224:227], a[36:39], v[116:119], v[224:227]
    s_cbranch_vccnz k2_hr62
k2_hr62b:
    v_mfma_f32_16x16x32_bf16 v[208:211], a[40:43], v[120:123], v[208:211]
    ds_write_b128 v14, v[228:231] offset:0
    v_mfma_f32_16x16x32_bf16 v[212:215], a[44:47], v[120:123], v[212:215]
    buffer_load_dwordx4 v[160:163], v251, s[8:11], s52 offen sc1
    v_mfma_f32_16x16x32_bf16 v[216:219], a[48:51], v[120:123], v[216:219]
    s_waitcnt vmcnt(9)
    v_cmp_gt_i32 vcc, 0, v127
    ds_write_b128 v14, v[232:235] offset:1024
    v_mfma_f32_16x16x32_bf16 v[220:223], a[52:55], v[120:123], v[220:223]
    v_mfma_f32_16x16x32_bf16 v[224:227], a[56:59], v[120:123], v[224:227]
    s_cbranch_vccnz k2_hr63
k2_hr63b:
    ds_write_b128 v14, v[236:239] offset:2048
    v_mfma_f32_16x16x32_bf16 v[208:211], a[60:63], v[124:127], v[208:211]
    v_mfma_f32_16x16x32_bf16 v[212:215], a[64:67], v[124:127], v[212:215]
    buffer_load_dwordx4 v[164:167], v251, s[8:11], s53 offen sc1
    ds_write_b128 v14, v[240:243] offset:3072
    v_mfma_f32_16x16x32_bf16 v[216:219], a[68:71], v[124:127], v[216:219]
    s_waitcnt vmcnt(9)
    v_cmp_gt_i32 vcc, 0, v131
    v_mfma_f32_16x16x32_bf16 v[220:223], a[72:75], v[124:127], v[220:223]
    ds_write_b128 v14, v[244:247] offset:4096
    v_mfma_f32_16x16x32_bf16 v[224:227], a[76:79], v[124:127], v[224:227]
    s_cbranch_vccnz k2_hr64
k2_hr64b:
    v_mfma_f32_16x16x32_bf16 v[208:211], a[80:83], v[128:131], v[208:211]
    v_mfma_f32_16x16x32_bf16 v[212:215], a[84:87], v[128:131], v[212:215]
    buffer_load_dwordx4 v[168:171], v251, s[8:11], s54 offen sc1
    v_mfma_f32_16x16x32_bf16 v[216:219], a[88:91], v[128:131], v[216:219]
    s_waitcnt vmcnt(9)
    v_cmp_gt_i32 vcc, 0, v135
    v_mfma_f32_16x16x32_bf16 v[220:223], a[92:95], v[128:131], v[220:223]
    v_mfma_f32_16x16x32_bf16 v[224:227], a[96:99], v[128:131], v[224:227]
    s_cbranch_vccnz k2_hr65
k2_hr65b:
    v_mfma_f32_16x16x32_bf16 v[208:211], a[100:103], v[132:135], v[208:211]
    v_mfma_f32_16x16x32_bf16 v[212:215], a[104:107], v[132:135], v[212:215]
    buffer_load_dwordx4 v[172:175], v251, s[8:11], s55 offen sc1
    v_mfma_f32_16x16x32_bf16 v[216:219], a[108:111], v[132:135], v[216:219]
    s_waitcnt vmcnt(9)
    v_cmp_gt_i32 vcc, 0, v139
    v_mfma_f32_16x16x32_bf16 v[220:223], a[112:115], v[132:135], v[220:223]
    v_mfma_f32_16x16x32_bf16 v[224:227], a[116:119], v[132:135], v[224:227]
    s_cbranch_vccnz k2_hr66
k2_hr66b:
    v_mfma_f32_16x16x32_bf16 v[208:211], a[120:123], v[136:139], v[208:211]
    v_mfma_f32_16x16x32_bf16 v[212:215], a[124:127], v[136:139], v[212:215]
    buffer_load_dwordx4 v[176:179], v251, s[8:11], s56 offen sc1
    v_mfma_f32_16x16x32_bf16 v[216:219], a[128:131], v[136:139], v[216:219]
    s_waitcnt vmcnt(9)
    v_cmp_gt_i32 vcc, 0, v143
    v_mfma_f32_16x16x32_bf16 v[220:223], a[132:135], v[136:139], v[220:223]
    v_mfma_f32_16x16x32_bf16 v[224:227], a[136:139], v[136:139], v[224:227]
    s_cbranch_vccnz k2_hr67
k2_hr67b:
    v_mfma_f32_16x16x32_bf16 v[208:211], a[140:143], v[140:143], v[208:211]
    v_mfma_f32_16x16x32_bf16 v[212:215], a[144:147], v[140:143], v[212:215]
    buffer_load_dwordx4 v[180:183], v251, s[8:11], s57 offen sc1
    v_mfma_f32_16x16x32_bf16 v[216:219], a[148:151], v[140:143], v[216:219]
    s_waitcnt vmcnt(9)
    v_cmp_gt_i32 vcc, 0, v147
    v_mfma_f32_16x16x32_bf16 v[220:223], a[152:155], v[140:143], v[220:223]
    v_mfma_f32_16x16x32_bf16 v[224:227], a[156:159], v[140:143], v[224:227]
    s_cbranch_vccnz k2_hr68
k2_hr68b:
    v_mfma_f32_16x16x32_bf16 v[208:211], a[160:163], v[144:147], v[208:211]
    v_mfma_f32_16x16x32_bf16 v[212:215], a[164:167], v[144:147], v[212:215]
    buffer_load_dwordx4 v[184:187], v251, s[8:11], s58 offen sc1
    v_mfma_f32_16x16x32_bf16 v[216:219], a[168:171], v[144:147], v[216:219]
    s_waitcnt vmcnt(9)
    v_cmp_gt_i32 vcc, 0, v151
    v_mfma_f32_16x16x32_bf16 v[220:223], a[172:175], v[144:147], v[220:223]
    v_mfma_f32_16x16x32_bf16 v[224:227], a[176:179], v[144:147], v[224:227]
    s_cbranch_vccnz k2_hr69
k2_hr69b:
    v_mfma_f32_16x16x32_bf16 v[208:211], a[180:183], v[148:151], v[208:211]
    v_mfma_f32_16x16x32_bf16 v[212:215], a[184:187], v[148:151], v[212:215]
    buffer_load_dwordx4 v[188:191], v251, s[8:11], s59 offen sc1
    v_mfma_f32_16x16x32_bf16 v[216:219], a[188:191], v[148:151], v[216:219]
    s_waitcnt vmcnt(9)
    v_cmp_gt_i32 vcc, 0, v155
    v_mfma_f32_16x16x32_bf16 v[220:223], a[192:195], v[148:151], v[220:223]
    v_mfma_f32_16x16x32_bf16 v[224:227], a[196:199], v[148:151], v[224:227]
    s_cbranch_vccnz k2_hr70
k2_hr70b:
    v_mfma_f32_16x16x32_bf16 v[208:211], a[200:203], v[152:155], v[208:211]
    v_mfma_f32_16x16x32_bf16 v[212:215], a[204:207], v[152:155], v[212:215]
    buffer_load_dwordx4 v[192:195], v251, s[8:11], s60 offen sc1
    v_mfma_f32_16x16x32_bf16 v[216:219], a[208:211], v[152:155], v[216:219]
    s_waitcnt vmcnt(9)
    v_cmp_gt_i32 vcc, 0, v159
    v_mfma_f32_16x16x32_bf16 v[220:223], a[212:215], v[152:155], v[220:223]
    v_mfma_f32_16x16x32_bf16 v[224:227], a[216:219], v[152:155], v[224:227]
    s_cbranch_vccnz k2_hr71
k2_hr71b:
    v_mfma_f32_16x16x32_bf16 v[208:211], a[220:223], v[156:159], v[208:211]
    v_mfma_f32_16x16x32_bf16 v[212:215], a[224:227], v[156:159], v[212:215]
    buffer_load_dwordx4 v[196:199], v251, s[8:11], s61 offen sc1
    v_mfma_f32_16x16x32_bf16 v[216:219], a[228:231], v[156:159], v[216:219]
    s_waitcnt vmcnt(9)
    v_cmp_gt_i32 vcc, 0, v163
    v_mfma_f32_16x16x32_bf16 v[220:223], a[232:235], v[156:159], v[220:223]
    v_mfma_f32_16x16x32_bf16 v[224:227], a[236:239], v[156:159], v[224:227]
    s_cbranch_vccnz k2_hr72
k2_hr72b:
    v_mfma_f32_16x16x32_bf16 v[228:231], a[0:3], v[160:163], 0
    v_mfma_f32_16x16x32_bf16 v[232:235], a[4:7], v[160:163], 0
    buffer_load_dwordx4 v[200:203], v251, s[8:11], s62 offen sc1
    v_mfma_f32_16x16x32_bf16 v[236:239], a[8:11], v[160:163], 0
    s_waitcnt vmcnt(9)
    v_cmp_gt_i32 vcc, 0, v167
    v_mfma_f32_16x16x32_bf16 v[240:243], a[12:15], v[160:163], 0
    v_mfma_f32_16x16x32_bf16 v[244:247], a[16:19], v[160:163], 0
    s_cbranch_vccnz k2_hr73
k2_hr73b:
    v_mfma_f32_16x16x32_bf16 v[228:231], a[20:23], v[164:167], v[228:231]
    v_mfma_f32_16x16x32_bf16 v[232:235], a[24:27], v[164:167], v[232:235]
    buffer_load_dwordx4 v[204:207], v251, s[8:11], s63 offen sc1
    v_mfma_f32_16x16x32_bf16 v[236:239], a[28:31], v[164:167], v[236:239]
    s_waitcnt vmcnt(9)
    v_cmp_gt_i32 vcc, 0, v171
    v_mfma_f32_16x16x32_bf16 v[240:243], a[32:35], v[164:167], v[240:243]
    s_add_u32 s23, s18, 3
    s_and_b32 s23, s23, 3
    s_mul_i32 s23, s23, 15360
    s_add_u32 s23, s23, 92160
    v_add_u32 v14, s23, v1
    v_mfma_f32_16x16x32_bf16 v[244:247], a[36:39], v[164:167], v[244:247]
    s_cbranch_vccnz k2_hr74
k2_hr74b:
    v_mfma_f32_16x16x32_bf16 v[228:231], a[40:43], v[168:171], v[228:231]
    ds_write_b128 v14, v[208:211] offset:0
    v_mfma_f32_16x16x32_bf16 v[232:235], a[44:47], v[168:171], v[232:235]
    v_mfma_f32_16x16x32_bf16 v[236:239], a[48:51], v[168:171], v[236:239]
    s_waitcnt vmcnt(8)
    v_cmp_gt_i32 vcc, 0, v175
    ds_write_b128 v14, v[212:215] offset:1024
    v_mfma_f32_16x16x32_bf16 v[240:243], a[52:55], v[168:171], v[240:243]
    v_mfma_f32_16x16x32_bf16 v[244:247], a[56:59], v[168:171], v[244:247]
    s_cbranch_vccnz k2_hr75
k2_hr75b:
    ds_write_b128 v14, v[216:219] offset:2048
    v_mfma_f32_16x16x32_bf16 v[228:231], a[60:63], v[172:175], v[228:231]
    v_mfma_f32_16x16x32_bf16 v[232:235], a[64:67], v[172:175], v[232:235]
    ds_write_b128 v14, v[220:223] offset:3072
    v_mfma_f32_16x16x32_bf16 v[236:239], a[68:71], v[172:175], v[236:239]
    s_waitcnt vmcnt(7)
    v_cmp_gt_i32 vcc, 0, v179
    v_mfma_f32_16x16x32_bf16 v[240:243], a[72:75], v[172:175], v[240:243]
    ds_write_b128 v14, v[224:227] offset:4096
    v_mfma_f32_16x16x32_bf16 v[244:247], a[76:79], v[172:175], v[244:247]
    s_cbranch_vccnz k2_hr76
k2_hr76b:
    v_mfma_f32_16x16x32_bf16 v[228:231], a[80:83], v[176:179], v[228:231]
    v_mfma_f32_16x16x32_bf16 v[232:235], a[84:87], v[176:179], v[232:235]
    v_mfma_f32_16x16x32_bf16 v[236:239], a[88:91], v[176:179], v[236:239]
    s_waitcnt vmcnt(6)
    v_cmp_gt_i32 vcc, 0, v183
    v_mfma_f32_16x16x32_bf16 v[240:243], a[92:95], v[176:179], v[240:243]
    v_mfma_f32_16x16x32_bf16 v[244:247], a[96:99], v[176:179], v[244:247]
    s_cbranch_vccnz k2_hr77
k2_hr77b:
    v_mfma_f32_16x16x32_bf16 v[228:231], a[100:103], v[180:183], v[228:231]
    v_mfma_f32_16x16x32_bf16 v[232:235], a[104:107], v[180:183], v[232:235]
    v_mfma_f32_16x16x32_bf16 v[236:239], a[108:111], v[180:183], v[236:239]
    s_waitcnt vmcnt(5)
    v_cmp_gt_i32 vcc, 0, v187
    v_mfma_f32_16x16x32_bf16 v[240:243], a[112:115], v[180:183], v[240:243]
    v_mfma_f32_16x16x32_bf16 v[244:247], a[116:119], v[180:183], v[244:247]
    s_cbranch_vccnz k2_hr78
k2_hr78b:
    s_waitcnt lgkmcnt(0)
    s_barrier
    s_mul_i32 s23, s18, 15360
    s_add_u32 s23, s23, 81920
    v_add_u32 v14, s23, v1
    v_mfma_f32_16x16x32_bf16 v[228:231], a[120:123], v[184:187], v[228:231]
    v_mfma_f32_16x16x32_bf16 v[232:235], a[124:127], v[184:187], v[232:235]
    ds_read_b128 v[64:67], v14 offset:0
    v_mfma_f32_16x16x32_bf16 v[236:239], a[128:131], v[184:187], v[236:239]
    s_waitcnt vmcnt(4)
    v_cmp_gt_i32 vcc, 0, v191
    ds_read_b128 v[68:71], v14 offset:1024
    v_mfma_f32_16x16x32_bf16 v[240:243], a[132:135], v[184:187], v[240:243]
    ds_read_b128 v[72:75], v14 offset:2048
    v_mfma_f32_16x16x32_bf16 v[244:247], a[136:139], v[184:187], v[244:247]
    s_cbranch_vccnz k2_hr79
k2_hr79b:
    ds_read_b128 v[76:79], v14 offset:3072
    v_mfma_f32_16x16x32_bf16 v[228:231], a[140:143], v[188:191], v[228:231]
    ds_read_b128 v[80:83], v14 offset:4096
    v_mfma_f32_16x16x32_bf16 v[232:235], a[144:147], v[188:191], v[232:235]
    ds_read_b128 v[84:87], v14 offset:5120
    v_mfma_f32_16x16x32_bf16 v[236:239], a[148:151], v[188:191], v[236:239]
    s_waitcnt vmcnt(3)
    v_cmp_gt_i32 vcc, 0, v195
    ds_read_b128 v[88:91], v14 offset:6144
    v_mfma_f32_16x16x32_bf16 v[240:243], a[152:155], v[188:191], v[240:243]
    ds_read_b128 v[92:95], v14 offset:7168
    v_mfma_f32_16x16x32_bf16 v[244:247], a[156:159], v[188:191], v[244:247]
    s_cbranch_vccnz k2_hr80
k2_hr80b:
    ds_read_b128 v[96:99], v14 offset:8192
    v_mfma_f32_16x16x32_bf16 v[228:231], a[160:163], v[192:195], v[228:231]
    ds_read_b128 v[100:103], v14 offset:9216
    v_mfma_f32_16x16x32_bf16 v[232:235], a[164:167], v[192:195], v[232:235]
    ds_read_b128 v[104:107], v14 offset:10240
    v_mfma_f32_16x16x32_bf16 v[236:239], a[168:171], v[192:195], v[236:239]
    s_waitcnt vmcnt(2)
    v_cmp_gt_i32 vcc, 0, v199
    ds_read_b128 v[108:111], v14 offset:11264
    v_mfma_f32_16x16x32_bf16 v[240:243], a[172:175], v[192:195], v[240:243]
    ds_read_b128 v[112:115], v14 offset:12288
    v_mfma_f32_16x16x32_bf16 v[244:247], a[176:179], v[192:195], v[244:247]
    s_cbranch_vccnz k2_hr81
k2_hr81b:
    ds_read_b128 v[116:119], v14 offset:13312
    v_mfma_f32_16x16x32_bf16 v[228:231], a[180:183], v[196:199], v[228:231]
    ds_read_b128 v[120:123], v14 offset:14336
    v_mfma_f32_16x16x32_bf16 v[232:235], a[184:187], v[196:199], v[232:235]
    v_mfma_f32_16x16x32_bf16 v[236:239], a[188:191], v[196:199], v[236:239]
    s_waitcnt vmcnt(1)
    v_cmp_gt_i32 vcc, 0, v203
    v_mfma_f32_16x16x32_bf16 v[240:243], a[192:195], v[196:199], v[240:243]
    v_mfma_f32_16x16x32_bf16 v[244:247], a[196:199], v[196:199], v[244:247]
    s_cbranch_vccnz k2_hr82
k2_hr82b:
    v_mfma_f32_16x16x32_bf16 v[228:231], a[200:203], v[200:203], v[228:231]
    v_mfma_f32_16x16x32_bf16 v[232:235], a[204:207], v[200:203], v[232:235]
    v_mfma_f32_16x16x32_bf16 v[236:239], a[208:211], v[200:203], v[236:239]
    s_waitcnt vmcnt(0)
    v_cmp_gt_i32 vcc, 0, v207
    v_mfma_f32_16x16x32_bf16 v[240:243], a[212:215], v[200:203], v[240:243]
    v_mfma_f32_16x16x32_bf16 v[244:247], a[216:219], v[200:203], v[244:247]
    s_cbranch_vccnz k2_hr83
k2_hr83b:
    v_mfma_f32_16x16x32_bf16 v[228:231], a[220:223], v[204:207], v[228:231]
    v_mfma_f32_16x16x32_bf16 v[232:235], a[224:227], v[204:207], v[232:235]
    v_mfma_f32_16x16x32_bf16 v[236:239], a[228:231], v[204:207], v[236:239]
    v_mfma_f32_16x16x32_bf16 v[240:243], a[232:235], v[204:207], v[240:243]
    v_mfma_f32_16x16x32_bf16 v[244:247], a[236:239], v[204:207], v[244:247]
    v_lshlrev_b32 v32, 16, v16
    v_and_b32 v36, 0xffff0000, v16
    v_lshlrev_b32 v33, 16, v17
    v_and_b32 v37, 0xffff0000, v17
    v_lshlrev_b32 v34, 16, v18
    v_and_b32 v38, 0xffff0000, v18
    v_lshlrev_b32 v35, 16, v19
    v_and_b32 v39, 0xffff0000, v19
    v_lshlrev_b32 v40, 16, v20
    v_and_b32 v44, 0xffff0000, v20
    v_lshlrev_b32 v41, 16, v21
    v_and_b32 v45, 0xffff0000, v21
    v_lshlrev_b32 v42, 16, v22
    v_and_b32 v46, 0xffff0000, v22
    v_lshlrev_b32 v43, 16, v23
    v_and_b32 v47, 0xffff0000, v23
    v_lshlrev_b32 v48, 16, v24
    v_and_b32 v49, 0xffff0000, v24
    v_lshlrev_b32 v50, 16, v25
    v_and_b32 v51, 0xffff0000, v25
    s_waitcnt lgkmcnt(0)
    v_pk_add_f32 v[64:65], v[64:65], v[84:85]
    v_pk_add_f32 v[228:229], v[228:229], v[104:105]
    v_pk_add_f32 v[66:67], v[66:67], v[86:87]
    v_pk_add_f32 v[230:231], v[230:231], v[106:107]
    v_pk_add_f32 v[68:69], v[68:69], v[88:89]
    v_pk_add_f32 v[232:233], v[232:233], v[108:109]
    v_pk_add_f32 v[70:71], v[70:71], v[90:91]
    v_pk_add_f32 v[234:235], v[234:235], v[110:111]
    v_pk_add_f32 v[72:73], v[72:73], v[92:93]
    v_pk_add_f32 v[236:237], v[236:237], v[112:113]
    v_pk_add_f32 v[74:75], v[74:75], v[94:95]
    v_pk_add_f32 v[238:239], v[238:239], v[114:115]
    v_pk_add_f32 v[76:77], v[76:77], v[96:97]
    v_pk_add_f32 v[240:241], v[240:241], v[116:117]
    v_pk_add_f32 v[78:79], v[78:79], v[98:99]
    v_pk_add_f32 v[242:243], v[242:243], v[118:119]
    v_pk_add_f32 v[80:81], v[80:81], v[100:101]
    v_pk_add_f32 v[244:245], v[244:245], v[120:121]
    v_pk_add_f32 v[82:83], v[82:83], v[102:103]
    v_pk_add_f32 v[246:247], v[246:247], v[122:123]
    v_pk_add_f32 v[228:229], v[228:229], v[64:65]
    v_pk_add_f32 v[230:231], v[230:231], v[66:67]
    v_pk_add_f32 v[232:233], v[232:233], v[68:69]
    v_pk_add_f32 v[234:235], v[234:235], v[70:71]
    v_pk_add_f32 v[236:237], v[236:237], v[72:73]
    v_pk_add_f32 v[238:239], v[238:239], v[74:75]
    v_pk_add_f32 v[240:241], v[240:241], v[76:77]
    v_pk_add_f32 v[242:243], v[242:243], v[78:79]
    v_pk_add_f32 v[244:245], v[244:245], v[80:81]
    v_pk_add_f32 v[246:247], v[246:247], v[82:83]
    v_mov_b32 v14, v7
    v_pk_fma_f32 v[32:33], v[228:229], v[14:15], v[32:33] op_sel_hi:[1,0,1]
    v_pk_fma_f32 v[34:35], v[230:231], v[14:15], v[34:35] op_sel_hi:[1,0,1]
    v_pk_fma_f32 v[36:37], v[232:233], v[14:15], v[36:37] op_sel_hi:[1,0,1]
    v_pk_fma_f32 v[38:39], v[234:235], v[14:15], v[38:39] op_sel_hi:[1,0,1]
    v_pk_fma_f32 v[40:41], v[236:237], v[14:15], v[40:41] op_sel_hi:[1,0,1]
    v_pk_fma_f32 v[42:43], v[238:239], v[14:15], v[42:43] op_sel_hi:[1,0,1]
    v_pk_fma_f32 v[44:45], v[240:241], v[14:15], v[44:45] op_sel_hi:[1,0,1]
    v_pk_fma_f32 v[46:47], v[242:243], v[14:15], v[46:47] op_sel_hi:[1,0,1]
    v_pk_fma_f32 v[48:49], v[244:245], v[14:15], v[48:49] op_sel_hi:[1,0,1]
    v_pk_fma_f32 v[50:51], v[246:247], v[14:15], v[50:51] op_sel_hi:[1,0,1]
    v_cvt_pk_bf16_f32 v64, v32, v36
    v_cvt_pk_bf16_f32 v65, v33, v37
    v_cvt_pk_bf16_f32 v66, v34, v38
    v_cvt_pk_bf16_f32 v67, v35, v39
    v_cvt_pk_bf16_f32 v68, v40, v44
    v_cvt_pk_bf16_f32 v69, v41, v45
    v_cvt_pk_bf16_f32 v70, v42, v46
    v_cvt_pk_bf16_f32 v71, v43, v47
    v_cvt_pk_bf16_f32 v72, v48, v49
    v_cvt_pk_bf16_f32 v73, v50, v51
    v_pk_add_f32 v[80:81], v[32:33], v[40:41]
    v_pk_add_f32 v[92:93], v[32:33], v[40:41] neg_lo:[0,1] neg_hi:[0,1]
    v_pk_add_f32 v[82:83], v[34:35], v[42:43]
    v_pk_add_f32 v[94:95], v[34:35], v[42:43] neg_lo:[0,1] neg_hi:[0,1]
    v_pk_add_f32 v[84:85], v[36:37], v[44:45]
    v_pk_add_f32 v[96:97], v[36:37], v[44:45] neg_lo:[0,1] neg_hi:[0,1]
    v_pk_add_f32 v[86:87], v[38:39], v[46:47]
    v_pk_add_f32 v[98:99], v[38:39], v[46:47] neg_lo:[0,1] neg_hi:[0,1]
    v_pk_add_f32 v[88:89], v[48:49], v[50:51]
    v_pk_add_f32 v[100:101], v[48:49], v[50:51] neg_lo:[0,1] neg_hi:[0,1]
    s_cmp_eq_u32 s17, 7
    s_cselect_b32 s37, 0xffff0000, 0
    s_mov_b32 s36, 0
    s_add_u32 s34, s24, 4456448
    s_add_u32 s35, s34, 20480
    v_cndmask_b32 v89, v89, v49, s[36:37]
    v_cndmask_b32 v101, v101, v51, s[36:37]
    v_cvt_pk_bf16_f32 v80, v80, v84
    v_cvt_pk_bf16_f32 v92, v92, v96
    v_cvt_pk_bf16_f32 v81, v81, v85
    v_cvt_pk_bf16_f32 v93, v93, v97
    v_cvt_pk_bf16_f32 v82, v82, v86
    v_cvt_pk_bf16_f32 v94, v94, v98
    v_cvt_pk_bf16_f32 v83, v83, v87
    v_cvt_pk_bf16_f32 v95, v95, v99
    v_cvt_pk_bf16_f32 v84, v88, v89
    v_cvt_pk_bf16_f32 v96, v100, v101
    buffer_store_dwordx4 v[80:83], v10, s[8:11], s34 offen
    buffer_store_dwordx4 v[92:95], v10, s[8:11], s35 offen
    buffer_store_dword v84, v11, s[8:11], s34 offen
    buffer_store_dword v96, v11, s[8:11], s35 offen
    v_pk_mul_f32 v[106:107], v[32:33], v[32:33]
    v_pk_add_f32 v[104:105], v[32:33], v[34:35]
    v_pk_fma_f32 v[106:107], v[34:35], v[34:35], v[106:107]
    v_pk_add_f32 v[104:105], v[104:105], v[36:37]
    v_pk_fma_f32 v[106:107], v[36:37], v[36:37], v[106:107]
    v_pk_add_f32 v[104:105], v[104:105], v[38:39]
    v_pk_fma_f32 v[106:107], v[38:39], v[38:39], v[106:107]
    v_pk_add_f32 v[104:105], v[104:105], v[40:41]
    v_pk_fma_f32 v[106:107], v[40:41], v[40:41], v[106:107]
    v_pk_add_f32 v[104:105], v[104:105], v[42:43]
    v_pk_fma_f32 v[106:107], v[42:43], v[42:43], v[106:107]
    v_pk_add_f32 v[104:105], v[104:105], v[44:45]
    v_pk_fma_f32 v[106:107], v[44:45], v[44:45], v[106:107]
    v_pk_add_f32 v[104:105], v[104:105], v[46:47]
    v_pk_fma_f32 v[106:107], v[46:47], v[46:47], v[106:107]
    v_pk_add_f32 v[104:105], v[104:105], v[48:49]
    v_pk_fma_f32 v[106:107], v[48:49], v[48:49], v[106:107]
    v_pk_add_f32 v[104:105], v[104:105], v[50:51]
    v_pk_fma_f32 v[106:107], v[50:51], v[50:51], v[106:107]
    v_add_f32 v104, v104, v105
    v_add_f32 v105, v106, v107
    s_lshl_b32 s23, s16, 12
    s_lshl_b32 s38, s17, 9
    s_add_u32 s23, s23, s38
    v_permlane32_swap_b32 v104, v105
    s_lshl_b32 s38, s18, 7
    s_add_u32 s23, s23, s38
    v_add_f32 v104, v104, v105
    s_add_u32 s23, s23, 262144
    v_mov_b32 v105, v104
    v_and_b32 v106, 15, v0
    v_lshrrev_b32 v107, 5, v0
    v_permlane16_swap_b32 v104, v105
    v_lshlrev_b32 v106, 3, v106
    v_lshl_add_u32 v106, v107, 2, v106
    v_add_f32 v104, v104, v105
    buffer_store_dword v104, v106, s[8:11], s23 offen
    s_add_u32 s34, s24, 7077888
    s_add_u32 s35, s34, 40960
    buffer_store_dwordx4 v[64:67], v8, s[8:11], s34 offen
    buffer_store_dwordx4 v[68:71], v8, s[8:11], s35 offen
    buffer_store_dword v72, v9, s[8:11], s34 offen
    buffer_store_dword v73, v9, s[8:11], s35 offen
    s_mul_i32 s34, s19, 40960
    s_add_u32 s34, s34, s24
    s_lshl_b32 s36, s18, 10
    s_add_u32 s34, s34, s36
    s_add_u32 s34, s34, 4456448
    s_add_u32 s35, s34, 20480
    s_cmp_eq_u32 s18, 3
    s_cbranch_scc1 k2_w384
    s_cmp_ge_u32 s18, s22
    s_cbranch_scc1 k2_g086
    s_lshl_b32 s23, s21, 5
    s_add_u32 s23, s23, 1
    v_and_b32 v210, 31, v0
    v_add_u32 v210, s23, v210
    v_cvt_f32_u32 v210, v210
    v_mul_f32 v210, 0x3acccccd, v210
    v_lshrrev_b32 v211, 5, v0
    v_lshlrev_b32 v211, 3, v211
    v_add_u32 v211, 1, v211
    v_cvt_f32_u32 v211, v211
    v_mul_f32 v211, v211, v210
    v_mul_f32 v212, 0x41800000, v210
    v_cos_f32 v208, v212
    v_add_f32 v213, v211, v212
    v_add_f32 v208, v208, v208
    v_cos_f32 v176, v211
    v_sin_f32 v177, v211
    v_cos_f32 v192, v213
    v_sin_f32 v193, v213
    v_add_f32 v211, v211, v210
    v_add_f32 v213, v213, v210
    v_cos_f32 v178, v211
    v_sin_f32 v179, v211
    v_cos_f32 v194, v213
    v_sin_f32 v195, v213
    v_add_f32 v211, v211, v210
    v_add_f32 v213, v213, v210
    v_cos_f32 v180, v211
    v_sin_f32 v181, v211
    v_cos_f32 v196, v213
    v_sin_f32 v197, v213
    v_add_f32 v211, v211, v210
    v_add_f32 v213, v213, v210
    v_cos_f32 v182, v211
    v_sin_f32 v183, v211
    v_cos_f32 v198, v213
    v_sin_f32 v199, v213
    v_add_f32 v211, v211, v210
    v_add_f32 v213, v213, v210
    v_cos_f32 v184, v211
    v_sin_f32 v185, v211
    v_cos_f32 v200, v213
    v_sin_f32 v201, v213
    v_add_f32 v211, v211, v210
    v_add_f32 v213, v213, v210
    v_cos_f32 v186, v211
    v_sin_f32 v187, v211
    v_cos_f32 v202, v213
    v_sin_f32 v203, v213
    v_add_f32 v211, v211, v210
    v_add_f32 v213, v213, v210
    v_cos_f32 v188, v211
    v_sin_f32 v189, v211
    v_cos_f32 v204, v213
    v_sin_f32 v205, v213
    v_add_f32 v211, v211, v210
    v_add_f32 v213, v213, v210
    v_cos_f32 v190, v211
    v_sin_f32 v191, v211
    v_cos_f32 v206, v213
    v_sin_f32 v207, v213
    v_mov_b32 v209, v208
    v_cvt_pk_bf16_f32 v16, v176, v178
    v_cvt_pk_bf16_f32 v20, v177, v179
    v_cvt_pk_bf16_f32 v17, v180, v182
    v_cvt_pk_bf16_f32 v21, v181, v183
    v_cvt_pk_bf16_f32 v18, v184, v186
    v_cvt_pk_bf16_f32 v22, v185, v187
    v_cvt_pk_bf16_f32 v19, v188, v190
    v_cvt_pk_bf16_f32 v23, v189, v191
    v_cvt_pk_bf16_f32 v24, v192, v194
    v_cvt_pk_bf16_f32 v28, v193, v195
    v_cvt_pk_bf16_f32 v25, v196, v198
    v_cvt_pk_bf16_f32 v29, v197, v199
    v_cvt_pk_bf16_f32 v26, v200, v202
    v_cvt_pk_bf16_f32 v30, v201, v203
    v_cvt_pk_bf16_f32 v27, v204, v206
    v_cvt_pk_bf16_f32 v31, v205, v207
    v_pk_fma_f32 v[176:177], v[192:193], v[208:209], v[176:177] neg_lo:[0,0,1] neg_hi:[0,0,1]
    v_pk_fma_f32 v[178:179], v[194:195], v[208:209], v[178:179] neg_lo:[0,0,1] neg_hi:[0,0,1]
    v_pk_fma_f32 v[180:181], v[196:197], v[208:209], v[180:181] neg_lo:[0,0,1] neg_hi:[0,0,1]
    v_pk_fma_f32 v[182:183], v[198:199], v[208:209], v[182:183] neg_lo:[0,0,1] neg_hi:[0,0,1]
    v_pk_fma_f32 v[184:185], v[200:201], v[208:209], v[184:185] neg_lo:[0,0,1] neg_hi:[0,0,1]
    v_pk_fma_f32 v[186:187], v[202:203], v[208:209], v[186:187] neg_lo:[0,0,1] neg_hi:[0,0,1]
    v_pk_fma_f32 v[188:189], v[204:205], v[208:209], v[188:189] neg_lo:[0,0,1] neg_hi:[0,0,1]
    v_pk_fma_f32 v[190:191], v[206:207], v[208:209], v[190:191] neg_lo:[0,0,1] neg_hi:[0,0,1]
    v_cvt_pk_bf16_f32 v32, v176, v178
    v_cvt_pk_bf16_f32 v36, v177, v179
    v_cvt_pk_bf16_f32 v33, v180, v182
    v_cvt_pk_bf16_f32 v37, v181, v183
    v_cvt_pk_bf16_f32 v34, v184, v186
    v_cvt_pk_bf16_f32 v38, v185, v187
    v_cvt_pk_bf16_f32 v35, v188, v190
    v_cvt_pk_bf16_f32 v39, v189, v191
    v_pk_fma_f32 v[192:193], v[176:177], v[208:209], v[192:193] neg_lo:[0,0,1] neg_hi:[0,0,1]
    v_pk_fma_f32 v[194:195], v[178:179], v[208:209], v[194:195] neg_lo:[0,0,1] neg_hi:[0,0,1]
    v_pk_fma_f32 v[196:197], v[180:181], v[208:209], v[196:197] neg_lo:[0,0,1] neg_hi:[0,0,1]
    v_pk_fma_f32 v[198:199], v[182:183], v[208:209], v[198:199] neg_lo:[0,0,1] neg_hi:[0,0,1]
    v_pk_fma_f32 v[200:201], v[184:185], v[208:209], v[200:201] neg_lo:[0,0,1] neg_hi:[0,0,1]
    v_pk_fma_f32 v[202:203], v[186:187], v[208:209], v[202:203] neg_lo:[0,0,1] neg_hi:[0,0,1]
    v_pk_fma_f32 v[204:205], v[188:189], v[208:209], v[204:205] neg_lo:[0,0,1] neg_hi:[0,0,1]
    v_pk_fma_f32 v[206:207], v[190:191], v[208:209], v[206:207] neg_lo:[0,0,1] neg_hi:[0,0,1]
    v_cvt_pk_bf16_f32 v40, v192, v194
    v_cvt_pk_bf16_f32 v44, v193, v195
    v_cvt_pk_bf16_f32 v41, v196, v198
    v_cvt_pk_bf16_f32 v45, v197, v199
    v_cvt_pk_bf16_f32 v42, v200, v202
    v_cvt_pk_bf16_f32 v46, v201, v203
    v_cvt_pk_bf16_f32 v43, v204, v206
    v_cvt_pk_bf16_f32 v47, v205, v207
    v_pk_fma_f32 v[176:177], v[192:193], v[208:209], v[176:177] neg_lo:[0,0,1] neg_hi:[0,0,1]
    v_pk_fma_f32 v[178:179], v[194:195], v[208:209], v[178:179] neg_lo:[0,0,1] neg_hi:[0,0,1]
    v_pk_fma_f32 v[180:181], v[196:197], v[208:209], v[180:181] neg_lo:[0,0,1] neg_hi:[0,0,1]
    v_pk_fma_f32 v[182:183], v[198:199], v[208:209], v[182:183] neg_lo:[0,0,1] neg_hi:[0,0,1]
    v_pk_fma_f32 v[184:185], v[200:201], v[208:209], v[184:185] neg_lo:[0,0,1] neg_hi:[0,0,1]
    v_pk_fma_f32 v[186:187], v[202:203], v[208:209], v[186:187] neg_lo:[0,0,1] neg_hi:[0,0,1]
    v_pk_fma_f32 v[188:189], v[204:205], v[208:209], v[188:189] neg_lo:[0,0,1] neg_hi:[0,0,1]
    v_pk_fma_f32 v[190:191], v[206:207], v[208:209], v[190:191] neg_lo:[0,0,1] neg_hi:[0,0,1]
    v_cvt_pk_bf16_f32 v48, v176, v178
    v_cvt_pk_bf16_f32 v52, v177, v179
    v_cvt_pk_bf16_f32 v49, v180, v182
    v_cvt_pk_bf16_f32 v53, v181, v183
    v_cvt_pk_bf16_f32 v50, v184, v186
    v_cvt_pk_bf16_f32 v54, v185, v187
    v_cvt_pk_bf16_f32 v51, v188, v190
    v_cvt_pk_bf16_f32 v55, v189, v191
k2_g086:
    s_waitcnt vmcnt(0)
    s_add_u32 s23, s46, 3
    v_mov_b32 v14, s45
    v_mov_b32 v15, s23
    s_cmp_lg_u32 s27, 0
    s_cbranch_scc1 k2_pubs88
    s_mov_b64 exec, 1
    buffer_store_dword v15, v14, s[8:11], 0 offen offset:0
    s_mov_b64 exec, -1
k2_pub87:
    s_cmp_ge_u32 s18, s22
    s_cbranch_scc1 k2_nog89
    v_pk_fma_f32 v[192:193], v[176:177], v[208:209], v[192:193] neg_lo:[0,0,1] neg_hi:[0,0,1]
    v_pk_fma_f32 v[194:195], v[178:179], v[208:209], v[194:195] neg_lo:[0,0,1] neg_hi:[0,0,1]
    v_pk_fma_f32 v[196:197], v[180:181], v[208:209], v[196:197] neg_lo:[0,0,1] neg_hi:[0,0,1]
    v_pk_fma_f32 v[198:199], v[182:183], v[208:209], v[198:199] neg_lo:[0,0,1] neg_hi:[0,0,1]
    v_pk_fma_f32 v[200:201], v[184:185], v[208:209], v[200:201] neg_lo:[0,0,1] neg_hi:[0,0,1]
    v_pk_fma_f32 v[202:203], v[186:187], v[208:209], v[202:203] neg_lo:[0,0,1] neg_hi:[0,0,1]
    v_pk_fma_f32 v[204:205], v[188:189], v[208:209], v[204:205] neg_lo:[0,0,1] neg_hi:[0,0,1]
    v_pk_fma_f32 v[206:207], v[190:191], v[208:209], v[206:207] neg_lo:[0,0,1] neg_hi:[0,0,1]
    v_cvt_pk_bf16_f32 v56, v192, v194
    v_cvt_pk_bf16_f32 v60, v193, v195
    v_cvt_pk_bf16_f32 v57, v196, v198
    v_cvt_pk_bf16_f32 v61, v197, v199
    v_cvt_pk_bf16_f32 v58, v200, v202
    v_cvt_pk_bf16_f32 v62, v201, v203
    v_cvt_pk_bf16_f32 v59, v204, v206
    v_cvt_pk_bf16_f32 v63, v205, v207
    v_pk_fma_f32 v[176:177], v[192:193], v[208:209], v[176:177] neg_lo:[0,0,1] neg_hi:[0,0,1]
    v_pk_fma_f32 v[178:179], v[194:195], v[208:209], v[178:179] neg_lo:[0,0,1] neg_hi:[0,0,1]
    v_pk_fma_f32 v[180:181], v[196:197], v[208:209], v[180:181] neg_lo:[0,0,1] neg_hi:[0,0,1]
    v_pk_fma_f32 v[182:183], v[198:199], v[208:209], v[182:183] neg_lo:[0,0,1] neg_hi:[0,0,1]
    v_pk_fma_f32 v[184:185], v[200:201], v[208:209], v[184:185] neg_lo:[0,0,1] neg_hi:[0,0,1]
    v_pk_fma_f32 v[186:187], v[202:203], v[208:209], v[186:187] neg_lo:[0,0,1] neg_hi:[0,0,1]
    v_pk_fma_f32 v[188:189], v[204:205], v[208:209], v[188:189] neg_lo:[0,0,1] neg_hi:[0,0,1]
    v_pk_fma_f32 v[190:191], v[206:207], v[208:209], v[190:191] neg_lo:[0,0,1] neg_hi:[0,0,1]
    v_cvt_pk_bf16_f32 v64, v176, v178
    v_cvt_pk_bf16_f32 v68, v177, v179
    v_cvt_pk_bf16_f32 v65, v180, v182
    v_cvt_pk_bf16_f32 v69, v181, v183
    v_cvt_pk_bf16_f32 v66, v184, v186
    v_cvt_pk_bf16_f32 v70, v185, v187
    v_cvt_pk_bf16_f32 v67, v188, v190
    v_cvt_pk_bf16_f32 v71, v189, v191
    v_pk_fma_f32 v[192:193], v[176:177], v[208:209], v[192:193] neg_lo:[0,0,1] neg_hi:[0,0,1]
    v_pk_fma_f32 v[194:195], v[178:179], v[208:209], v[194:195] neg_lo:[0,0,1] neg_hi:[0,0,1]
    v_pk_fma_f32 v[196:197], v[180:181], v[208:209], v[196:197] neg_lo:[0,0,1] neg_hi:[0,0,1]
    v_pk_fma_f32 v[198:199], v[182:183], v[208:209], v[198:199] neg_lo:[0,0,1] neg_hi:[0,0,1]
    v_pk_fma_f32 v[200:201], v[184:185], v[208:209], v[200:201] neg_lo:[0,0,1] neg_hi:[0,0,1]
    v_pk_fma_f32 v[202:203], v[186:187], v[208:209], v[202:203] neg_lo:[0,0,1] neg_hi:[0,0,1]
    v_pk_fma_f32 v[204:205], v[188:189], v[208:209], v[204:205] neg_lo:[0,0,1] neg_hi:[0,0,1]
    v_pk_fma_f32 v[206:207], v[190:191], v[208:209], v[206:207] neg_lo:[0,0,1] neg_hi:[0,0,1]
    v_cvt_pk_bf16_f32 v72, v192, v194
    v_cvt_pk_bf16_f32 v76, v193, v195
    v_cvt_pk_bf16_f32 v73, v196, v198
    v_cvt_pk_bf16_f32 v77, v197, v199
    v_cvt_pk_bf16_f32 v74, v200, v202
    v_cvt_pk_bf16_f32 v78, v201, v203
    v_cvt_pk_bf16_f32 v75, v204, v206
    v_cvt_pk_bf16_f32 v79, v205, v207
    v_pk_fma_f32 v[176:177], v[192:193], v[208:209], v[176:177] neg_lo:[0,0,1] neg_hi:[0,0,1]
    v_pk_fma_f32 v[178:179], v[194:195], v[208:209], v[178:179] neg_lo:[0,0,1] neg_hi:[0,0,1]
    v_pk_fma_f32 v[180:181], v[196:197], v[208:209], v[180:181] neg_lo:[0,0,1] neg_hi:[0,0,1]
    v_pk_fma_f32 v[182:183], v[198:199], v[208:209], v[182:183] neg_lo:[0,0,1] neg_hi:[0,0,1]
    v_pk_fma_f32 v[184:185], v[200:201], v[208:209], v[184:185] neg_lo:[0,0,1] neg_hi:[0,0,1]
    v_pk_fma_f32 v[186:187], v[202:203], v[208:209], v[186:187] neg_lo:[0,0,1] neg_hi:[0,0,1]
    v_pk_fma_f32 v[188:189], v[204:205], v[208:209], v[188:189] neg_lo:[0,0,1] neg_hi:[0,0,1]
    v_pk_fma_f32 v[190:191], v[206:207], v[208:209], v[190:191] neg_lo:[0,0,1] neg_hi:[0,0,1]
    v_cvt_pk_bf16_f32 v80, v176, v178
    v_cvt_pk_bf16_f32 v84, v177, v179
    v_cvt_pk_bf16_f32 v81, v180, v182
    v_cvt_pk_bf16_f32 v85, v181, v183
    v_cvt_pk_bf16_f32 v82, v184, v186
    v_cvt_pk_bf16_f32 v86, v185, v187
    v_cvt_pk_bf16_f32 v83, v188, v190
    v_cvt_pk_bf16_f32 v87, v189, v191
    v_pk_fma_f32 v[192:193], v[176:177], v[208:209], v[192:193] neg_lo:[0,0,1] neg_hi:[0,0,1]
    v_pk_fma_f32 v[194:195], v[178:179], v[208:209], v[194:195] neg_lo:[0,0,1] neg_hi:[0,0,1]
    v_pk_fma_f32 v[196:197], v[180:181], v[208:209], v[196:197] neg_lo:[0,0,1] neg_hi:[0,0,1]
    v_pk_fma_f32 v[198:199], v[182:183], v[208:209], v[198:199] neg_lo:[0,0,1] neg_hi:[0,0,1]
    v_pk_fma_f32 v[200:201], v[184:185], v[208:209], v[200:201] neg_lo:[0,0,1] neg_hi:[0,0,1]
    v_pk_fma_f32 v[202:203], v[186:187], v[208:209], v[202:203] neg_lo:[0,0,1] neg_hi:[0,0,1]
    v_pk_fma_f32 v[204:205], v[188:189], v[208:209], v[204:205] neg_lo:[0,0,1] neg_hi:[0,0,1]
    v_pk_fma_f32 v[206:207], v[190:191], v[208:209], v[206:207] neg_lo:[0,0,1] neg_hi:[0,0,1]
    v_cvt_pk_bf16_f32 v88, v192, v194
    v_cvt_pk_bf16_f32 v92, v193, v195
    v_cvt_pk_bf16_f32 v89, v196, v198
    v_cvt_pk_bf16_f32 v93, v197, v199
    v_cvt_pk_bf16_f32 v90, v200, v202
    v_cvt_pk_bf16_f32 v94, v201, v203
    v_cvt_pk_bf16_f32 v91, v204, v206
    v_cvt_pk_bf16_f32 v95, v205, v207
    v_pk_fma_f32 v[176:177], v[192:193], v[208:209], v[176:177] neg_lo:[0,0,1] neg_hi:[0,0,1]
    v_pk_fma_f32 v[178:179], v[194:195], v[208:209], v[178:179] neg_lo:[0,0,1] neg_hi:[0,0,1]
    v_pk_fma_f32 v[180:181], v[196:197], v[208:209], v[180:181] neg_lo:[0,0,1] neg_hi:[0,0,1]
    v_pk_fma_f32 v[182:183], v[198:199], v[208:209], v[182:183] neg_lo:[0,0,1] neg_hi:[0,0,1]
    v_pk_fma_f32 v[184:185], v[200:201], v[208:209], v[184:185] neg_lo:[0,0,1] neg_hi:[0,0,1]
    v_pk_fma_f32 v[186:187], v[202:203], v[208:209], v[186:187] neg_lo:[0,0,1] neg_hi:[0,0,1]
    v_pk_fma_f32 v[188:189], v[204:205], v[208:209], v[188:189] neg_lo:[0,0,1] neg_hi:[0,0,1]
    v_pk_fma_f32 v[190:191], v[206:207], v[208:209], v[190:191] neg_lo:[0,0,1] neg_hi:[0,0,1]
    v_cvt_pk_bf16_f32 v96, v176, v178
    v_cvt_pk_bf16_f32 v100, v177, v179
    v_cvt_pk_bf16_f32 v97, v180, v182
    v_cvt_pk_bf16_f32 v101, v181, v183
    v_cvt_pk_bf16_f32 v98, v184, v186
    v_cvt_pk_bf16_f32 v102, v185, v187
    v_cvt_pk_bf16_f32 v99, v188, v190
    v_cvt_pk_bf16_f32 v103, v189, v191
    v_pk_fma_f32 v[192:193], v[176:177], v[208:209], v[192:193] neg_lo:[0,0,1] neg_hi:[0,0,1]
    v_pk_fma_f32 v[194:195], v[178:179], v[208:209], v[194:195] neg_lo:[0,0,1] neg_hi:[0,0,1]
    v_pk_fma_f32 v[196:197], v[180:181], v[208:209], v[196:197] neg_lo:[0,0,1] neg_hi:[0,0,1]
    v_pk_fma_f32 v[198:199], v[182:183], v[208:209], v[198:199] neg_lo:[0,0,1] neg_hi:[0,0,1]
    v_pk_fma_f32 v[200:201], v[184:185], v[208:209], v[200:201] neg_lo:[0,0,1] neg_hi:[0,0,1]
    v_pk_fma_f32 v[202:203], v[186:187], v[208:209], v[202:203] neg_lo:[0,0,1] neg_hi:[0,0,1]
    v_pk_fma_f32 v[204:205], v[188:189], v[208:209], v[204:205] neg_lo:[0,0,1] neg_hi:[0,0,1]
    v_pk_fma_f32 v[206:207], v[190:191], v[208:209], v[206:207] neg_lo:[0,0,1] neg_hi:[0,0,1]
    v_cvt_pk_bf16_f32 v104, v192, v194
    v_cvt_pk_bf16_f32 v108, v193, v195
    v_cvt_pk_bf16_f32 v105, v196, v198
    v_cvt_pk_bf16_f32 v109, v197, v199
    v_cvt_pk_bf16_f32 v106, v200, v202
    v_cvt_pk_bf16_f32 v110, v201, v203
    v_cvt_pk_bf16_f32 v107, v204, v206
    v_cvt_pk_bf16_f32 v111, v205, v207
    v_pk_fma_f32 v[176:177], v[192:193], v[208:209], v[176:177] neg_lo:[0,0,1] neg_hi:[0,0,1]
    v_pk_fma_f32 v[178:179], v[194:195], v[208:209], v[178:179] neg_lo:[0,0,1] neg_hi:[0,0,1]
    v_pk_fma_f32 v[180:181], v[196:197], v[208:209], v[180:181] neg_lo:[0,0,1] neg_hi:[0,0,1]
    v_pk_fma_f32 v[182:183], v[198:199], v[208:209], v[182:183] neg_lo:[0,0,1] neg_hi:[0,0,1]
    v_pk_fma_f32 v[184:185], v[200:201], v[208:209], v[184:185] neg_lo:[0,0,1] neg_hi:[0,0,1]
    v_pk_fma_f32 v[186:187], v[202:203], v[208:209], v[186:187] neg_lo:[0,0,1] neg_hi:[0,0,1]
    v_pk_fma_f32 v[188:189], v[204:205], v[208:209], v[188:189] neg_lo:[0,0,1] neg_hi:[0,0,1]
    v_pk_fma_f32 v[190:191], v[206:207], v[208:209], v[190:191] neg_lo:[0,0,1] neg_hi:[0,0,1]
    v_cvt_pk_bf16_f32 v112, v176, v178
    v_cvt_pk_bf16_f32 v116, v177, v179
    v_cvt_pk_bf16_f32 v113, v180, v182
    v_cvt_pk_bf16_f32 v117, v181, v183
    v_cvt_pk_bf16_f32 v114, v184, v186
    v_cvt_pk_bf16_f32 v118, v185, v187
    v_cvt_pk_bf16_f32 v115, v188, v190
    v_cvt_pk_bf16_f32 v119, v189, v191
    v_pk_fma_f32 v[192:193], v[176:177], v[208:209], v[192:193] neg_lo:[0,0,1] neg_hi:[0,0,1]
    v_pk_fma_f32 v[194:195], v[178:179], v[208:209], v[194:195] neg_lo:[0,0,1] neg_hi:[0,0,1]
    v_pk_fma_f32 v[196:197], v[180:181], v[208:209], v[196:197] neg_lo:[0,0,1] neg_hi:[0,0,1]
    v_pk_fma_f32 v[198:199], v[182:183], v[208:209], v[198:199] neg_lo:[0,0,1] neg_hi:[0,0,1]
    v_pk_fma_f32 v[200:201], v[184:185], v[208:209], v[200:201] neg_lo:[0,0,1] neg_hi:[0,0,1]
    v_pk_fma_f32 v[202:203], v[186:187], v[208:209], v[202:203] neg_lo:[0,0,1] neg_hi:[0,0,1]
    v_pk_fma_f32 v[204:205], v[188:189], v[208:209], v[204:205] neg_lo:[0,0,1] neg_hi:[0,0,1]
    v_pk_fma_f32 v[206:207], v[190:191], v[208:209], v[206:207] neg_lo:[0,0,1] neg_hi:[0,0,1]
    v_cvt_pk_bf16_f32 v120, v192, v194
    v_cvt_pk_bf16_f32 v124, v193, v195
    v_cvt_pk_bf16_f32 v121, v196, v198
    v_cvt_pk_bf16_f32 v125, v197, v199
    v_cvt_pk_bf16_f32 v122, v200, v202
    v_cvt_pk_bf16_f32 v126, v201, v203
    v_cvt_pk_bf16_f32 v123, v204, v206
    v_cvt_pk_bf16_f32 v127, v205, v207
    v_pk_fma_f32 v[176:177], v[192:193], v[208:209], v[176:177] neg_lo:[0,0,1] neg_hi:[0,0,1]
    v_pk_fma_f32 v[178:179], v[194:195], v[208:209], v[178:179] neg_lo:[0,0,1] neg_hi:[0,0,1]
    v_pk_fma_f32 v[180:181], v[196:197], v[208:209], v[180:181] neg_lo:[0,0,1] neg_hi:[0,0,1]
    v_pk_fma_f32 v[182:183], v[198:199], v[208:209], v[182:183] neg_lo:[0,0,1] neg_hi:[0,0,1]
    v_pk_fma_f32 v[184:185], v[200:201], v[208:209], v[184:185] neg_lo:[0,0,1] neg_hi:[0,0,1]
    v_pk_fma_f32 v[186:187], v[202:203], v[208:209], v[186:187] neg_lo:[0,0,1] neg_hi:[0,0,1]
    v_pk_fma_f32 v[188:189], v[204:205], v[208:209], v[188:189] neg_lo:[0,0,1] neg_hi:[0,0,1]
    v_pk_fma_f32 v[190:191], v[206:207], v[208:209], v[190:191] neg_lo:[0,0,1] neg_hi:[0,0,1]
    v_cvt_pk_bf16_f32 v128, v176, v178
    v_cvt_pk_bf16_f32 v132, v177, v179
    v_cvt_pk_bf16_f32 v129, v180, v182
    v_cvt_pk_bf16_f32 v133, v181, v183
    v_cvt_pk_bf16_f32 v130, v184, v186
    v_cvt_pk_bf16_f32 v134, v185, v187
    v_cvt_pk_bf16_f32 v131, v188, v190
    v_cvt_pk_bf16_f32 v135, v189, v191
    v_pk_fma_f32 v[192:193], v[176:177], v[208:209], v[192:193] neg_lo:[0,0,1] neg_hi:[0,0,1]
    v_pk_fma_f32 v[194:195], v[178:179], v[208:209], v[194:195] neg_lo:[0,0,1] neg_hi:[0,0,1]
    v_pk_fma_f32 v[196:197], v[180:181], v[208:209], v[196:197] neg_lo:[0,0,1] neg_hi:[0,0,1]
    v_pk_fma_f32 v[198:199], v[182:183], v[208:209], v[198:199] neg_lo:[0,0,1] neg_hi:[0,0,1]
    v_pk_fma_f32 v[200:201], v[184:185], v[208:209], v[200:201] neg_lo:[0,0,1] neg_hi:[0,0,1]
    v_pk_fma_f32 v[202:203], v[186:187], v[208:209], v[202:203] neg_lo:[0,0,1] neg_hi:[0,0,1]
    v_pk_fma_f32 v[204:205], v[188:189], v[208:209], v[204:205] neg_lo:[0,0,1] neg_hi:[0,0,1]
    v_pk_fma_f32 v[206:207], v[190:191], v[208:209], v[206:207] neg_lo:[0,0,1] neg_hi:[0,0,1]
    v_cvt_pk_bf16_f32 v136, v192, v194
    v_cvt_pk_bf16_f32 v140, v193, v195
    v_cvt_pk_bf16_f32 v137, v196, v198
    v_cvt_pk_bf16_f32 v141, v197, v199
    v_cvt_pk_bf16_f32 v138, v200, v202
    v_cvt_pk_bf16_f32 v142, v201, v203
    v_cvt_pk_bf16_f32 v139, v204, v206
    v_cvt_pk_bf16_f32 v143, v205, v207
    v_pk_fma_f32 v[176:177], v[192:193], v[208:209], v[176:177] neg_lo:[0,0,1] neg_hi:[0,0,1]
    v_pk_fma_f32 v[178:179], v[194:195], v[208:209], v[178:179] neg_lo:[0,0,1] neg_hi:[0,0,1]
    v_pk_fma_f32 v[180:181], v[196:197], v[208:209], v[180:181] neg_lo:[0,0,1] neg_hi:[0,0,1]
    v_pk_fma_f32 v[182:183], v[198:199], v[208:209], v[182:183] neg_lo:[0,0,1] neg_hi:[0,0,1]
    v_pk_fma_f32 v[184:185], v[200:201], v[208:209], v[184:185] neg_lo:[0,0,1] neg_hi:[0,0,1]
    v_pk_fma_f32 v[186:187], v[202:203], v[208:209], v[186:187] neg_lo:[0,0,1] neg_hi:[0,0,1]
    v_pk_fma_f32 v[188:189], v[204:205], v[208:209], v[188:189] neg_lo:[0,0,1] neg_hi:[0,0,1]
    v_pk_fma_f32 v[190:191], v[206:207], v[208:209], v[190:191] neg_lo:[0,0,1] neg_hi:[0,0,1]
    v_cvt_pk_bf16_f32 v144, v176, v178
    v_cvt_pk_bf16_f32 v148, v177, v179
    v_cvt_pk_bf16_f32 v145, v180, v182
    v_cvt_pk_bf16_f32 v149, v181, v183
    v_cvt_pk_bf16_f32 v146, v184, v186
    v_cvt_pk_bf16_f32 v150, v185, v187
    v_cvt_pk_bf16_f32 v147, v188, v190
    v_cvt_pk_bf16_f32 v151, v189, v191
    v_pk_fma_f32 v[192:193], v[176:177], v[208:209], v[192:193] neg_lo:[0,0,1] neg_hi:[0,0,1]
    v_pk_fma_f32 v[194:195], v[178:179], v[208:209], v[194:195] neg_lo:[0,0,1] neg_hi:[0,0,1]
    v_pk_fma_f32 v[196:197], v[180:181], v[208:209], v[196:197] neg_lo:[0,0,1] neg_hi:[0,0,1]
    v_pk_fma_f32 v[198:199], v[182:183], v[208:209], v[198:199] neg_lo:[0,0,1] neg_hi:[0,0,1]
    v_pk_fma_f32 v[200:201], v[184:185], v[208:209], v[200:201] neg_lo:[0,0,1] neg_hi:[0,0,1]
    v_pk_fma_f32 v[202:203], v[186:187], v[208:209], v[202:203] neg_lo:[0,0,1] neg_hi:[0,0,1]
    v_pk_fma_f32 v[204:205], v[188:189], v[208:209], v[204:205] neg_lo:[0,0,1] neg_hi:[0,0,1]
    v_pk_fma_f32 v[206:207], v[190:191], v[208:209], v[206:207] neg_lo:[0,0,1] neg_hi:[0,0,1]
    v_cvt_pk_bf16_f32 v152, v192, v194
    v_cvt_pk_bf16_f32 v156, v193, v195
    v_cvt_pk_bf16_f32 v153, v196, v198
    v_cvt_pk_bf16_f32 v157, v197, v199
    v_cvt_pk_bf16_f32 v154, v200, v202
    v_cvt_pk_bf16_f32 v158, v201, v203
    v_cvt_pk_bf16_f32 v155, v204, v206
    v_cvt_pk_bf16_f32 v159, v205, v207
    v_pk_fma_f32 v[176:177], v[192:193], v[208:209], v[176:177] neg_lo:[0,0,1] neg_hi:[0,0,1]
    v_pk_fma_f32 v[178:179], v[194:195], v[208:209], v[178:179] neg_lo:[0,0,1] neg_hi:[0,0,1]
    v_pk_fma_f32 v[180:181], v[196:197], v[208:209], v[180:181] neg_lo:[0,0,1] neg_hi:[0,0,1]
    v_pk_fma_f32 v[182:183], v[198:199], v[208:209], v[182:183] neg_lo:[0,0,1] neg_hi:[0,0,1]
    v_pk_fma_f32 v[184:185], v[200:201], v[208:209], v[184:185] neg_lo:[0,0,1] neg_hi:[0,0,1]
    v_pk_fma_f32 v[186:187], v[202:203], v[208:209], v[186:187] neg_lo:[0,0,1] neg_hi:[0,0,1]
    v_pk_fma_f32 v[188:189], v[204:205], v[208:209], v[188:189] neg_lo:[0,0,1] neg_hi:[0,0,1]
    v_pk_fma_f32 v[190:191], v[206:207], v[208:209], v[190:191] neg_lo:[0,0,1] neg_hi:[0,0,1]
    v_cvt_pk_bf16_f32 v160, v176, v178
    v_cvt_pk_bf16_f32 v164, v177, v179
    v_cvt_pk_bf16_f32 v161, v180, v182
    v_cvt_pk_bf16_f32 v165, v181, v183
    v_cvt_pk_bf16_f32 v162, v184, v186
    v_cvt_pk_bf16_f32 v166, v185, v187
    v_cvt_pk_bf16_f32 v163, v188, v190
    v_cvt_pk_bf16_f32 v167, v189, v191
    v_pk_fma_f32 v[192:193], v[176:177], v[208:209], v[192:193] neg_lo:[0,0,1] neg_hi:[0,0,1]
    v_pk_fma_f32 v[194:195], v[178:179], v[208:209], v[194:195] neg_lo:[0,0,1] neg_hi:[0,0,1]
    v_pk_fma_f32 v[196:197], v[180:181], v[208:209], v[196:197] neg_lo:[0,0,1] neg_hi:[0,0,1]
    v_pk_fma_f32 v[198:199], v[182:183], v[208:209], v[198:199] neg_lo:[0,0,1] neg_hi:[0,0,1]
    v_pk_fma_f32 v[200:201], v[184:185], v[208:209], v[200:201] neg_lo:[0,0,1] neg_hi:[0,0,1]
    v_pk_fma_f32 v[202:203], v[186:187], v[208:209], v[202:203] neg_lo:[0,0,1] neg_hi:[0,0,1]
    v_pk_fma_f32 v[204:205], v[188:189], v[208:209], v[204:205] neg_lo:[0,0,1] neg_hi:[0,0,1]
    v_pk_fma_f32 v[206:207], v[190:191], v[208:209], v[206:207] neg_lo:[0,0,1] neg_hi:[0,0,1]
    v_cvt_pk_bf16_f32 v168, v192, v194
    v_cvt_pk_bf16_f32 v172, v193, v195
    v_cvt_pk_bf16_f32 v169, v196, v198
    v_cvt_pk_bf16_f32 v173, v197, v199
    v_cvt_pk_bf16_f32 v170, v200, v202
    v_cvt_pk_bf16_f32 v174, v201, v203
    v_cvt_pk_bf16_f32 v171, v204, v206
    v_cvt_pk_bf16_f32 v175, v205, v207
k2_nog89:
    s_branch k2_sb85
k2_w384:
    s_waitcnt vmcnt(0)
    s_add_u32 s23, s46, 3
    v_mov_b32 v14, s45
    v_mov_b32 v15, s23
    s_cmp_lg_u32 s27, 0
    s_cbranch_scc1 k2_pubs91
    s_mov_b64 exec, 1
    buffer_store_dword v15, v14, s[8:11], 0 offen offset:0
    s_mov_b64 exec, -1
k2_pub90:
    s_mov_b32 s38, 0
    s_add_u32 s23, s46, 3
k2_poll92:
    buffer_load_dwordx4 v[252:255], v12, s[8:11], 0 offen offset:0 sc1
    s_add_u32 s38, s38, 1
    s_cmp_gt_u32 s38, 60000
    s_cbranch_scc1 k2_pout93
    s_waitcnt vmcnt(0)
    v_subrev_u32 v252, s23, v252
    v_subrev_u32 v253, s23, v253
    v_subrev_u32 v254, s23, v254
    v_subrev_u32 v255, s23, v255
    v_max3_u32 v252, v252, v253, v254
    v_max_u32 v252, v252, v255
    v_cmp_lt_u32 vcc, 15, v252
    s_cbranch_vccnz k2_poll92
k2_pout93:
k2_sb85:
    s_waitcnt lgkmcnt(0)
    s_barrier
    s_cmp_lg_u32 s27, 0
    s_cbranch_scc1 k2_acqs95
k2_acq94:
    s_add_u32 m0, s36, 0
    s_nop 0
    buffer_load_dwordx4 v1, s[8:11], s34 offen sc1 lds
    s_add_u32 m0, s36, 20480
    s_add_u32 s34, s34, 4096
    buffer_load_dwordx4 v1, s[8:11], s35 offen sc1 lds
    s_add_u32 m0, s36, 4096
    s_add_u32 s35, s35, 4096
    buffer_load_dwordx4 v1, s[8:11], s34 offen sc1 lds
    s_add_u32 m0, s36, 24576
    s_add_u32 s34, s34, 4096
    buffer_load_dwordx4 v1, s[8:11], s35 offen sc1 lds
    s_add_u32 m0, s36, 8192
    s_add_u32 s35, s35, 4096
    buffer_load_dwordx4 v1, s[8:11], s34 offen sc1 lds
    s_add_u32 m0, s36, 28672
    s_add_u32 s34, s34, 4096
    buffer_load_dwordx4 v1, s[8:11], s35 offen sc1 lds
    s_add_u32 m0, s36, 12288
    s_add_u32 s35, s35, 4096
    buffer_load_dwordx4 v1, s[8:11], s34 offen sc1 lds
    s_add_u32 m0, s36, 32768
    s_add_u32 s34, s34, 4096
    buffer_load_dwordx4 v1, s[8:11], s35 offen sc1 lds
    s_add_u32 m0, s36, 16384
    s_add_u32 s35, s35, 4096
    buffer_load_dwordx4 v1, s[8:11], s34 offen sc1 lds
    s_add_u32 m0, s36, 36864
    s_add_u32 s34, s34, 4096
    buffer_load_dwordx4 v1, s[8:11], s35 offen sc1 lds
    s_cmp_ge_u32 s18, s22
    s_cbranch_scc1 k2_nou96
    v_mov_b32 v10, v13
    v_lshrrev_b32 v9, 5, v0
    v_lshlrev_b32 v9, 4, v9
    v_add_u32 v9, 159744, v9
    s_mul_i32 s32, s21, 8192
    s_lshl_b32 s33, s20, 7
    s_add_u32 s32, s32, s33
    s_add_u32 s32, s32, 12320768
    v_and_b32 v14, 31, v0
    v_lshlrev_b32 v14, 4, v14
    v_lshrrev_b32 v15, 5, v0
    v_mul_u32_u24 v13, 512, v15
    v_add_u32 v14, v14, v13
    s_waitcnt vmcnt(8)
    s_barrier
    ds_read_b128 v[208:211], v14 offset:0
    ds_read_b128 v[212:215], v14 offset:20480
    ds_read_b128 v[216:219], v14 offset:1024
    ds_read_b128 v[220:223], v14 offset:21504
    v_mov_b32 v240, 0
    v_mov_b32 v241, 0
    v_mov_b32 v242, 0
    v_mul_u32_u24 v243, 0x3f8000, v15
    v_lshlrev_b32 v243, 8, v243
    s_waitcnt lgkmcnt(2)
    v_mfma_f32_32x32x16_bf16 v[176:191], v[208:211], v[16:19], 0
    v_mfma_f32_32x32x16_bf16 v[192:207], v[212:215], v[20:23], 0
    ds_read_b128 v[208:211], v14 offset:2048
    ds_read_b128 v[212:215], v14 offset:22528
    s_waitcnt lgkmcnt(2)
    v_mfma_f32_32x32x16_bf16 v[176:191], v[216:219], v[24:27], v[176:191]
    v_mfma_f32_32x32x16_bf16 v[192:207], v[220:223], v[28:31], v[192:207]
    ds_read_b128 v[216:219], v14 offset:3072
    ds_read_b128 v[220:223], v14 offset:23552
    s_waitcnt lgkmcnt(2)
    v_mfma_f32_32x32x16_bf16 v[176:191], v[208:211], v[32:35], v[176:191]
    v_mfma_f32_32x32x16_bf16 v[192:207], v[212:215], v[36:39], v[192:207]
    s_waitcnt vmcnt(6)
    s_barrier
    ds_read_b128 v[208:211], v14 offset:4096
    ds_read_b128 v[212:215], v14 offset:24576
    s_waitcnt lgkmcnt(2)
    v_mfma_f32_32x32x16_bf16 v[176:191], v[216:219], v[40:43], v[176:191]
    v_mfma_f32_32x32x16_bf16 v[192:207], v[220:223], v[44:47], v[192:207]
    ds_read_b128 v[216:219], v14 offset:5120
    ds_read_b128 v[220:223], v14 offset:25600
    s_waitcnt lgkmcnt(2)
    v_mfma_f32_32x32x16_bf16 v[176:191], v[208:211], v[48:51], v[176:191]
    v_mfma_f32_32x32x16_bf16 v[192:207], v[212:215], v[52:55], v[192:207]
    ds_read_b128 v[208:211], v14 offset:6144
    ds_read_b128 v[212:215], v14 offset:26624
    s_waitcnt lgkmcnt(2)
    v_mfma_f32_32x32x16_bf16 v[176:191], v[216:219], v[56:59], v[176:191]
    v_mfma_f32_32x32x16_bf16 v[192:207], v[220:223], v[60:63], v[192:207]
    ds_read_b128 v[216:219], v14 offset:7168
    ds_read_b128 v[220:223], v14 offset:27648
    s_waitcnt lgkmcnt(2)
    v_mfma_f32_32x32x16_bf16 v[176:191], v[208:211], v[64:67], v[176:191]
    v_mfma_f32_32x32x16_bf16 v[192:207], v[212:215], v[68:71], v[192:207]
    s_waitcnt vmcnt(4)
    s_barrier
    ds_read_b128 v[208:211], v14 offset:8192
    ds_read_b128 v[212:215], v14 offset:28672
    s_waitcnt lgkmcnt(2)
    v_mfma_f32_32x32x16_bf16 v[176:191], v[216:219], v[72:75], v[176:191]
    v_mfma_f32_32x32x16_bf16 v[192:207], v[220:223], v[76:79], v[192:207]
    ds_read_b128 v[216:219], v14 offset:9216
    ds_read_b128 v[220:223], v14 offset:29696
    s_waitcnt lgkmcnt(2)
    v_mfma_f32_32x32x16_bf16 v[176:191], v[208:211], v[80:83], v[176:191]
    v_mfma_f32_32x32x16_bf16 v[192:207], v[212:215], v[84:87], v[192:207]
    ds_read_b128 v[208:211], v14 offset:10240
    ds_read_b128 v[212:215], v14 offset:30720
    s_waitcnt lgkmcnt(2)
    v_mfma_f32_32x32x16_bf16 v[176:191], v[216:219], v[88:91], v[176:191]
    v_mfma_f32_32x32x16_bf16 v[192:207], v[220:223], v[92:95], v[192:207]
    ds_read_b128 v[216:219], v14 offset:11264
    ds_read_b128 v[220:223], v14 offset:31744
    s_waitcnt lgkmcnt(2)
    v_mfma_f32_32x32x16_bf16 v[176:191], v[208:211], v[96:99], v[176:191]
    v_mfma_f32_32x32x16_bf16 v[192:207], v[212:215], v[100:103], v[192:207]
    s_waitcnt vmcnt(2)
    s_barrier
    ds_read_b128 v[208:211], v14 offset:12288
    ds_read_b128 v[212:215], v14 offset:32768
    s_waitcnt lgkmcnt(2)
    v_mfma_f32_32x32x16_bf16 v[176:191], v[216:219], v[104:107], v[176:191]
    v_mfma_f32_32x32x16_bf16 v[192:207], v[220:223], v[108:111], v[192:207]
    ds_read_b128 v[216:219], v14 offset:13312
    ds_read_b128 v[220:223], v14 offset:33792
    s_waitcnt lgkmcnt(2)
    v_mfma_f32_32x32x16_bf16 v[176:191], v[208:211], v[112:115], v[176:191]
    v_mfma_f32_32x32x16_bf16 v[192:207], v[212:215], v[116:119], v[192:207]
    ds_read_b128 v[208:211], v14 offset:14336
    ds_read_b128 v[212:215], v14 offset:34816
    s_waitcnt lgkmcnt(2)
    v_mfma_f32_32x32x16_bf16 v[176:191], v[216:219], v[120:123], v[176:191]
    v_mfma_f32_32x32x16_bf16 v[192:207], v[220:223], v[124:127], v[192:207]
    ds_read_b128 v[216:219], v14 offset:15360
    ds_read_b128 v[220:223], v14 offset:35840
    s_waitcnt lgkmcnt(2)
    v_mfma_f32_32x32x16_bf16 v[176:191], v[208:211], v[128:131], v[176:191]
    v_mfma_f32_32x32x16_bf16 v[192:207], v[212:215], v[132:135], v[192:207]
    s_waitcnt vmcnt(0)
    s_barrier
    ds_read_b128 v[208:211], v14 offset:16384
    ds_read_b128 v[212:215], v14 offset:36864
    s_waitcnt lgkmcnt(2)
    v_mfma_f32_32x32x16_bf16 v[176:191], v[216:219], v[136:139], v[176:191]
    v_mfma_f32_32x32x16_bf16 v[192:207], v[220:223], v[140:143], v[192:207]
    ds_read_b128 v[216:219], v14 offset:17408
    ds_read_b128 v[220:223], v14 offset:37888
    s_waitcnt lgkmcnt(2)
    v_mfma_f32_32x32x16_bf16 v[176:191], v[208:211], v[144:147], v[176:191]
    v_mfma_f32_32x32x16_bf16 v[192:207], v[212:215], v[148:151], v[192:207]
    ds_read_b128 v[208:211], v14 offset:18432
    ds_read_b128 v[212:215], v14 offset:38912
    s_waitcnt lgkmcnt(2)
    v_mfma_f32_32x32x16_bf16 v[176:191], v[216:219], v[152:155], v[176:191]
    v_mfma_f32_32x32x16_bf16 v[192:207], v[220:223], v[156:159], v[192:207]
    ds_read_b128 v[216:219], v14 offset:19456
    ds_read_b128 v[220:223], v14 offset:39936
    ds_read_b128 v[224:227], v9 offset:0
    ds_read_b128 v[228:231], v9 offset:32
    ds_read_b128 v[232:235], v9 offset:64
    ds_read_b128 v[236:239], v9 offset:96
    s_waitcnt lgkmcnt(6)
    v_mfma_f32_32x32x16_bf16 v[176:191], v[208:211], v[160:163], v[176:191]
    v_mfma_f32_32x32x16_bf16 v[192:207], v[212:215], v[164:167], v[192:207]
    s_waitcnt lgkmcnt(4)
    v_mfma_f32_32x32x16_bf16 v[176:191], v[216:219], v[168:171], v[176:191]
    v_mfma_f32_32x32x16_bf16 v[192:207], v[220:223], v[172:175], v[192:207]
    v_mfma_f32_32x32x16_bf16 v[176:191], v[220:223], v[240:243], v[176:191]
    v_lshlrev_b32 v13, 4, v0
    v_add_u32 v13, 143360, v13
    ds_read_b128 v[160:163], v13 offset:0
    ds_read_b128 v[164:167], v13 offset:1024
    ds_read_b128 v[168:171], v13 offset:2048
    ds_read_b128 v[172:175], v13 offset:3072
    s_nop 7
    ds_read_b128 v[208:211], v13 offset:4096
    ds_read_b128 v[212:215], v13 offset:5120
    ds_read_b128 v[216:219], v13 offset:6144
    ds_read_b128 v[220:223], v13 offset:7168
    s_waitcnt lgkmcnt(8)
    v_pk_mul_f32 v[192:193], v[192:193], v[224:225]
    v_pk_mul_f32 v[194:195], v[194:195], v[226:227]
    v_pk_mul_f32 v[196:197], v[196:197], v[228:229]
    v_pk_mul_f32 v[198:199], v[198:199], v[230:231]
    v_pk_mul_f32 v[200:201], v[200:201], v[232:233]
    v_pk_mul_f32 v[202:203], v[202:203], v[234:235]
    v_pk_mul_f32 v[204:205], v[204:205], v[236:237]
    v_pk_mul_f32 v[206:207], v[206:207], v[238:239]
    v_cvt_pk_bf16_f32 v248, v192, v193
    v_cvt_pk_bf16_f32 v249, v194, v195
    v_cvt_pk_bf16_f32 v250, v196, v197
    v_cvt_pk_bf16_f32 v251, v198, v199
    v_cvt_pk_bf16_f32 v252, v200, v201
    v_cvt_pk_bf16_f32 v253, v202, v203
    v_cvt_pk_bf16_f32 v254, v204, v205
    v_cvt_pk_bf16_f32 v255, v206, v207
    v_pk_mul_f32 v[176:177], v[176:177], v[224:225]
    v_pk_mul_f32 v[178:179], v[178:179], v[226:227]
    v_pk_mul_f32 v[180:181], v[180:181], v[228:229]
    v_pk_mul_f32 v[182:183], v[182:183], v[230:231]
    v_pk_mul_f32 v[184:185], v[184:185], v[232:233]
    v_pk_mul_f32 v[186:187], v[186:187], v[234:235]
    v_pk_mul_f32 v[188:189], v[188:189], v[236:237]
    v_pk_mul_f32 v[190:191], v[190:191], v[238:239]
    v_cvt_pk_bf16_f32 v240, v176, v177
    v_cvt_pk_bf16_f32 v241, v178, v179
    v_cvt_pk_bf16_f32 v242, v180, v181
    v_cvt_pk_bf16_f32 v243, v182, v183
    v_cvt_pk_bf16_f32 v244, v184, v185
    v_cvt_pk_bf16_f32 v245, v186, v187
    v_cvt_pk_bf16_f32 v246, v188, v189
    v_cvt_pk_bf16_f32 v247, v190, v191
    s_waitcnt lgkmcnt(0)
    v_and_b32 v14, 15, v0
    v_mul_u32_u24 v14, 81920, v14
    v_bfe_u32 v13, v0, 4, 1
    v_lshl_add_u32 v14, v13, 5, v14
    v_lshl_add_u32 v14, v15, 4, v14
    v_mfma_f32_32x32x16_bf16 v[192:207], v[240:243], v[160:163], 0
    v_mfma_f32_32x32x16_bf16 v[192:207], v[244:247], v[164:167], v[192:207]
    v_mfma_f32_32x32x16_bf16 v[192:207], v[248:251], v[168:171], v[192:207]
    v_mfma_f32_32x32x16_bf16 v[192:207], v[252:255], v[172:175], v[192:207]
    v_mfma_f32_32x32x16_bf16 v[176:191], v[240:243], v[208:211], 0
    v_mfma_f32_32x32x16_bf16 v[176:191], v[244:247], v[212:215], v[176:191]
    v_mfma_f32_32x32x16_bf16 v[176:191], v[248:251], v[216:219], v[176:191]
    v_mfma_f32_32x32x16_bf16 v[176:191], v[252:255], v[220:223], v[176:191]
    s_add_u32 s23, s32, 1310720
    s_nop 6
    v_permlane16_swap_b32 v192, v200
    v_permlane16_swap_b32 v193, v201
    v_permlane16_swap_b32 v194, v202
    v_permlane16_swap_b32 v195, v203
    v_permlane16_swap_b32 v196, v204
    v_permlane16_swap_b32 v197, v205
    v_permlane16_swap_b32 v198, v206
    v_permlane16_swap_b32 v199, v207
    v_cvt_pk_bf16_f32 v224, v192, v200
    v_cvt_pk_bf16_f32 v225, v193, v201
    v_cvt_pk_bf16_f32 v226, v194, v202
    v_cvt_pk_bf16_f32 v227, v195, v203
    buffer_store_dwordx4 v[224:227], v14, s[8:11], s32 offen offset:0 sc1
    v_cvt_pk_bf16_f32 v228, v196, v204
    v_cvt_pk_bf16_f32 v229, v197, v205
    v_cvt_pk_bf16_f32 v230, v198, v206
    v_cvt_pk_bf16_f32 v231, v199, v207
    buffer_store_dwordx4 v[228:231], v14, s[8:11], s32 offen offset:64 sc1
    s_nop 0
    v_permlane16_swap_b32 v176, v184
    v_permlane16_swap_b32 v177, v185
    v_permlane16_swap_b32 v178, v186
    v_permlane16_swap_b32 v179, v187
    v_permlane16_swap_b32 v180, v188
    v_permlane16_swap_b32 v181, v189
    v_permlane16_swap_b32 v182, v190
    v_permlane16_swap_b32 v183, v191
    v_cvt_pk_bf16_f32 v232, v176, v184
    v_cvt_pk_bf16_f32 v233, v177, v185
    v_cvt_pk_bf16_f32 v234, v178, v186
    v_cvt_pk_bf16_f32 v235, v179, v187
    buffer_store_dwordx4 v[232:235], v14, s[8:11], s23 offen offset:0 sc1
    v_cvt_pk_bf16_f32 v236, v180, v188
    v_cvt_pk_bf16_f32 v237, v181, v189
    v_cvt_pk_bf16_f32 v238, v182, v190
    v_cvt_pk_bf16_f32 v239, v183, v191
    buffer_store_dwordx4 v[236:239], v14, s[8:11], s23 offen offset:64 sc1
    v_mov_b32 v13, v10
    s_branch k2_xend98
k2_nou96:
    s_cmp_lg_u32 s18, 3
    s_cbranch_scc1 k2_xw397
    v_and_b32 v14, 31, v0
    v_lshlrev_b32 v14, 3, v14
    s_lshl_b32 s23, s16, 12
    s_lshl_b32 s38, s19, 8
    s_add_u32 s23, s23, s38
    s_add_u32 s23, s23, 262144
    buffer_load_dwordx2 v[224:225], v14, s[8:11], s23 offen offset:0 sc1
    buffer_load_dwordx2 v[226:227], v14, s[8:11], s23 offen offset:512 sc1
    buffer_load_dwordx2 v[228:229], v14, s[8:11], s23 offen offset:1024 sc1
    buffer_load_dwordx2 v[230:231], v14, s[8:11], s23 offen offset:1536 sc1
    buffer_load_dwordx2 v[232:233], v14, s[8:11], s23 offen offset:2048 sc1
    buffer_load_dwordx2 v[234:235], v14, s[8:11], s23 offen offset:2560 sc1
    buffer_load_dwordx2 v[236:237], v14, s[8:11], s23 offen offset:3072 sc1
    buffer_load_dwordx2 v[238:239], v14, s[8:11], s23 offen offset:3584 sc1
    s_waitcnt vmcnt(16)
    s_barrier
    s_waitcnt vmcnt(14)
    s_barrier
    s_waitcnt vmcnt(12)
    s_barrier
    s_waitcnt vmcnt(10)
    s_barrier
    s_waitcnt vmcnt(0)
    v_pk_add_f32 v[224:225], v[224:225], v[226:227]
    v_pk_add_f32 v[224:225], v[224:225], v[228:229]
    v_pk_add_f32 v[224:225], v[224:225], v[230:231]
    v_pk_add_f32 v[224:225], v[224:225], v[232:233]
    v_pk_add_f32 v[224:225], v[224:225], v[234:235]
    v_pk_add_f32 v[224:225], v[224:225], v[236:237]
    v_pk_add_f32 v[224:225], v[224:225], v[238:239]
    v_mul_f32 v224, 0x3acccccd, v224
    v_mul_f32 v225, 0x3acccccd, v225
    v_fma_f32 v225, -v224, v224, v225
    v_max_f32 v225, 0, v225
    v_add_f32 v225, 0x3727c5ac, v225
    v_rsq_f32 v225, v225
    v_lshlrev_b32 v14, 2, v0
    v_add_u32 v14, 159744, v14
    ds_write_b32 v14, v225
    s_waitcnt lgkmcnt(0)
    s_barrier
    s_branch k2_xend98
k2_xw397:
    s_waitcnt vmcnt(16)
    s_barrier
    s_waitcnt vmcnt(14)
    s_barrier
    s_waitcnt vmcnt(12)
    s_barrier
    s_waitcnt vmcnt(10)
    s_barrier
    s_waitcnt vmcnt(8)
    s_barrier
k2_xend98:
    s_cmp_eq_u32 s18, 3
    s_cbranch_scc1 k2_gpoll
    s_cmp_ge_u32 s18, s22
    s_cbranch_scc1 k2_nor99
    s_lshl_b32 s33, s21, 12
    s_add_u32 s33, s33, s24
    s_add_u32 s34, s33, 7077888
    s_add_u32 s35, s34, 40960
    buffer_load_dwordx4 v[192:195], v3, s[8:11], s34 offen offset:0 sc1
    buffer_load_dwordx4 v[196:199], v3, s[8:11], s34 offen offset:512 sc1
    buffer_load_dwordx4 v[200:203], v4, s[8:11], s35 offen offset:0 sc1
    buffer_load_dwordx4 v[204:207], v4, s[8:11], s35 offen offset:512 sc1
k2_nor99:
    s_mul_i32 s23, s17, 24576
    s_mul_i32 s38, s18, 6144
    s_add_u32 s23, s23, s38
    s_add_u32 s23, s23, s28
    s_add_u32 s23, s23, 14942208
    s_add_u32 s38, s23, 4096
    v_mov_b32 v248, -1
    v_mov_b32 v249, -1
    v_mov_b32 v250, -1
    v_mov_b32 v251, -1
    buffer_store_dwordx4 v[248:251], v1, s[8:11], s23 offen offset:0
    buffer_store_dwordx4 v[248:251], v1, s[8:11], s23 offen offset:1024
    buffer_store_dwordx4 v[248:251], v1, s[8:11], s23 offen offset:2048
    buffer_store_dwordx4 v[248:251], v1, s[8:11], s23 offen offset:3072
    buffer_store_dwordx4 v[248:251], v1, s[8:11], s38 offen offset:0
    buffer_store_dwordx4 v[248:251], v1, s[8:11], s38 offen offset:1024
    s_nop 1
    s_add_u32 s23, s29, 0
    s_cmp_ge_u32 s23, 20
    s_cselect_b32 s38, 20, 0
    s_sub_u32 s23, s23, s38
    s_mul_i32 s23, s23, 3072
    s_add_u32 s23, s23, s39
    buffer_load_dwordx4 v[16:19], v1, s[8:11], s23 offen offset:0
    buffer_load_dwordx4 v[20:23], v1, s[8:11], s23 offen offset:1024
    buffer_load_dwordx4 v[24:27], v1, s[8:11], s23 offen offset:2048
    s_add_u32 s23, s29, 1
    s_cmp_ge_u32 s23, 20
    s_cselect_b32 s38, 20, 0
    s_sub_u32 s23, s23, s38
    s_mul_i32 s23, s23, 3072
    s_add_u32 s23, s23, s39
    buffer_load_dwordx4 v[28:31], v1, s[8:11], s23 offen offset:0
    buffer_load_dwordx4 v[32:35], v1, s[8:11], s23 offen offset:1024
    buffer_load_dwordx4 v[36:39], v1, s[8:11], s23 offen offset:2048
    s_add_u32 s23, s29, 2
    s_cmp_ge_u32 s23, 20
    s_cselect_b32 s38, 20, 0
    s_sub_u32 s23, s23, s38
    s_mul_i32 s23, s23, 3072
    s_add_u32 s23, s23, s39
    buffer_load_dwordx4 v[40:43], v1, s[8:11], s23 offen offset:0
    buffer_load_dwordx4 v[44:47], v1, s[8:11], s23 offen offset:1024
    buffer_load_dwordx4 v[48:51], v1, s[8:11], s23 offen offset:2048
    s_add_u32 s23, s29, 3
    s_cmp_ge_u32 s23, 20
    s_cselect_b32 s38, 20, 0
    s_sub_u32 s23, s23, s38
    s_mul_i32 s23, s23, 3072
    s_add_u32 s23, s23, s39
    buffer_load_dwordx4 v[52:55], v1, s[8:11], s23 offen offset:0
    buffer_load_dwordx4 v[56:59], v1, s[8:11], s23 offen offset:1024
    buffer_load_dwordx4 v[60:63], v1, s[8:11], s23 offen offset:2048
    s_add_u32 s23, s29, 4
    s_cmp_ge_u32 s23, 20
    s_cselect_b32 s38, 20, 0
    s_sub_u32 s23, s23, s38
    s_mul_i32 s23, s23, 3072
    s_add_u32 s23, s23, s39
    buffer_load_dwordx4 v[64:67], v1, s[8:11], s23 offen offset:0
    buffer_load_dwordx4 v[68:71], v1, s[8:11], s23 offen offset:1024
    buffer_load_dwordx4 v[72:75], v1, s[8:11], s23 offen offset:2048
    s_add_u32 s23, s29, 5
    s_cmp_ge_u32 s23, 20
    s_cselect_b32 s38, 20, 0
    s_sub_u32 s23, s23, s38
    s_mul_i32 s23, s23, 3072
    s_add_u32 s23, s23, s39
    buffer_load_dwordx4 v[76:79], v1, s[8:11], s23 offen offset:0
    buffer_load_dwordx4 v[80:83], v1, s[8:11], s23 offen offset:1024
    buffer_load_dwordx4 v[84:87], v1, s[8:11], s23 offen offset:2048
    s_add_u32 s23, s29, 6
    s_cmp_ge_u32 s23, 20
    s_cselect_b32 s38, 20, 0
    s_sub_u32 s23, s23, s38
    s_mul_i32 s23, s23, 3072
    s_add_u32 s23, s23, s39
    buffer_load_dwordx4 v[88:91], v1, s[8:11], s23 offen offset:0
    buffer_load_dwordx4 v[92:95], v1, s[8:11], s23 offen offset:1024
    buffer_load_dwordx4 v[96:99], v1, s[8:11], s23 offen offset:2048
    s_add_u32 s23, s29, 7
    s_cmp_ge_u32 s23, 20
    s_cselect_b32 s38, 20, 0
    s_sub_u32 s23, s23, s38
    s_mul_i32 s23, s23, 3072
    s_add_u32 s23, s23, s39
    buffer_load_dwordx4 v[100:103], v1, s[8:11], s23 offen offset:0
    buffer_load_dwordx4 v[104:107], v1, s[8:11], s23 offen offset:1024
    buffer_load_dwordx4 v[108:111], v1, s[8:11], s23 offen offset:2048
    s_branch k2_gdone
k2_gpoll:
    s_mul_i32 s23, s17, 24576
    s_mul_i32 s38, s18, 6144
    s_add_u32 s23, s23, s38
    s_add_u32 s23, s23, s28
    s_add_u32 s23, s23, 14942208
    s_add_u32 s38, s23, 4096
    v_mov_b32 v248, -1
    v_mov_b32 v249, -1
    v_mov_b32 v250, -1
    v_mov_b32 v251, -1
    buffer_store_dwordx4 v[248:251], v1, s[8:11], s23 offen offset:0
    buffer_store_dwordx4 v[248:251], v1, s[8:11], s23 offen offset:1024
    buffer_store_dwordx4 v[248:251], v1, s[8:11], s23 offen offset:2048
    buffer_store_dwordx4 v[248:251], v1, s[8:11], s23 offen offset:3072
    buffer_store_dwordx4 v[248:251], v1, s[8:11], s38 offen offset:0
    buffer_store_dwordx4 v[248:251], v1, s[8:11], s38 offen offset:1024
    s_nop 1
    s_add_u32 s23, s29, 0
    s_cmp_ge_u32 s23, 20
    s_cselect_b32 s38, 20, 0
    s_sub_u32 s23, s23, s38
    s_mul_i32 s23, s23, 3072
    s_add_u32 s23, s23, s39
    buffer_load_dwordx4 v[16:19], v1, s[8:11], s23 offen offset:0
    buffer_load_dwordx4 v[20:23], v1, s[8:11], s23 offen offset:1024
    buffer_load_dwordx4 v[24:27], v1, s[8:11], s23 offen offset:2048
    s_add_u32 s23, s29, 1
    s_cmp_ge_u32 s23, 20
    s_cselect_b32 s38, 20, 0
    s_sub_u32 s23, s23, s38
    s_mul_i32 s23, s23, 3072
    s_add_u32 s23, s23, s39
    buffer_load_dwordx4 v[28:31], v1, s[8:11], s23 offen offset:0
    buffer_load_dwordx4 v[32:35], v1, s[8:11], s23 offen offset:1024
    buffer_load_dwordx4 v[36:39], v1, s[8:11], s23 offen offset:2048
    s_add_u32 s23, s29, 2
    s_cmp_ge_u32 s23, 20
    s_cselect_b32 s38, 20, 0
    s_sub_u32 s23, s23, s38
    s_mul_i32 s23, s23, 3072
    s_add_u32 s23, s23, s39
    buffer_load_dwordx4 v[40:43], v1, s[8:11], s23 offen offset:0
    buffer_load_dwordx4 v[44:47], v1, s[8:11], s23 offen offset:1024
    buffer_load_dwordx4 v[48:51], v1, s[8:11], s23 offen offset:2048
    s_add_u32 s23, s29, 3
    s_cmp_ge_u32 s23, 20
    s_cselect_b32 s38, 20, 0
    s_sub_u32 s23, s23, s38
    s_mul_i32 s23, s23, 3072
    s_add_u32 s23, s23, s39
    buffer_load_dwordx4 v[52:55], v1, s[8:11], s23 offen offset:0
    buffer_load_dwordx4 v[56:59], v1, s[8:11], s23 offen offset:1024
    buffer_load_dwordx4 v[60:63], v1, s[8:11], s23 offen offset:2048
    s_add_u32 s23, s29, 4
    s_cmp_ge_u32 s23, 20
    s_cselect_b32 s38, 20, 0
    s_sub_u32 s23, s23, s38
    s_mul_i32 s23, s23, 3072
    s_add_u32 s23, s23, s39
    buffer_load_dwordx4 v[64:67], v1, s[8:11], s23 offen offset:0
    buffer_load_dwordx4 v[68:71], v1, s[8:11], s23 offen offset:1024
    buffer_load_dwordx4 v[72:75], v1, s[8:11], s23 offen offset:2048
    s_add_u32 s23, s29, 5
    s_cmp_ge_u32 s23, 20
    s_cselect_b32 s38, 20, 0
    s_sub_u32 s23, s23, s38
    s_mul_i32 s23, s23, 3072
    s_add_u32 s23, s23, s39
    buffer_load_dwordx4 v[76:79], v1, s[8:11], s23 offen offset:0
    buffer_load_dwordx4 v[80:83], v1, s[8:11], s23 offen offset:1024
    buffer_load_dwordx4 v[84:87], v1, s[8:11], s23 offen offset:2048
    s_add_u32 s23, s29, 6
    s_cmp_ge_u32 s23, 20
    s_cselect_b32 s38, 20, 0
    s_sub_u32 s23, s23, s38
    s_mul_i32 s23, s23, 3072
    s_add_u32 s23, s23, s39
    buffer_load_dwordx4 v[88:91], v1, s[8:11], s23 offen offset:0
    buffer_load_dwordx4 v[92:95], v1, s[8:11], s23 offen offset:1024
    buffer_load_dwordx4 v[96:99], v1, s[8:11], s23 offen offset:2048
    s_add_u32 s23, s29, 7
    s_cmp_ge_u32 s23, 20
    s_cselect_b32 s38, 20, 0
    s_sub_u32 s23, s23, s38
    s_mul_i32 s23, s23, 3072
    s_add_u32 s23, s23, s39
    buffer_load_dwordx4 v[100:103], v1, s[8:11], s23 offen offset:0
    buffer_load_dwordx4 v[104:107], v1, s[8:11], s23 offen offset:1024
    buffer_load_dwordx4 v[108:111], v1, s[8:11], s23 offen offset:2048
    s_add_u32 s23, s29, 8
    s_cmp_ge_u32 s23, 20
    s_cselect_b32 s38, 20, 0
    s_sub_u32 s23, s23, s38
    s_mul_i32 s23, s23, 3072
    s_add_u32 s23, s23, s39
    buffer_load_dwordx4 v[112:115], v1, s[8:11], s23 offen offset:0
    buffer_load_dwordx4 v[116:119], v1, s[8:11], s23 offen offset:1024
    buffer_load_dwordx4 v[120:123], v1, s[8:11], s23 offen offset:2048
    s_add_u32 s23, s29, 9
    s_cmp_ge_u32 s23, 20
    s_cselect_b32 s38, 20, 0
    s_sub_u32 s23, s23, s38
    s_mul_i32 s23, s23, 3072
    s_add_u32 s23, s23, s39
    buffer_load_dwordx4 v[124:127], v1, s[8:11], s23 offen offset:0
    buffer_load_dwordx4 v[128:131], v1, s[8:11], s23 offen offset:1024
    buffer_load_dwordx4 v[132:135], v1, s[8:11], s23 offen offset:2048
    s_add_u32 s23, s29, 10
    s_cmp_ge_u32 s23, 20
    s_cselect_b32 s38, 20, 0
    s_sub_u32 s23, s23, s38
    s_mul_i32 s23, s23, 3072
    s_add_u32 s23, s23, s39
    buffer_load_dwordx4 v[136:139], v1, s[8:11], s23 offen offset:0
    buffer_load_dwordx4 v[140:143], v1, s[8:11], s23 offen offset:1024
    buffer_load_dwordx4 v[144:147], v1, s[8:11], s23 offen offset:2048
k2_gdone:
    s_waitcnt lgkmcnt(0)
    s_cmp_ge_u32 s18, s22
    s_cbranch_scc1 k2_nou100
    s_mov_b32 s47, 0
    s_add_u32 s31, s25, 12320768
    s_add_u32 s32, s31, 4096
    buffer_load_dword v160, v2, s[8:11], s31 offen offset:0 sc1
    buffer_load_dword v161, v2, s[8:11], s31 offen offset:128 sc1
    buffer_load_dword v162, v2, s[8:11], s31 offen offset:256 sc1
    buffer_load_dword v163, v2, s[8:11], s31 offen offset:384 sc1
    buffer_load_dword v164, v2, s[8:11], s31 offen offset:1024 sc1
    buffer_load_dword v165, v2, s[8:11], s31 offen offset:1152 sc1
    buffer_load_dword v166, v2, s[8:11], s31 offen offset:1280 sc1
    buffer_load_dword v167, v2, s[8:11], s31 offen offset:1408 sc1
    buffer_load_dword v168, v2, s[8:11], s31 offen offset:2048 sc1
    buffer_load_dword v169, v2, s[8:11], s31 offen offset:2176 sc1
    buffer_load_dword v170, v2, s[8:11], s31 offen offset:2304 sc1
    buffer_load_dword v171, v2, s[8:11], s31 offen offset:2432 sc1
    buffer_load_dword v172, v2, s[8:11], s31 offen offset:3072 sc1
    buffer_load_dword v173, v2, s[8:11], s31 offen offset:3200 sc1
    buffer_load_dword v174, v2, s[8:11], s31 offen offset:3328 sc1
    buffer_load_dword v175, v2, s[8:11], s31 offen offset:3456 sc1
    buffer_load_dword v176, v2, s[8:11], s32 offen offset:0 sc1
    buffer_load_dword v177, v2, s[8:11], s32 offen offset:128 sc1
    buffer_load_dword v178, v2, s[8:11], s32 offen offset:256 sc1
    buffer_load_dword v179, v2, s[8:11], s32 offen offset:384 sc1
    buffer_load_dword v180, v2, s[8:11], s32 offen offset:1024 sc1
    buffer_load_dword v181, v2, s[8:11], s32 offen offset:1152 sc1
    buffer_load_dword v182, v2, s[8:11], s32 offen offset:1280 sc1
    buffer_load_dword v183, v2, s[8:11], s32 offen offset:1408 sc1
    buffer_load_dword v184, v2, s[8:11], s32 offen offset:2048 sc1
    buffer_load_dword v185, v2, s[8:11], s32 offen offset:2176 sc1
    buffer_load_dword v186, v2, s[8:11], s32 offen offset:2304 sc1
    buffer_load_dword v187, v2, s[8:11], s32 offen offset:2432 sc1
    buffer_load_dword v188, v2, s[8:11], s32 offen offset:3072 sc1
    buffer_load_dword v189, v2, s[8:11], s32 offen offset:3200 sc1
    buffer_load_dword v190, v2, s[8:11], s32 offen offset:3328 sc1
    buffer_load_dword v191, v2, s[8:11], s32 offen offset:3456 sc1
    v_add_u32 v14, 151552, v1
    ds_read_b128 v[224:227], v14 offset:0
    ds_read_b128 v[228:231], v14 offset:1024
    ds_read_b128 v[232:235], v14 offset:2048
    ds_read_b128 v[236:239], v14 offset:3072
    ds_read_b128 v[240:243], v14 offset:4096
    ds_read_b128 v[244:247], v14 offset:5120
    ds_read_b128 v[248:251], v14 offset:6144
    ds_read_b128 v[252:255], v14 offset:7168
    s_cmp_eq_u32 s21, 9
    s_cselect_b32 s37, -1, 0
    s_mov_b32 s36, 0
k2_tr101:
    s_waitcnt vmcnt(28)
    s_waitcnt lgkmcnt(7)
    v_mfma_f32_32x32x16_bf16 v[208:223], v[160:163], v[224:227], 0
    v_max_u32 v15, v160, v161
    v_max3_u32 v15, v15, v162, v163
    s_waitcnt vmcnt(24)
    s_waitcnt lgkmcnt(6)
    v_mfma_f32_32x32x16_bf16 v[208:223], v[164:167], v[228:231], v[208:223]
    v_max3_u32 v15, v15, v164, v165
    v_max3_u32 v15, v15, v166, v167
    s_waitcnt vmcnt(20)
    s_waitcnt lgkmcnt(5)
    v_mfma_f32_32x32x16_bf16 v[208:223], v[168:171], v[232:235], v[208:223]
    v_max3_u32 v15, v15, v168, v169
    v_max3_u32 v15, v15, v170, v171
    s_waitcnt vmcnt(16)
    s_waitcnt lgkmcnt(4)
    v_mfma_f32_32x32x16_bf16 v[208:223], v[172:175], v[236:239], v[208:223]
    v_max3_u32 v15, v15, v172, v173
    v_max3_u32 v15, v15, v174, v175
    s_waitcnt vmcnt(12)
    s_waitcnt lgkmcnt(3)
    v_mfma_f32_32x32x16_bf16 v[208:223], v[176:179], v[240:243], v[208:223]
    v_max3_u32 v15, v15, v176, v177
    v_max3_u32 v15, v15, v178, v179
    s_waitcnt vmcnt(8)
    s_waitcnt lgkmcnt(2)
    v_mfma_f32_32x32x16_bf16 v[208:223], v[180:183], v[244:247], v[208:223]
    v_max3_u32 v15, v15, v180, v181
    v_max3_u32 v15, v15, v182, v183
    s_waitcnt vmcnt(4)
    s_waitcnt lgkmcnt(1)
    v_mfma_f32_32x32x16_bf16 v[208:223], v[184:187], v[248:251], v[208:223]
    v_max3_u32 v15, v15, v184, v185
    v_max3_u32 v15, v15, v186, v187
    s_waitcnt vmcnt(0)
    s_waitcnt lgkmcnt(0)
    v_mfma_f32_32x32x16_bf16 v[208:223], v[188:191], v[252:255], v[208:223]
    v_max3_u32 v15, v15, v188, v189
    v_max3_u32 v15, v15, v190, v191
    v_cmp_eq_u32 vcc, -1, v15
    s_cbranch_vccnz k2_tr101a
k2_tr101b:
    v_lshlrev_b32 v160, 16, v192
    v_and_b32 v161, 0xffff0000, v192
    v_lshlrev_b32 v176, 16, v200
    v_and_b32 v177, 0xffff0000, v200
    v_lshlrev_b32 v162, 16, v193
    v_and_b32 v163, 0xffff0000, v193
    v_lshlrev_b32 v178, 16, v201
    v_and_b32 v179, 0xffff0000, v201
    v_lshlrev_b32 v164, 16, v194
    v_and_b32 v165, 0xffff0000, v194
    v_lshlrev_b32 v180, 16, v202
    v_and_b32 v181, 0xffff0000, v202
    v_lshlrev_b32 v166, 16, v195
    v_and_b32 v167, 0xffff0000, v195
    v_lshlrev_b32 v182, 16, v203
    v_and_b32 v183, 0xffff0000, v203
    v_lshlrev_b32 v168, 16, v196
    v_and_b32 v169, 0xffff0000, v196
    v_lshlrev_b32 v184, 16, v204
    v_and_b32 v185, 0xffff0000, v204
    v_lshlrev_b32 v170, 16, v197
    v_and_b32 v171, 0xffff0000, v197
    v_lshlrev_b32 v186, 16, v205
    v_and_b32 v187, 0xffff0000, v205
    v_lshlrev_b32 v172, 16, v198
    v_and_b32 v173, 0xffff0000, v198
    v_lshlrev_b32 v188, 16, v206
    v_and_b32 v189, 0xffff0000, v206
    v_lshlrev_b32 v174, 16, v199
    v_and_b32 v175, 0xffff0000, v199
    v_lshlrev_b32 v190, 16, v207
    v_and_b32 v191, 0xffff0000, v207
    v_pk_add_f32 v[160:161], v[160:161], v[208:209]
    v_pk_add_f32 v[162:163], v[162:163], v[210:211]
    v_pk_add_f32 v[164:165], v[164:165], v[212:213]
    v_pk_add_f32 v[166:167], v[166:167], v[214:215]
    v_pk_add_f32 v[168:169], v[168:169], v[216:217]
    v_pk_add_f32 v[170:171], v[170:171], v[218:219]
    v_pk_add_f32 v[172:173], v[172:173], v[220:221]
    v_pk_add_f32 v[174:175], v[174:175], v[222:223]
    v_cndmask_b32 v223, v223, 0, s[36:37]
    v_cvt_pk_bf16_f32 v192, v160, v161
    v_cvt_pk_bf16_f32 v193, v162, v163
    v_cvt_pk_bf16_f32 v194, v164, v165
    v_cvt_pk_bf16_f32 v195, v166, v167
    v_cvt_pk_bf16_f32 v196, v168, v169
    v_cvt_pk_bf16_f32 v197, v170, v171
    v_cvt_pk_bf16_f32 v198, v172, v173
    v_cvt_pk_bf16_f32 v199, v174, v175
    s_add_u32 s34, s33, 7077888
    s_add_u32 s35, s34, 40960
    buffer_store_dwordx4 v[192:195], v3, s[8:11], s34 offen offset:0
    buffer_store_dwordx4 v[196:199], v3, s[8:11], s34 offen offset:512
    v_pk_add_f32 v[176:177], v[176:177], v[208:209]
    v_pk_add_f32 v[178:179], v[178:179], v[210:211]
    v_pk_add_f32 v[180:181], v[180:181], v[212:213]
    v_pk_add_f32 v[182:183], v[182:183], v[214:215]
    v_pk_add_f32 v[184:185], v[184:185], v[216:217]
    v_pk_add_f32 v[186:187], v[186:187], v[218:219]
    v_pk_add_f32 v[188:189], v[188:189], v[220:221]
    v_pk_add_f32 v[190:191], v[190:191], v[222:223]
    v_cvt_pk_bf16_f32 v200, v176, v177
    v_cvt_pk_bf16_f32 v201, v178, v179
    v_cvt_pk_bf16_f32 v202, v180, v181
    v_cvt_pk_bf16_f32 v203, v182, v183
    v_cvt_pk_bf16_f32 v204, v184, v185
    v_cvt_pk_bf16_f32 v205, v186, v187
    v_cvt_pk_bf16_f32 v206, v188, v189
    v_cvt_pk_bf16_f32 v207, v190, v191
    buffer_store_dwordx4 v[200:203], v4, s[8:11], s35 offen offset:0
    buffer_store_dwordx4 v[204:207], v4, s[8:11], s35 offen offset:512
    v_pk_mul_f32 v[226:227], v[160:161], v[160:161]
    v_pk_add_f32 v[224:225], v[160:161], v[162:163]
    v_pk_fma_f32 v[226:227], v[162:163], v[162:163], v[226:227]
    v_pk_add_f32 v[224:225], v[224:225], v[164:165]
    v_pk_fma_f32 v[226:227], v[164:165], v[164:165], v[226:227]
    v_pk_add_f32 v[224:225], v[224:225], v[166:167]
    v_pk_fma_f32 v[226:227], v[166:167], v[166:167], v[226:227]
    v_pk_add_f32 v[224:225], v[224:225], v[168:169]
    v_pk_fma_f32 v[226:227], v[168:169], v[168:169], v[226:227]
    v_pk_add_f32 v[224:225], v[224:225], v[170:171]
    v_pk_fma_f32 v[226:227], v[170:171], v[170:171], v[226:227]
    v_pk_add_f32 v[224:225], v[224:225], v[172:173]
    v_pk_fma_f32 v[226:227], v[172:173], v[172:173], v[226:227]
    v_pk_add_f32 v[224:225], v[224:225], v[174:175]
    v_pk_fma_f32 v[226:227], v[174:175], v[174:175], v[226:227]
    v_pk_mul_f32 v[230:231], v[176:177], v[176:177]
    v_pk_add_f32 v[228:229], v[176:177], v[178:179]
    v_pk_fma_f32 v[230:231], v[178:179], v[178:179], v[230:231]
    v_pk_add_f32 v[228:229], v[228:229], v[180:181]
    v_pk_fma_f32 v[230:231], v[180:181], v[180:181], v[230:231]
    v_pk_add_f32 v[228:229], v[228:229], v[182:183]
    v_pk_fma_f32 v[230:231], v[182:183], v[182:183], v[230:231]
    v_pk_add_f32 v[228:229], v[228:229], v[184:185]
    v_pk_fma_f32 v[230:231], v[184:185], v[184:185], v[230:231]
    v_pk_add_f32 v[228:229], v[228:229], v[186:187]
    v_pk_fma_f32 v[230:231], v[186:187], v[186:187], v[230:231]
    v_pk_add_f32 v[228:229], v[228:229], v[188:189]
    v_pk_fma_f32 v[230:231], v[188:189], v[188:189], v[230:231]
    v_pk_add_f32 v[228:229], v[228:229], v[190:191]
    v_pk_fma_f32 v[230:231], v[190:191], v[190:191], v[230:231]
    v_add_f32 v224, v224, v225
    v_add_f32 v225, v226, v227
    v_add_f32 v228, v228, v229
    v_add_f32 v229, v230, v231
    s_mul_i32 s23, s16, 10240
    s_lshl_b32 s38, s21, 9
    v_permlane32_swap_b32 v224, v228
    v_permlane32_swap_b32 v225, v229
    s_add_u32 s23, s23, s38
    s_add_u32 s23, s23, 21233664
    v_pk_add_f32 v[224:225], v[224:225], v[228:229]
    buffer_store_dwordx2 v[224:225], v5, s[8:11], s23 offen
k2_nou100:
    s_add_u32 s41, s24, 7077888
    s_add_u32 s42, s29, s18
    s_lshl_b32 s40, s18, 12
    s_add_u32 s48, s42, 0
    s_cmp_ge_u32 s48, 20
    s_cselect_b32 s38, 20, 0
    s_sub_u32 s48, s48, s38
    s_mul_i32 s48, s48, 4096
    s_add_u32 s48, s48, s41
    s_add_u32 s49, s42, 4
    s_cmp_ge_u32 s49, 20
    s_cselect_b32 s38, 20, 0
    s_sub_u32 s49, s49, s38
    s_mul_i32 s49, s49, 4096
    s_add_u32 s49, s49, s41
    s_add_u32 s50, s42, 8
    s_cmp_ge_u32 s50, 20
    s_cselect_b32 s38, 20, 0
    s_sub_u32 s50, s50, s38
    s_mul_i32 s50, s50, 4096
    s_add_u32 s50, s50, s41
    s_add_u32 s51, s42, 12
    s_cmp_ge_u32 s51, 20
    s_cselect_b32 s38, 20, 0
    s_sub_u32 s51, s51, s38
    s_mul_i32 s51, s51, 4096
    s_add_u32 s51, s51, s41
    s_add_u32 s52, s42, 16
    s_cmp_ge_u32 s52, 20
    s_cselect_b32 s38, 20, 0
    s_sub_u32 s52, s52, s38
    s_mul_i32 s52, s52, 4096
    s_add_u32 s52, s52, s41
    s_add_u32 s53, s29, 11
    s_cmp_ge_u32 s53, 20
    s_cselect_b32 s38, 20, 0
    s_sub_u32 s53, s53, s38
    s_mul_i32 s53, s53, 3072
    s_add_u32 s53, s53, s39
    s_add_u32 s54, s29, 12
    s_cmp_ge_u32 s54, 20
    s_cselect_b32 s38, 20, 0
    s_sub_u32 s54, s54, s38
    s_mul_i32 s54, s54, 3072
    s_add_u32 s54, s54, s39
    s_add_u32 s55, s29, 13
    s_cmp_ge_u32 s55, 20
    s_cselect_b32 s38, 20, 0
    s_sub_u32 s55, s55, s38
    s_mul_i32 s55, s55, 3072
    s_add_u32 s55, s55, s39
    s_add_u32 s56, s29, 14
    s_cmp_ge_u32 s56, 20
    s_cselect_b32 s38, 20, 0
    s_sub_u32 s56, s56, s38
    s_mul_i32 s56, s56, 3072
    s_add_u32 s56, s56, s39
    s_add_u32 s57, s29, 15
    s_cmp_ge_u32 s57, 20
    s_cselect_b32 s38, 20, 0
    s_sub_u32 s57, s57, s38
    s_mul_i32 s57, s57, 3072
    s_add_u32 s57, s57, s39
    s_add_u32 s58, s29, 16
    s_cmp_ge_u32 s58, 20
    s_cselect_b32 s38, 20, 0
    s_sub_u32 s58, s58, s38
    s_mul_i32 s58, s58, 3072
    s_add_u32 s58, s58, s39
    s_add_u32 s59, s29, 17
    s_cmp_ge_u32 s59, 20
    s_cselect_b32 s38, 20, 0
    s_sub_u32 s59, s59, s38
    s_mul_i32 s59, s59, 3072
    s_add_u32 s59, s59, s39
    s_add_u32 s60, s29, 18
    s_cmp_ge_u32 s60, 20
    s_cselect_b32 s38, 20, 0
    s_sub_u32 s60, s60, s38
    s_mul_i32 s60, s60, 3072
    s_add_u32 s60, s60, s39
    s_add_u32 s61, s29, 19
    s_cmp_ge_u32 s61, 20
    s_cselect_b32 s38, 20, 0
    s_sub_u32 s61, s61, s38
    s_mul_i32 s61, s61, 3072
    s_add_u32 s61, s61, s39
    s_mul_i32 s42, s18, 3072
    s_min_u32 s42, s42, 7168
    s_mul_i32 s63, s16, 10240
    s_add_u32 s63, s63, s42
    s_add_u32 s63, s63, 21233664
    s_add_u32 s42, s42, 81920
    s_add_u32 m0, s40, 0
    s_cmp_eq_u32 s18, 3
    s_cbranch_scc1 k2_w3102
    s_waitcnt vmcnt(0)
    s_add_u32 s23, s46, 5
    v_mov_b32 v14, s45
    v_mov_b32 v15, s23
    s_cmp_lg_u32 s27, 0
    s_cbranch_scc1 k2_pubs105
    s_mov_b64 exec, 1
    buffer_store_dword v15, v14, s[8:11], 0 offen offset:0
    s_mov_b64 exec, -1
k2_pub104:
    s_add_u32 s23, s29, 8
    s_cmp_ge_u32 s23, 20
    s_cselect_b32 s38, 20, 0
    s_sub_u32 s23, s23, s38
    s_mul_i32 s23, s23, 3072
    s_add_u32 s23, s23, s39
    buffer_load_dwordx4 v[112:115], v1, s[8:11], s23 offen offset:0
    buffer_load_dwordx4 v[116:119], v1, s[8:11], s23 offen offset:1024
    buffer_load_dwordx4 v[120:123], v1, s[8:11], s23 offen offset:2048
    s_add_u32 s23, s29, 9
    s_cmp_ge_u32 s23, 20
    s_cselect_b32 s38, 20, 0
    s_sub_u32 s23, s23, s38
    s_mul_i32 s23, s23, 3072
    s_add_u32 s23, s23, s39
    buffer_load_dwordx4 v[124:127], v1, s[8:11], s23 offen offset:0
    buffer_load_dwordx4 v[128:131], v1, s[8:11], s23 offen offset:1024
    buffer_load_dwordx4 v[132:135], v1, s[8:11], s23 offen offset:2048
    s_add_u32 s23, s29, 10
    s_cmp_ge_u32 s23, 20
    s_cselect_b32 s38, 20, 0
    s_sub_u32 s23, s23, s38
    s_mul_i32 s23, s23, 3072
    s_add_u32 s23, s23, s39
    buffer_load_dwordx4 v[136:139], v1, s[8:11], s23 offen offset:0
    buffer_load_dwordx4 v[140:143], v1, s[8:11], s23 offen offset:1024
    buffer_load_dwordx4 v[144:147], v1, s[8:11], s23 offen offset:2048
    s_branch k2_sb103
k2_w3102:
    s_waitcnt vmcnt(0)
    s_add_u32 s23, s46, 5
    v_mov_b32 v14, s45
    v_mov_b32 v15, s23
    s_cmp_lg_u32 s27, 0
    s_cbranch_scc1 k2_pubs107
    s_mov_b64 exec, 1
    buffer_store_dword v15, v14, s[8:11], 0 offen offset:0
    s_mov_b64 exec, -1
k2_pub106:
    s_mov_b32 s38, 0
    s_add_u32 s23, s46, 5
k2_poll108:
    buffer_load_dwordx4 v[252:255], v12, s[8:11], 0 offen offset:0 sc1
    s_add_u32 s38, s38, 1
    s_cmp_gt_u32 s38, 60000
    s_cbranch_scc1 k2_pout109
    s_waitcnt vmcnt(0)
    v_subrev_u32 v252, s23, v252
    v_subrev_u32 v253, s23, v253
    v_subrev_u32 v254, s23, v254
    v_subrev_u32 v255, s23, v255
    v_max3_u32 v252, v252, v253, v254
    v_max_u32 v252, v252, v255
    v_cmp_lt_u32 vcc, 15, v252
    s_cbranch_vccnz k2_poll108
k2_pout109:
k2_sb103:
    s_waitcnt lgkmcnt(0)
    s_barrier
    s_cmp_lg_u32 s27, 0
    s_cbranch_scc1 k2_acqs111
k2_acq110:
    buffer_load_dwordx4 v1, s[8:11], s48 offen offset:0 sc1 lds
    buffer_load_dwordx4 v1, s[8:11], s48 offen offset:1024 sc1 lds
    buffer_load_dwordx4 v1, s[8:11], s48 offen offset:2048 sc1 lds
    buffer_load_dwordx4 v1, s[8:11], s48 offen offset:3072 sc1 lds
    s_mov_b32 m0, s42
    v_add_u32 v15, 0x10000, v1
    buffer_load_dwordx4 v1, s[8:11], s63 offen offset:0 sc1 lds
    buffer_load_dwordx4 v1, s[8:11], s63 offen offset:1024 sc1 lds
    buffer_load_dwordx4 v1, s[8:11], s63 offen offset:2048 sc1 lds
    s_add_u32 m0, s40, 16384
    v_lshlrev_b32 v14, 3, v0
    buffer_load_dwordx4 v1, s[8:11], s49 offen offset:0 sc1 lds
    buffer_load_dwordx4 v1, s[8:11], s49 offen offset:1024 sc1 lds
    buffer_load_dwordx4 v1, s[8:11], s49 offen offset:2048 sc1 lds
    buffer_load_dwordx4 v1, s[8:11], s49 offen offset:3072 sc1 lds
    v_add_u32 v14, 81920, v14
    v_add_u32 v10, 4096, v1
    s_waitcnt vmcnt(7)
    s_barrier
    ds_read_b128 v[208:211], v1 offset:0
    ds_read_b128 v[212:215], v1 offset:1024
    ds_read_b128 v[216:219], v1 offset:2048
    ds_read_b128 v[220:223], v1 offset:3072
    s_waitcnt lgkmcnt(3)
    v_mfma_f32_16x16x32_bf16 v[160:163], v[16:19], v[208:211], 0
    v_mfma_f32_16x16x32_bf16 v[176:179], v[20:23], v[208:211], 0
    ds_read_b128 v[224:227], v1 offset:4096
    v_mfma_f32_16x16x32_bf16 v[192:195], v[24:27], v[208:211], 0
    s_waitcnt lgkmcnt(3)
    v_mfma_f32_16x16x32_bf16 v[164:167], v[16:19], v[212:215], 0
    ds_read_b128 v[228:231], v1 offset:5120
    s_add_u32 m0, s40, 32768
    v_mfma_f32_16x16x32_bf16 v[180:183], v[20:23], v[212:215], 0
    buffer_load_dwordx4 v1, s[8:11], s50 offen offset:0 sc1 lds
    v_mfma_f32_16x16x32_bf16 v[196:199], v[24:27], v[212:215], 0
    ds_read_b128 v[232:235], v1 offset:6144
    s_waitcnt lgkmcnt(4)
    v_mfma_f32_16x16x32_bf16 v[168:171], v[16:19], v[216:219], 0
    buffer_load_dwordx4 v1, s[8:11], s50 offen offset:1024 sc1 lds
    v_mfma_f32_16x16x32_bf16 v[184:187], v[20:23], v[216:219], 0
    ds_read_b128 v[236:239], v1 offset:7168
    v_mfma_f32_16x16x32_bf16 v[200:203], v[24:27], v[216:219], 0
    buffer_load_dwordx4 v1, s[8:11], s50 offen offset:2048 sc1 lds
    s_waitcnt lgkmcnt(4)
    v_mfma_f32_16x16x32_bf16 v[172:175], v[16:19], v[220:223], 0
    v_mfma_f32_16x16x32_bf16 v[188:191], v[20:23], v[220:223], 0
    v_mfma_f32_16x16x32_bf16 v[204:207], v[24:27], v[220:223], 0
    s_waitcnt lgkmcnt(3)
    v_mfma_f32_16x16x32_bf16 v[160:163], v[28:31], v[224:227], v[160:163]
    v_mfma_f32_16x16x32_bf16 v[176:179], v[32:35], v[224:227], v[176:179]
    ds_read_b128 v[208:211], v1 offset:8192
    v_mfma_f32_16x16x32_bf16 v[192:195], v[36:39], v[224:227], v[192:195]
    s_waitcnt lgkmcnt(3)
    v_mfma_f32_16x16x32_bf16 v[164:167], v[28:31], v[228:231], v[164:167]
    ds_read_b128 v[212:215], v1 offset:9216
    v_mfma_f32_16x16x32_bf16 v[180:183], v[32:35], v[228:231], v[180:183]
    buffer_load_dwordx4 v1, s[8:11], s50 offen offset:3072 sc1 lds
    v_mfma_f32_16x16x32_bf16 v[196:199], v[36:39], v[228:231], v[196:199]
    ds_read_b128 v[216:219], v1 offset:10240
    s_waitcnt lgkmcnt(4)
    v_mfma_f32_16x16x32_bf16 v[168:171], v[28:31], v[232:235], v[168:171]
    buffer_load_dwordx4 v[148:151], v1, s[8:11], s53 offen offset:0
    v_mfma_f32_16x16x32_bf16 v[184:187], v[32:35], v[232:235], v[184:187]
    ds_read_b128 v[220:223], v1 offset:11264
    v_mfma_f32_16x16x32_bf16 v[200:203], v[36:39], v[232:235], v[200:203]
    buffer_load_dwordx4 v[152:155], v1, s[8:11], s53 offen offset:1024
    s_waitcnt lgkmcnt(4)
    v_mfma_f32_16x16x32_bf16 v[172:175], v[28:31], v[236:239], v[172:175]
    v_mfma_f32_16x16x32_bf16 v[188:191], v[32:35], v[236:239], v[188:191]
    v_mfma_f32_16x16x32_bf16 v[204:207], v[36:39], v[236:239], v[204:207]
    s_waitcnt lgkmcnt(3)
    v_mfma_f32_16x16x32_bf16 v[160:163], v[40:43], v[208:211], v[160:163]
    v_mfma_f32_16x16x32_bf16 v[176:179], v[44:47], v[208:211], v[176:179]
    ds_read_b128 v[224:227], v1 offset:12288
    v_mfma_f32_16x16x32_bf16 v[192:195], v[48:51], v[208:211], v[192:195]
    s_waitcnt lgkmcnt(3)
    v_mfma_f32_16x16x32_bf16 v[164:167], v[40:43], v[212:215], v[164:167]
    ds_read_b128 v[228:231], v1 offset:13312
    v_mfma_f32_16x16x32_bf16 v[180:183], v[44:47], v[212:215], v[180:183]
    buffer_load_dwordx4 v[156:159], v1, s[8:11], s53 offen offset:2048
    v_mfma_f32_16x16x32_bf16 v[196:199], v[48:51], v[212:215], v[196:199]
    ds_read_b128 v[232:235], v1 offset:14336
    s_add_u32 m0, s40, 49152
    s_waitcnt lgkmcnt(4)
    v_mfma_f32_16x16x32_bf16 v[168:171], v[40:43], v[216:219], v[168:171]
    buffer_load_dwordx4 v1, s[8:11], s51 offen offset:0 sc1 lds
    v_mfma_f32_16x16x32_bf16 v[184:187], v[44:47], v[216:219], v[184:187]
    ds_read_b128 v[236:239], v1 offset:15360
    v_mfma_f32_16x16x32_bf16 v[200:203], v[48:51], v[216:219], v[200:203]
    buffer_load_dwordx4 v1, s[8:11], s51 offen offset:1024 sc1 lds
    s_waitcnt lgkmcnt(4)
    v_mfma_f32_16x16x32_bf16 v[172:175], v[40:43], v[220:223], v[172:175]
    v_mfma_f32_16x16x32_bf16 v[188:191], v[44:47], v[220:223], v[188:191]
    v_mfma_f32_16x16x32_bf16 v[204:207], v[48:51], v[220:223], v[204:207]
    s_waitcnt lgkmcnt(3)
    v_mfma_f32_16x16x32_bf16 v[160:163], v[52:55], v[224:227], v[160:163]
    s_waitcnt vmcnt(9)
    s_barrier
    v_mfma_f32_16x16x32_bf16 v[176:179], v[56:59], v[224:227], v[176:179]
    ds_read_b128 v[208:211], v1 offset:16384
    v_mfma_f32_16x16x32_bf16 v[192:195], v[60:63], v[224:227], v[192:195]
    s_waitcnt lgkmcnt(3)
    v_mfma_f32_16x16x32_bf16 v[164:167], v[52:55], v[228:231], v[164:167]
    ds_read_b128 v[212:215], v1 offset:17408
    v_mfma_f32_16x16x32_bf16 v[180:183], v[56:59], v[228:231], v[180:183]
    buffer_load_dwordx4 v1, s[8:11], s51 offen offset:2048 sc1 lds
    v_mfma_f32_16x16x32_bf16 v[196:199], v[60:63], v[228:231], v[196:199]
    ds_read_b128 v[216:219], v1 offset:18432
    s_waitcnt lgkmcnt(4)
    v_mfma_f32_16x16x32_bf16 v[168:171], v[52:55], v[232:235], v[168:171]
    buffer_load_dwordx4 v1, s[8:11], s51 offen offset:3072 sc1 lds
    v_mfma_f32_16x16x32_bf16 v[184:187], v[56:59], v[232:235], v[184:187]
    ds_read_b128 v[220:223], v1 offset:19456
    v_mfma_f32_16x16x32_bf16 v[200:203], v[60:63], v[232:235], v[200:203]
    buffer_load_dwordx4 v[16:19], v1, s[8:11], s54 offen offset:0
    s_waitcnt lgkmcnt(4)
    v_mfma_f32_16x16x32_bf16 v[172:175], v[52:55], v[236:239], v[172:175]
    v_mfma_f32_16x16x32_bf16 v[188:191], v[56:59], v[236:239], v[188:191]
    v_mfma_f32_16x16x32_bf16 v[204:207], v[60:63], v[236:239], v[204:207]
    s_waitcnt lgkmcnt(3)
    v_mfma_f32_16x16x32_bf16 v[160:163], v[64:67], v[208:211], v[160:163]
    ds_read2st64_b64 v[248:251], v14 offset0:0 offset1:1
    v_mfma_f32_16x16x32_bf16 v[176:179], v[68:71], v[208:211], v[176:179]
    ds_read_b128 v[224:227], v1 offset:20480
    v_mfma_f32_16x16x32_bf16 v[192:195], v[72:75], v[208:211], v[192:195]
    ds_read2st64_b64 v[252:255], v14 offset0:2 offset1:3
    s_waitcnt lgkmcnt(5)
    v_mfma_f32_16x16x32_bf16 v[164:167], v[64:67], v[212:215], v[164:167]
    ds_read_b128 v[228:231], v1 offset:21504
    v_mfma_f32_16x16x32_bf16 v[180:183], v[68:71], v[212:215], v[180:183]
    buffer_load_dwordx4 v[20:23], v1, s[8:11], s54 offen offset:1024
    v_mfma_f32_16x16x32_bf16 v[196:199], v[72:75], v[212:215], v[196:199]
    ds_read_b128 v[232:235], v1 offset:22528
    s_waitcnt lgkmcnt(6)
    v_mfma_f32_16x16x32_bf16 v[168:171], v[64:67], v[216:219], v[168:171]
    buffer_load_dwordx4 v[24:27], v1, s[8:11], s54 offen offset:2048
    v_mfma_f32_16x16x32_bf16 v[184:187], v[68:71], v[216:219], v[184:187]
    ds_read_b128 v[236:239], v1 offset:23552
    v_mfma_f32_16x16x32_bf16 v[200:203], v[72:75], v[216:219], v[200:203]
    buffer_load_dwordx4 v[28:31], v1, s[8:11], s55 offen offset:0
    s_waitcnt lgkmcnt(6)
    v_mfma_f32_16x16x32_bf16 v[172:175], v[64:67], v[220:223], v[172:175]
    s_waitcnt lgkmcnt(3)
    v_add_f32 v248, v248, v250
    v_add_f32 v249, v249, v251
    v_mfma_f32_16x16x32_bf16 v[188:191], v[68:71], v[220:223], v[188:191]
    v_add_f32 v252, v252, v254
    v_add_f32 v253, v253, v255
    v_mfma_f32_16x16x32_bf16 v[204:207], v[72:75], v[220:223], v[204:207]
    v_add_f32 v244, v248, v252
    v_add_f32 v245, v249, v253
    v_mfma_f32_16x16x32_bf16 v[160:163], v[76:79], v[224:227], v[160:163]
    ds_read2st64_b64 v[248:251], v14 offset0:4 offset1:5
    v_mfma_f32_16x16x32_bf16 v[176:179], v[80:83], v[224:227], v[176:179]
    ds_read_b128 v[208:211], v1 offset:24576
    v_mfma_f32_16x16x32_bf16 v[192:195], v[84:87], v[224:227], v[192:195]
    ds_read2st64_b64 v[252:255], v14 offset0:6 offset1:7
    s_waitcnt lgkmcnt(5)
    v_mfma_f32_16x16x32_bf16 v[164:167], v[76:79], v[228:231], v[164:167]
    ds_read_b128 v[212:215], v1 offset:25600
    v_mfma_f32_16x16x32_bf16 v[180:183], v[80:83], v[228:231], v[180:183]
    buffer_load_dwordx4 v[32:35], v1, s[8:11], s55 offen offset:1024
    v_mfma_f32_16x16x32_bf16 v[196:199], v[84:87], v[228:231], v[196:199]
    ds_read_b128 v[216:219], v1 offset:26624
    s_waitcnt lgkmcnt(6)
    v_mfma_f32_16x16x32_bf16 v[168:171], v[76:79], v[232:235], v[168:171]
    buffer_load_dwordx4 v[36:39], v1, s[8:11], s55 offen offset:2048
    v_mfma_f32_16x16x32_bf16 v[184:187], v[80:83], v[232:235], v[184:187]
    ds_read_b128 v[220:223], v1 offset:27648
    v_mfma_f32_16x16x32_bf16 v[200:203], v[84:87], v[232:235], v[200:203]
    buffer_load_dwordx4 v[40:43], v1, s[8:11], s56 offen offset:0
    s_waitcnt lgkmcnt(6)
    v_mfma_f32_16x16x32_bf16 v[172:175], v[76:79], v[236:239], v[172:175]
    s_waitcnt lgkmcnt(3)
    v_add_f32 v248, v248, v250
    v_add_f32 v249, v249, v251
    v_mfma_f32_16x16x32_bf16 v[188:191], v[80:83], v[236:239], v[188:191]
    v_add_f32 v252, v252, v254
    v_add_f32 v253, v253, v255
    v_mfma_f32_16x16x32_bf16 v[204:207], v[84:87], v[236:239], v[204:207]
    v_add_f32 v244, v244, v248
    v_add_f32 v245, v245, v249
    v_add_f32 v244, v244, v252
    v_add_f32 v245, v245, v253
    v_mfma_f32_16x16x32_bf16 v[160:163], v[88:91], v[208:211], v[160:163]
    ds_read2st64_b64 v[248:251], v14 offset0:8 offset1:9
    v_mfma_f32_16x16x32_bf16 v[176:179], v[92:95], v[208:211], v[176:179]
    ds_read_b128 v[224:227], v1 offset:28672
    v_mfma_f32_16x16x32_bf16 v[192:195], v[96:99], v[208:211], v[192:195]
    ds_read2st64_b64 v[252:255], v14 offset0:10 offset1:11
    s_waitcnt lgkmcnt(5)
    v_mfma_f32_16x16x32_bf16 v[164:167], v[88:91], v[212:215], v[164:167]
    ds_read_b128 v[228:231], v1 offset:29696
    v_mfma_f32_16x16x32_bf16 v[180:183], v[92:95], v[212:215], v[180:183]
    buffer_load_dwordx4 v[44:47], v1, s[8:11], s56 offen offset:1024
    v_mfma_f32_16x16x32_bf16 v[196:199], v[96:99], v[212:215], v[196:199]
    ds_read_b128 v[232:235], v1 offset:30720
    s_waitcnt lgkmcnt(6)
    v_mfma_f32_16x16x32_bf16 v[168:171], v[88:91], v[216:219], v[168:171]
    buffer_load_dwordx4 v[48:51], v1, s[8:11], s56 offen offset:2048
    v_mfma_f32_16x16x32_bf16 v[184:187], v[92:95], v[216:219], v[184:187]
    ds_read_b128 v[236:239], v1 offset:31744
    v_mfma_f32_16x16x32_bf16 v[200:203], v[96:99], v[216:219], v[200:203]
    buffer_load_dwordx4 v[52:55], v1, s[8:11], s57 offen offset:0
    s_waitcnt lgkmcnt(6)
    v_mfma_f32_16x16x32_bf16 v[172:175], v[88:91], v[220:223], v[172:175]
    s_waitcnt lgkmcnt(3)
    v_add_f32 v248, v248, v250
    v_add_f32 v249, v249, v251
    v_mfma_f32_16x16x32_bf16 v[188:191], v[92:95], v[220:223], v[188:191]
    v_add_f32 v252, v252, v254
    v_add_f32 v253, v253, v255
    v_mfma_f32_16x16x32_bf16 v[204:207], v[96:99], v[220:223], v[204:207]
    v_add_f32 v244, v244, v248
    v_add_f32 v245, v245, v249
    v_add_f32 v244, v244, v252
    v_add_f32 v245, v245, v253
    v_mfma_f32_16x16x32_bf16 v[160:163], v[100:103], v[224:227], v[160:163]
    s_waitcnt vmcnt(17)
    s_barrier
    ds_read2st64_b64 v[248:251], v14 offset0:12 offset1:13
    v_mfma_f32_16x16x32_bf16 v[176:179], v[104:107], v[224:227], v[176:179]
    ds_read_b128 v[208:211], v1 offset:32768
    v_mfma_f32_16x16x32_bf16 v[192:195], v[108:111], v[224:227], v[192:195]
    ds_read2st64_b64 v[252:255], v14 offset0:14 offset1:15
    s_waitcnt lgkmcnt(5)
    v_mfma_f32_16x16x32_bf16 v[164:167], v[100:103], v[228:231], v[164:167]
    ds_read_b128 v[212:215], v1 offset:33792
    v_mfma_f32_16x16x32_bf16 v[180:183], v[104:107], v[228:231], v[180:183]
    buffer_load_dwordx4 v[56:59], v1, s[8:11], s57 offen offset:1024
    v_mfma_f32_16x16x32_bf16 v[196:199], v[108:111], v[228:231], v[196:199]
    ds_read_b128 v[216:219], v1 offset:34816
    s_waitcnt lgkmcnt(6)
    v_mfma_f32_16x16x32_bf16 v[168:171], v[100:103], v[232:235], v[168:171]
    buffer_load_dwordx4 v[60:63], v1, s[8:11], s57 offen offset:2048
    v_mfma_f32_16x16x32_bf16 v[184:187], v[104:107], v[232:235], v[184:187]
    ds_read_b128 v[220:223], v1 offset:35840
    s_add_u32 m0, s40, 65536
    v_mfma_f32_16x16x32_bf16 v[200:203], v[108:111], v[232:235], v[200:203]
    buffer_load_dwordx4 v1, s[8:11], s52 offen offset:0 sc1 lds
    s_waitcnt lgkmcnt(6)
    v_mfma_f32_16x16x32_bf16 v[172:175], v[100:103], v[236:239], v[172:175]
    s_waitcnt lgkmcnt(3)
    v_add_f32 v248, v248, v250
    v_add_f32 v249, v249, v251
    v_mfma_f32_16x16x32_bf16 v[188:191], v[104:107], v[236:239], v[188:191]
    v_add_f32 v252, v252, v254
    v_add_f32 v253, v253, v255
    v_mfma_f32_16x16x32_bf16 v[204:207], v[108:111], v[236:239], v[204:207]
    v_add_f32 v244, v244, v248
    v_add_f32 v245, v245, v249
    v_add_f32 v244, v244, v252
    v_add_f32 v245, v245, v253
    v_mfma_f32_16x16x32_bf16 v[160:163], v[112:115], v[208:211], v[160:163]
    ds_read2st64_b64 v[248:251], v14 offset0:16 offset1:17
    v_mfma_f32_16x16x32_bf16 v[176:179], v[116:119], v[208:211], v[176:179]
    ds_read_b128 v[224:227], v1 offset:36864
    v_mfma_f32_16x16x32_bf16 v[192:195], v[120:123], v[208:211], v[192:195]
    ds_read2st64_b64 v[252:255], v14 offset0:18 offset1:19
    s_waitcnt lgkmcnt(5)
    v_mfma_f32_16x16x32_bf16 v[164:167], v[112:115], v[212:215], v[164:167]
    ds_read_b128 v[228:231], v1 offset:37888
    v_mfma_f32_16x16x32_bf16 v[180:183], v[116:119], v[212:215], v[180:183]
    buffer_load_dwordx4 v1, s[8:11], s52 offen offset:1024 sc1 lds
    v_mfma_f32_16x16x32_bf16 v[196:199], v[120:123], v[212:215], v[196:199]
    ds_read_b128 v[232:235], v1 offset:38912
    s_waitcnt lgkmcnt(6)
    v_mfma_f32_16x16x32_bf16 v[168:171], v[112:115], v[216:219], v[168:171]
    buffer_load_dwordx4 v1, s[8:11], s52 offen offset:2048 sc1 lds
    v_mfma_f32_16x16x32_bf16 v[184:187], v[116:119], v[216:219], v[184:187]
    ds_read_b128 v[236:239], v1 offset:39936
    v_mfma_f32_16x16x32_bf16 v[200:203], v[120:123], v[216:219], v[200:203]
    buffer_load_dwordx4 v1, s[8:11], s52 offen offset:3072 sc1 lds
    s_waitcnt lgkmcnt(6)
    v_mfma_f32_16x16x32_bf16 v[172:175], v[112:115], v[220:223], v[172:175]
    s_waitcnt lgkmcnt(3)
    v_add_f32 v248, v248, v250
    v_add_f32 v249, v249, v251
    v_mfma_f32_16x16x32_bf16 v[188:191], v[116:119], v[220:223], v[188:191]
    v_add_f32 v252, v252, v254
    v_add_f32 v253, v253, v255
    v_mfma_f32_16x16x32_bf16 v[204:207], v[120:123], v[220:223], v[204:207]
    v_add_f32 v244, v244, v248
    v_add_f32 v245, v245, v249
    v_add_f32 v244, v244, v252
    v_add_f32 v245, v245, v253
    v_mfma_f32_16x16x32_bf16 v[160:163], v[124:127], v[224:227], v[160:163]
    v_mul_f32 v244, 0x3acccccd, v244
    v_mfma_f32_16x16x32_bf16 v[176:179], v[128:131], v[224:227], v[176:179]
    ds_read_b128 v[208:211], v1 offset:40960
    v_mul_f32 v245, 0x3acccccd, v245
    v_mfma_f32_16x16x32_bf16 v[192:195], v[132:135], v[224:227], v[192:195]
    v_fma_f32 v245, -v244, v244, v245
    s_waitcnt lgkmcnt(3)
    v_mfma_f32_16x16x32_bf16 v[164:167], v[124:127], v[228:231], v[164:167]
    ds_read_b128 v[212:215], v1 offset:41984
    v_max_f32 v245, 0, v245
    v_mfma_f32_16x16x32_bf16 v[180:183], v[128:131], v[228:231], v[180:183]
    buffer_load_dwordx4 v[64:67], v1, s[8:11], s58 offen offset:0
    v_add_f32 v245, 0x3727c5ac, v245
    v_mfma_f32_16x16x32_bf16 v[196:199], v[132:135], v[228:231], v[196:199]
    ds_read_b128 v[216:219], v1 offset:43008
    v_rsq_f32 v245, v245
    s_waitcnt lgkmcnt(4)
    v_mfma_f32_16x16x32_bf16 v[168:171], v[124:127], v[232:235], v[168:171]
    buffer_load_dwordx4 v[68:71], v1, s[8:11], s58 offen offset:1024
    v_and_b32 v246, 15, v0
    v_mfma_f32_16x16x32_bf16 v[184:187], v[128:131], v[232:235], v[184:187]
    ds_read_b128 v[220:223], v1 offset:44032
    v_lshlrev_b32 v246, 2, v246
    v_mfma_f32_16x16x32_bf16 v[200:203], v[132:135], v[232:235], v[200:203]
    buffer_load_dwordx4 v[72:75], v1, s[8:11], s58 offen offset:2048
    s_lshl_b32 s23, s18, 6
    s_waitcnt lgkmcnt(4)
    v_mfma_f32_16x16x32_bf16 v[172:175], v[124:127], v[236:239], v[172:175]
    v_add_u32 v247, s23, v246
    v_mfma_f32_16x16x32_bf16 v[188:191], v[128:131], v[236:239], v[188:191]
    v_sub_f32 v244, 0, v244
    v_mfma_f32_16x16x32_bf16 v[204:207], v[132:135], v[236:239], v[204:207]
    s_waitcnt lgkmcnt(3)
    v_mfma_f32_16x16x32_bf16 v[160:163], v[136:139], v[208:211], v[160:163]
    ds_bpermute_b32 v248, v246, v244 offset:0
    v_mfma_f32_16x16x32_bf16 v[176:179], v[140:143], v[208:211], v[176:179]
    ds_read_b128 v[224:227], v1 offset:45056
    v_mfma_f32_16x16x32_bf16 v[192:195], v[144:147], v[208:211], v[192:195]
    ds_bpermute_b32 v250, v246, v244 offset:64
    s_waitcnt lgkmcnt(5)
    v_mfma_f32_16x16x32_bf16 v[164:167], v[136:139], v[212:215], v[164:167]
    ds_read_b128 v[228:231], v1 offset:46080
    v_mfma_f32_16x16x32_bf16 v[180:183], v[140:143], v[212:215], v[180:183]
    buffer_load_dwordx4 v[76:79], v1, s[8:11], s59 offen offset:0
    v_mfma_f32_16x16x32_bf16 v[196:199], v[144:147], v[212:215], v[196:199]
    ds_read_b128 v[232:235], v1 offset:47104
    s_waitcnt lgkmcnt(6)
    v_mfma_f32_16x16x32_bf16 v[168:171], v[136:139], v[216:219], v[168:171]
    buffer_load_dwordx4 v[80:83], v1, s[8:11], s59 offen offset:1024
    v_mfma_f32_16x16x32_bf16 v[184:187], v[140:143], v[216:219], v[184:187]
    ds_read_b128 v[236:239], v1 offset:48128
    v_mfma_f32_16x16x32_bf16 v[200:203], v[144:147], v[216:219], v[200:203]
    buffer_load_dwordx4 v[84:87], v1, s[8:11], s59 offen offset:2048
    s_waitcnt lgkmcnt(6)
    v_mfma_f32_16x16x32_bf16 v[172:175], v[136:139], v[220:223], v[172:175]
    ds_bpermute_b32 v252, v246, v244 offset:128
    v_mfma_f32_16x16x32_bf16 v[188:191], v[140:143], v[220:223], v[188:191]
    ds_bpermute_b32 v254, v246, v244 offset:192
    v_mfma_f32_16x16x32_bf16 v[204:207], v[144:147], v[220:223], v[204:207]
    ds_bpermute_b32 v7, v247, v245
    s_waitcnt vmcnt(26)
    s_waitcnt lgkmcnt(7)
    v_mfma_f32_16x16x32_bf16 v[160:163], v[148:151], v[224:227], v[160:163]
    s_waitcnt vmcnt(22)
    s_barrier
    v_mfma_f32_16x16x32_bf16 v[176:179], v[152:155], v[224:227], v[176:179]
    ds_read_b128 v[208:211], v1 offset:49152
    v_mfma_f32_16x16x32_bf16 v[192:195], v[156:159], v[224:227], v[192:195]
    s_waitcnt lgkmcnt(6)
    v_mfma_f32_16x16x32_bf16 v[164:167], v[148:151], v[228:231], v[164:167]
    ds_read_b128 v[212:215], v1 offset:50176
    buffer_load_dwordx4 v[88:91], v1, s[8:11], s60 offen offset:0
    v_mfma_f32_16x16x32_bf16 v[180:183], v[152:155], v[228:231], v[180:183]
    v_mfma_f32_16x16x32_bf16 v[196:199], v[156:159], v[228:231], v[196:199]
    ds_read_b128 v[216:219], v1 offset:51200
    buffer_load_dwordx4 v[92:95], v1, s[8:11], s60 offen offset:1024
    s_waitcnt lgkmcnt(7)
    v_mfma_f32_16x16x32_bf16 v[168:171], v[148:151], v[232:235], v[168:171]
    v_mfma_f32_16x16x32_bf16 v[184:187], v[152:155], v[232:235], v[184:187]
    ds_read_b128 v[220:223], v1 offset:52224
    buffer_load_dwordx4 v[96:99], v1, s[8:11], s60 offen offset:2048
    v_mfma_f32_16x16x32_bf16 v[200:203], v[156:159], v[232:235], v[200:203]
    s_waitcnt lgkmcnt(7)
    v_mfma_f32_16x16x32_bf16 v[172:175], v[148:151], v[236:239], v[172:175]
    buffer_load_dwordx4 v[100:103], v1, s[8:11], s61 offen offset:0
    v_mfma_f32_16x16x32_bf16 v[188:191], v[152:155], v[236:239], v[188:191]
    v_mfma_f32_16x16x32_bf16 v[204:207], v[156:159], v[236:239], v[204:207]
    s_waitcnt vmcnt(23)
    s_waitcnt lgkmcnt(3)
    v_mfma_f32_16x16x32_bf16 v[160:163], v[16:19], v[208:211], v[160:163]
    v_mfma_f32_16x16x32_bf16 v[176:179], v[20:23], v[208:211], v[176:179]
    ds_read_b128 v[224:227], v1 offset:53248
    v_mfma_f32_16x16x32_bf16 v[192:195], v[24:27], v[208:211], v[192:195]
    s_waitcnt lgkmcnt(3)
    v_mfma_f32_16x16x32_bf16 v[164:167], v[16:19], v[212:215], v[164:167]
    ds_read_b128 v[228:231], v1 offset:54272
    buffer_load_dwordx4 v[104:107], v1, s[8:11], s61 offen offset:1024
    v_mfma_f32_16x16x32_bf16 v[180:183], v[20:23], v[212:215], v[180:183]
    v_mfma_f32_16x16x32_bf16 v[196:199], v[24:27], v[212:215], v[196:199]
    ds_read_b128 v[232:235], v1 offset:55296
    buffer_load_dwordx4 v[108:111], v1, s[8:11], s61 offen offset:2048
    s_waitcnt lgkmcnt(4)
    v_mfma_f32_16x16x32_bf16 v[168:171], v[16:19], v[216:219], v[168:171]
    s_mul_i32 s23, s17, 6
    v_mfma_f32_16x16x32_bf16 v[184:187], v[20:23], v[216:219], v[184:187]
    ds_read_b128 v[236:239], v1 offset:56320
    v_mfma_f32_16x16x32_bf16 v[200:203], v[24:27], v[216:219], v[200:203]
    s_add_u32 s41, s23, s18
    s_waitcnt lgkmcnt(4)
    v_mfma_f32_16x16x32_bf16 v[172:175], v[16:19], v[220:223], v[172:175]
    v_mfma_f32_16x16x32_bf16 v[188:191], v[20:23], v[220:223], v[188:191]
    s_lshl_b32 s41, s41, 12
    v_mfma_f32_16x16x32_bf16 v[204:207], v[24:27], v[220:223], v[204:207]
    s_add_u32 s41, s41, s28
    s_waitcnt vmcnt(22)
    s_waitcnt lgkmcnt(3)
    v_mfma_f32_16x16x32_bf16 v[160:163], v[28:31], v[224:227], v[160:163]
    s_add_u32 s41, s41, 14942208
    v_mfma_f32_16x16x32_bf16 v[176:179], v[32:35], v[224:227], v[176:179]
    ds_read_b128 v[208:211], v1 offset:57344
    s_lshr_b32 s42, s18, 1
    v_mfma_f32_16x16x32_bf16 v[192:195], v[36:39], v[224:227], v[192:195]
    s_add_u32 s42, s42, s23
    s_waitcnt lgkmcnt(3)
    v_mfma_f32_16x16x32_bf16 v[164:167], v[28:31], v[228:231], v[164:167]
    ds_read_b128 v[212:215], v1 offset:58368
    v_mfma_f32_16x16x32_bf16 v[180:183], v[32:35], v[228:231], v[180:183]
    s_add_u32 s42, s42, 4
    v_mfma_f32_16x16x32_bf16 v[196:199], v[36:39], v[228:231], v[196:199]
    ds_read_b128 v[216:219], v1 offset:59392
    s_waitcnt lgkmcnt(4)
    v_mfma_f32_16x16x32_bf16 v[168:171], v[28:31], v[232:235], v[168:171]
    s_lshl_b32 s42, s42, 12
    v_mfma_f32_16x16x32_bf16 v[184:187], v[32:35], v[232:235], v[184:187]
    ds_read_b128 v[220:223], v1 offset:60416
    v_mfma_f32_16x16x32_bf16 v[200:203], v[36:39], v[232:235], v[200:203]
    s_add_u32 s42, s42, s28
    s_waitcnt lgkmcnt(4)
    v_mfma_f32_16x16x32_bf16 v[172:175], v[28:31], v[236:239], v[172:175]
    v_mfma_f32_16x16x32_bf16 v[188:191], v[32:35], v[236:239], v[188:191]
    s_add_u32 s42, s42, 14942208
    v_mfma_f32_16x16x32_bf16 v[204:207], v[36:39], v[236:239], v[204:207]
    s_mul_i32 s43, s18, 49152
    s_waitcnt vmcnt(19)
    s_waitcnt lgkmcnt(3)
    v_mfma_f32_16x16x32_bf16 v[160:163], v[40:43], v[208:211], v[160:163]
    s_add_u32 s43, s43, s28
    v_mfma_f32_16x16x32_bf16 v[176:179], v[44:47], v[208:211], v[176:179]
    ds_read_b128 v[224:227], v1 offset:61440
    s_add_u32 s43, s43, 14942208
    v_mfma_f32_16x16x32_bf16 v[192:195], v[48:51], v[208:211], v[192:195]
    s_lshl_b32 s47, s30, 12
    s_waitcnt lgkmcnt(3)
    v_mfma_f32_16x16x32_bf16 v[164:167], v[40:43], v[212:215], v[164:167]
    ds_read_b128 v[228:231], v1 offset:62464
    v_mfma_f32_16x16x32_bf16 v[180:183], v[44:47], v[212:215], v[180:183]
    s_add_u32 s52, s47, s43
    v_mfma_f32_16x16x32_bf16 v[196:199], v[48:51], v[212:215], v[196:199]
    ds_read_b128 v[232:235], v1 offset:63488
    s_waitcnt lgkmcnt(4)
    v_mfma_f32_16x16x32_bf16 v[168:171], v[40:43], v[216:219], v[168:171]
    s_add_u32 s43, s43, 49152
    v_mfma_f32_16x16x32_bf16 v[184:187], v[44:47], v[216:219], v[184:187]
    ds_read_b128 v[236:239], v1 offset:64512
    v_mfma_f32_16x16x32_bf16 v[200:203], v[48:51], v[216:219], v[200:203]
    s_add_u32 s53, s52, 4096
    s_waitcnt lgkmcnt(4)
    v_mfma_f32_16x16x32_bf16 v[172:175], v[40:43], v[220:223], v[172:175]
    v_mfma_f32_16x16x32_bf16 v[188:191], v[44:47], v[220:223], v[188:191]
    s_cmp_ge_u32 s53, s43
    s_cselect_b32 s38, 49152, 0
    v_mfma_f32_16x16x32_bf16 v[204:207], v[48:51], v[220:223], v[204:207]
    s_sub_u32 s53, s53, s38
    s_waitcnt vmcnt(16)
    s_waitcnt lgkmcnt(3)
    v_mfma_f32_16x16x32_bf16 v[160:163], v[52:55], v[224:227], v[160:163]
    s_waitcnt vmcnt(12)
    s_barrier
    s_add_u32 s54, s53, 4096
    v_mfma_f32_16x16x32_bf16 v[176:179], v[56:59], v[224:227], v[176:179]
    ds_read_b128 v[208:211], v15 offset:0
    s_cmp_ge_u32 s54, s43
    s_cselect_b32 s38, 49152, 0
    v_mfma_f32_16x16x32_bf16 v[192:195], v[60:63], v[224:227], v[192:195]
    s_sub_u32 s54, s54, s38
    s_waitcnt lgkmcnt(3)
    v_mfma_f32_16x16x32_bf16 v[164:167], v[52:55], v[228:231], v[164:167]
    ds_read_b128 v[212:215], v15 offset:1024
    v_mfma_f32_16x16x32_bf16 v[180:183], v[56:59], v[228:231], v[180:183]
    s_add_u32 s55, s54, 4096
    v_mfma_f32_16x16x32_bf16 v[196:199], v[60:63], v[228:231], v[196:199]
    ds_read_b128 v[216:219], v15 offset:2048
    s_waitcnt lgkmcnt(4)
    v_mfma_f32_16x16x32_bf16 v[168:171], v[52:55], v[232:235], v[168:171]
    s_cmp_ge_u32 s55, s43
    s_cselect_b32 s38, 49152, 0
    v_mfma_f32_16x16x32_bf16 v[184:187], v[56:59], v[232:235], v[184:187]
    ds_read_b128 v[220:223], v15 offset:3072
    v_mfma_f32_16x16x32_bf16 v[200:203], v[60:63], v[232:235], v[200:203]
    s_sub_u32 s55, s55, s38
    s_waitcnt lgkmcnt(4)
    v_mfma_f32_16x16x32_bf16 v[172:175], v[52:55], v[236:239], v[172:175]
    v_mfma_f32_16x16x32_bf16 v[188:191], v[56:59], v[236:239], v[188:191]
    s_add_u32 s56, s55, 4096
    v_mfma_f32_16x16x32_bf16 v[204:207], v[60:63], v[236:239], v[204:207]
    s_cmp_ge_u32 s56, s43
    s_cselect_b32 s38, 49152, 0
    s_waitcnt vmcnt(9)
    s_waitcnt lgkmcnt(3)
    v_mfma_f32_16x16x32_bf16 v[160:163], v[64:67], v[208:211], v[160:163]
    s_sub_u32 s56, s56, s38
    v_mfma_f32_16x16x32_bf16 v[176:179], v[68:71], v[208:211], v[176:179]
    ds_read_b128 v[224:227], v15 offset:4096
    s_add_u32 s57, s56, 4096
    v_mfma_f32_16x16x32_bf16 v[192:195], v[72:75], v[208:211], v[192:195]
    s_cmp_ge_u32 s57, s43
    s_cselect_b32 s38, 49152, 0
    s_waitcnt lgkmcnt(3)
    v_mfma_f32_16x16x32_bf16 v[164:167], v[64:67], v[212:215], v[164:167]
    ds_read_b128 v[228:231], v15 offset:5120
    v_mfma_f32_16x16x32_bf16 v[180:183], v[68:71], v[212:215], v[180:183]
    s_sub_u32 s57, s57, s38
    v_mfma_f32_16x16x32_bf16 v[196:199], v[72:75], v[212:215], v[196:199]
    ds_read_b128 v[232:235], v15 offset:6144
    s_waitcnt lgkmcnt(4)
    v_mfma_f32_16x16x32_bf16 v[168:171], v[64:67], v[216:219], v[168:171]
    s_add_u32 s58, s57, 4096
    v_mfma_f32_16x16x32_bf16 v[184:187], v[68:71], v[216:219], v[184:187]
    ds_read_b128 v[236:239], v15 offset:7168
    v_mfma_f32_16x16x32_bf16 v[200:203], v[72:75], v[216:219], v[200:203]
    s_cmp_ge_u32 s58, s43
    s_cselect_b32 s38, 49152, 0
    s_waitcnt lgkmcnt(4)
    v_mfma_f32_16x16x32_bf16 v[172:175], v[64:67], v[220:223], v[172:175]
    v_mfma_f32_16x16x32_bf16 v[188:191], v[68:71], v[220:223], v[188:191]
    s_sub_u32 s58, s58, s38
    v_mfma_f32_16x16x32_bf16 v[204:207], v[72:75], v[220:223], v[204:207]
    s_add_u32 s59, s58, 4096
    s_waitcnt vmcnt(6)
    s_waitcnt lgkmcnt(3)
    v_mfma_f32_16x16x32_bf16 v[160:163], v[76:79], v[224:227], v[160:163]
    s_cmp_ge_u32 s59, s43
    s_cselect_b32 s38, 49152, 0
    v_mfma_f32_16x16x32_bf16 v[176:179], v[80:83], v[224:227], v[176:179]
    ds_read_b128 v[208:211], v15 offset:8192
    s_sub_u32 s59, s59, s38
    v_mfma_f32_16x16x32_bf16 v[192:195], v[84:87], v[224:227], v[192:195]
    s_add_u32 s60, s59, 4096
    s_waitcnt lgkmcnt(3)
    v_mfma_f32_16x16x32_bf16 v[164:167], v[76:79], v[228:231], v[164:167]
    ds_read_b128 v[212:215], v15 offset:9216
    v_mfma_f32_16x16x32_bf16 v[180:183], v[80:83], v[228:231], v[180:183]
    s_cmp_ge_u32 s60, s43
    s_cselect_b32 s38, 49152, 0
    v_mfma_f32_16x16x32_bf16 v[196:199], v[84:87], v[228:231], v[196:199]
    ds_read_b128 v[216:219], v15 offset:10240
    s_waitcnt lgkmcnt(4)
    v_mfma_f32_16x16x32_bf16 v[168:171], v[76:79], v[232:235], v[168:171]
    s_sub_u32 s60, s60, s38
    v_mfma_f32_16x16x32_bf16 v[184:187], v[80:83], v[232:235], v[184:187]
    ds_read_b128 v[220:223], v15 offset:11264
    v_mfma_f32_16x16x32_bf16 v[200:203], v[84:87], v[232:235], v[200:203]
    s_add_u32 s61, s60, 4096
    s_waitcnt lgkmcnt(4)
    v_mfma_f32_16x16x32_bf16 v[172:175], v[76:79], v[236:239], v[172:175]
    v_mfma_f32_16x16x32_bf16 v[188:191], v[80:83], v[236:239], v[188:191]
    s_cmp_ge_u32 s61, s43
    s_cselect_b32 s38, 49152, 0
    v_mfma_f32_16x16x32_bf16 v[204:207], v[84:87], v[236:239], v[204:207]
    s_sub_u32 s61, s61, s38
    s_waitcnt vmcnt(3)
    s_waitcnt lgkmcnt(3)
    v_mfma_f32_16x16x32_bf16 v[160:163], v[88:91], v[208:211], v[160:163]
    s_add_u32 s62, s61, 4096
    v_mfma_f32_16x16x32_bf16 v[176:179], v[92:95], v[208:211], v[176:179]
    ds_read_b128 v[224:227], v15 offset:12288
    s_cmp_ge_u32 s62, s43
    s_cselect_b32 s38, 49152, 0
    v_mfma_f32_16x16x32_bf16 v[192:195], v[96:99], v[208:211], v[192:195]
    s_sub_u32 s62, s62, s38
    s_waitcnt lgkmcnt(3)
    v_mfma_f32_16x16x32_bf16 v[164:167], v[88:91], v[212:215], v[164:167]
    ds_read_b128 v[228:231], v15 offset:13312
    v_mfma_f32_16x16x32_bf16 v[180:183], v[92:95], v[212:215], v[180:183]
    s_add_u32 s63, s62, 4096
    v_mfma_f32_16x16x32_bf16 v[196:199], v[96:99], v[212:215], v[196:199]
    ds_read_b128 v[232:235], v15 offset:14336
    s_waitcnt lgkmcnt(4)
    v_mfma_f32_16x16x32_bf16 v[168:171], v[88:91], v[216:219], v[168:171]
    s_cmp_ge_u32 s63, s43
    s_cselect_b32 s38, 49152, 0
    v_mfma_f32_16x16x32_bf16 v[184:187], v[92:95], v[216:219], v[184:187]
    ds_read_b128 v[236:239], v15 offset:15360
    v_mfma_f32_16x16x32_bf16 v[200:203], v[96:99], v[216:219], v[200:203]
    s_sub_u32 s63, s63, s38
    s_waitcnt lgkmcnt(4)
    v_mfma_f32_16x16x32_bf16 v[172:175], v[88:91], v[220:223], v[172:175]
    v_mfma_f32_16x16x32_bf16 v[188:191], v[92:95], v[220:223], v[188:191]
    s_add_u32 s48, s18, 1
    v_mfma_f32_16x16x32_bf16 v[204:207], v[96:99], v[220:223], v[204:207]
    s_and_b32 s48, s48, 3
    s_waitcnt vmcnt(0)
    s_waitcnt lgkmcnt(3)
    v_mfma_f32_16x16x32_bf16 v[160:163], v[100:103], v[224:227], v[160:163]
    s_lshl_b32 s48, s48, 10
    v_mfma_f32_16x16x32_bf16 v[176:179], v[104:107], v[224:227], v[176:179]
    s_add_u32 s49, s18, 2
    v_mfma_f32_16x16x32_bf16 v[192:195], v[108:111], v[224:227], v[192:195]
    s_and_b32 s49, s49, 3
    s_waitcnt lgkmcnt(2)
    v_mfma_f32_16x16x32_bf16 v[164:167], v[100:103], v[228:231], v[164:167]
    v_mfma_f32_16x16x32_bf16 v[180:183], v[104:107], v[228:231], v[180:183]
    s_lshl_b32 s49, s49, 10
    v_mfma_f32_16x16x32_bf16 v[196:199], v[108:111], v[228:231], v[196:199]
    s_waitcnt lgkmcnt(1)
    v_mfma_f32_16x16x32_bf16 v[168:171], v[100:103], v[232:235], v[168:171]
    s_add_u32 s50, s18, 3
    v_mfma_f32_16x16x32_bf16 v[184:187], v[104:107], v[232:235], v[184:187]
    v_mfma_f32_16x16x32_bf16 v[200:203], v[108:111], v[232:235], v[200:203]
    s_and_b32 s50, s50, 3
    s_waitcnt lgkmcnt(0)
    v_mfma_f32_16x16x32_bf16 v[172:175], v[100:103], v[236:239], v[172:175]
    v_mfma_f32_16x16x32_bf16 v[188:191], v[104:107], v[236:239], v[188:191]
    s_lshl_b32 s50, s50, 10
    v_mfma_f32_16x16x32_bf16 v[204:207], v[108:111], v[236:239], v[204:207]
    s_add_u32 s51, s18, 4
    s_and_b32 s51, s51, 3
    s_lshl_b32 s51, s51, 10
    s_nop 5
    v_accvgpr_read_b32 v128, a240
    v_accvgpr_read_b32 v129, a241
    v_accvgpr_read_b32 v130, a242
    v_accvgpr_read_b32 v131, a243
    v_accvgpr_read_b32 v132, a244
    v_accvgpr_read_b32 v133, a245
    v_accvgpr_read_b32 v134, a246
    v_accvgpr_read_b32 v135, a247
    v_accvgpr_read_b32 v136, a248
    v_accvgpr_read_b32 v137, a249
    v_accvgpr_read_b32 v138, a250
    v_accvgpr_read_b32 v139, a251
    s_waitcnt lgkmcnt(0)
    v_pk_fma_f32 v[160:161], v[128:129], v[248:249], v[160:161] op_sel_hi:[1,0,1]
    v_pk_fma_f32 v[162:163], v[130:131], v[248:249], v[162:163] op_sel_hi:[1,0,1]
    v_pk_fma_f32 v[176:177], v[132:133], v[248:249], v[176:177] op_sel_hi:[1,0,1]
    v_pk_fma_f32 v[178:179], v[134:135], v[248:249], v[178:179] op_sel_hi:[1,0,1]
    v_pk_fma_f32 v[192:193], v[136:137], v[248:249], v[192:193] op_sel_hi:[1,0,1]
    v_pk_fma_f32 v[194:195], v[138:139], v[248:249], v[194:195] op_sel_hi:[1,0,1]
    v_cvt_pk_bf16_f32 v16, v160, v161
    v_cvt_pk_bf16_f32 v17, v162, v163
    v_cvt_pk_bf16_f32 v18, v176, v177
    v_cvt_pk_bf16_f32 v19, v178, v179
    v_cvt_pk_bf16_f32 v32, v192, v193
    v_cvt_pk_bf16_f32 v33, v194, v195
    v_pk_max_i16 v16, v16, 0
    v_pk_max_i16 v17, v17, 0
    v_pk_max_i16 v18, v18, 0
    v_pk_max_i16 v19, v19, 0
    v_pk_max_i16 v32, v32, 0
    v_pk_max_i16 v33, v33, 0
    buffer_store_dwordx4 v[16:19], v1, s[8:11], s41 offen offset:0
    v_pk_fma_f32 v[164:165], v[128:129], v[250:251], v[164:165] op_sel_hi:[1,0,1]
    v_pk_fma_f32 v[166:167], v[130:131], v[250:251], v[166:167] op_sel_hi:[1,0,1]
    v_pk_fma_f32 v[180:181], v[132:133], v[250:251], v[180:181] op_sel_hi:[1,0,1]
    v_pk_fma_f32 v[182:183], v[134:135], v[250:251], v[182:183] op_sel_hi:[1,0,1]
    v_pk_fma_f32 v[196:197], v[136:137], v[250:251], v[196:197] op_sel_hi:[1,0,1]
    v_pk_fma_f32 v[198:199], v[138:139], v[250:251], v[198:199] op_sel_hi:[1,0,1]
    v_cvt_pk_bf16_f32 v20, v164, v165
    v_cvt_pk_bf16_f32 v21, v166, v167
    v_cvt_pk_bf16_f32 v22, v180, v181
    v_cvt_pk_bf16_f32 v23, v182, v183
    v_cvt_pk_bf16_f32 v34, v196, v197
    v_cvt_pk_bf16_f32 v35, v198, v199
    v_pk_max_i16 v20, v20, 0
    v_pk_max_i16 v21, v21, 0
    v_pk_max_i16 v22, v22, 0
    v_pk_max_i16 v23, v23, 0
    v_pk_max_i16 v34, v34, 0
    v_pk_max_i16 v35, v35, 0
    buffer_store_dwordx4 v[20:23], v1, s[8:11], s41 offen offset:1024
    s_nop 0
    v_permlane32_swap_b32 v32, v34
    v_permlane32_swap_b32 v33, v35
    buffer_store_dwordx4 v[32:35], v6, s[8:11], s42 offen offset:0
    v_pk_fma_f32 v[168:169], v[128:129], v[252:253], v[168:169] op_sel_hi:[1,0,1]
    v_pk_fma_f32 v[170:171], v[130:131], v[252:253], v[170:171] op_sel_hi:[1,0,1]
    v_pk_fma_f32 v[184:185], v[132:133], v[252:253], v[184:185] op_sel_hi:[1,0,1]
    v_pk_fma_f32 v[186:187], v[134:135], v[252:253], v[186:187] op_sel_hi:[1,0,1]
    v_pk_fma_f32 v[200:201], v[136:137], v[252:253], v[200:201] op_sel_hi:[1,0,1]
    v_pk_fma_f32 v[202:203], v[138:139], v[252:253], v[202:203] op_sel_hi:[1,0,1]
    v_cvt_pk_bf16_f32 v24, v168, v169
    v_cvt_pk_bf16_f32 v25, v170, v171
    v_cvt_pk_bf16_f32 v26, v184, v185
    v_cvt_pk_bf16_f32 v27, v186, v187
    v_cvt_pk_bf16_f32 v36, v200, v201
    v_cvt_pk_bf16_f32 v37, v202, v203
    v_pk_max_i16 v24, v24, 0
    v_pk_max_i16 v25, v25, 0
    v_pk_max_i16 v26, v26, 0
    v_pk_max_i16 v27, v27, 0
    v_pk_max_i16 v36, v36, 0
    v_pk_max_i16 v37, v37, 0
    buffer_store_dwordx4 v[24:27], v1, s[8:11], s41 offen offset:2048
    v_pk_fma_f32 v[172:173], v[128:129], v[254:255], v[172:173] op_sel_hi:[1,0,1]
    v_pk_fma_f32 v[174:175], v[130:131], v[254:255], v[174:175] op_sel_hi:[1,0,1]
    v_pk_fma_f32 v[188:189], v[132:133], v[254:255], v[188:189] op_sel_hi:[1,0,1]
    v_pk_fma_f32 v[190:191], v[134:135], v[254:255], v[190:191] op_sel_hi:[1,0,1]
    v_pk_fma_f32 v[204:205], v[136:137], v[254:255], v[204:205] op_sel_hi:[1,0,1]
    v_pk_fma_f32 v[206:207], v[138:139], v[254:255], v[206:207] op_sel_hi:[1,0,1]
    v_cvt_pk_bf16_f32 v28, v172, v173
    v_cvt_pk_bf16_f32 v29, v174, v175
    v_cvt_pk_bf16_f32 v30, v188, v189
    v_cvt_pk_bf16_f32 v31, v190, v191
    v_cvt_pk_bf16_f32 v38, v204, v205
    v_cvt_pk_bf16_f32 v39, v206, v207
    v_pk_max_i16 v28, v28, 0
    v_pk_max_i16 v29, v29, 0
    v_pk_max_i16 v30, v30, 0
    v_pk_max_i16 v31, v31, 0
    v_pk_max_i16 v38, v38, 0
    v_pk_max_i16 v39, v39, 0
    buffer_store_dwordx4 v[28:31], v1, s[8:11], s41 offen offset:3072
    s_nop 0
    v_permlane32_swap_b32 v36, v38
    v_permlane32_swap_b32 v37, v39
    buffer_store_dwordx4 v[36:39], v6, s[8:11], s42 offen offset:2048
    v_add_u32 v248, s48, v1
    v_add_u32 v249, s49, v1
    v_add_u32 v250, s50, v1
    v_add_u32 v251, s51, v1
    s_cmp_lg_u32 s27, 0
    s_cbranch_scc1 k2_hs112
k2_hs112b:
    buffer_load_dwordx4 v[16:19], v248, s[8:11], s52 offen sc1
    buffer_load_dwordx4 v[20:23], v248, s[8:11], s53 offen sc1
    buffer_load_dwordx4 v[24:27], v248, s[8:11], s54 offen sc1
    buffer_load_dwordx4 v[28:31], v248, s[8:11], s55 offen sc1
    buffer_load_dwordx4 v[32:35], v248, s[8:11], s56 offen sc1
    buffer_load_dwordx4 v[36:39], v248, s[8:11], s57 offen sc1
    buffer_load_dwordx4 v[40:43], v248, s[8:11], s58 offen sc1
    buffer_load_dwordx4 v[44:47], v248, s[8:11], s59 offen sc1
    buffer_load_dwordx4 v[48:51], v248, s[8:11], s60 offen sc1
    buffer_load_dwordx4 v[52:55], v248, s[8:11], s61 offen sc1
    v_lshrrev_b32 v14, 4, v0
    v_and_b32 v15, 15, v0
    s_mul_i32 s23, s17, 5
    v_add_u32 v8, s23, v14
    v_lshrrev_b32 v9, 2, v8
    v_lshlrev_b32 v9, 12, v9
    v_and_b32 v10, 3, v8
    v_lshl_add_u32 v9, v10, 8, v9
    v_lshlrev_b32 v10, 9, v8
    s_lshl_b32 s38, s18, 10
    v_lshl_add_u32 v11, v15, 4, s38
    v_add_u32 v8, v9, v11
    s_add_u32 s23, s23, 4
    s_lshr_b32 s35, s23, 2
    s_lshl_b32 s35, s35, 12
    s_and_b32 s36, s23, 3
    s_lshl_b32 s36, s36, 8
    s_add_u32 s35, s35, s36
    v_lshl_add_u32 v9, v14, 2, v11
    v_add_u32 v9, s35, v9
    s_lshr_b32 s35, s18, 1
    s_mul_i32 s35, s35, 40960
    s_and_b32 s36, s18, 1
    s_lshl_b32 s36, s36, 8
    s_add_u32 s35, s35, s36
    v_lshl_add_u32 v11, v15, 4, s35
    v_add_u32 v10, v10, v11
    s_lshl_b32 s23, s23, 9
    v_lshl_add_u32 v11, v14, 2, v11
    v_add_u32 v11, s23, v11
    s_sub_u32 s23, 64, s16
    s_cmp_eq_u32 s16, 0
    s_cselect_b32 s23, 32, s23
    s_cmp_lt_u32 s18, 2
    s_cselect_b32 s23, s16, s23
    s_and_b32 s38, s18, 1
    s_lshl_b32 s38, s38, 10
    s_add_u32 s23, s23, s38
    v_and_b32 v14, 15, v0
    v_lshl_add_u32 v14, v14, 6, s23
    v_mul_u32_u24 v14, 1280, v14
    v_lshrrev_b32 v15, 4, v0
    s_mul_i32 s23, s17, 80
    s_add_u32 s38, s23, 2
    v_lshl_add_u32 v2, v15, 4, s38
    v_add_u32 v2, v2, v14
    s_sub_u32 s38, 1264, s23
    v_lshlrev_b32 v3, 4, v15
    v_sub_u32 v3, s38, v3
    v_add_u32 v3, v3, v14
    s_add_u32 s38, s23, 66
    v_lshl_add_u32 v4, v15, 2, s38
    v_add_u32 v4, v4, v14
    s_sub_u32 s38, 1214, s23
    v_lshlrev_b32 v5, 2, v15
    v_sub_u32 v5, s38, v5
    v_add_u32 v6, -2, v5
    v_cmp_eq_u32 vcc, 640, v6
    v_add_u32 v5, v5, v14
    s_nop 0
    v_cndmask_b32 v6, v6, 0, vcc
    v_add_u32 v6, v6, v14
    s_waitcnt vmcnt(9)
    v_cmp_gt_i32 vcc, 0, v19
    s_cbranch_vccnz k2_hr123
k2_hr123b:
    v_mfma_f32_16x16x32_bf16 v[208:211], a[0:3], v[16:19], 0
    v_mfma_f32_16x16x32_bf16 v[212:215], a[4:7], v[16:19], 0
    buffer_load_dwordx4 v[56:59], v248, s[8:11], s62 offen sc1
    v_mfma_f32_16x16x32_bf16 v[216:219], a[8:11], v[16:19], 0
    s_waitcnt vmcnt(9)
    v_cmp_gt_i32 vcc, 0, v23
    v_mfma_f32_16x16x32_bf16 v[220:223], a[12:15], v[16:19], 0
    v_mfma_f32_16x16x32_bf16 v[224:227], a[16:19], v[16:19], 0
    s_cbranch_vccnz k2_hr124
k2_hr124b:
    v_mfma_f32_16x16x32_bf16 v[208:211], a[20:23], v[20:23], v[208:211]
    v_mfma_f32_16x16x32_bf16 v[212:215], a[24:27], v[20:23], v[212:215]
    buffer_load_dwordx4 v[60:63], v248, s[8:11], s63 offen sc1
    v_mfma_f32_16x16x32_bf16 v[216:219], a[28:31], v[20:23], v[216:219]
    s_waitcnt vmcnt(9)
    v_cmp_gt_i32 vcc, 0, v27
    v_mfma_f32_16x16x32_bf16 v[220:223], a[32:35], v[20:23], v[220:223]
    v_mfma_f32_16x16x32_bf16 v[224:227], a[36:39], v[20:23], v[224:227]
    s_cbranch_vccnz k2_hr125
k2_hr125b:
    v_mfma_f32_16x16x32_bf16 v[208:211], a[40:43], v[24:27], v[208:211]
    v_mfma_f32_16x16x32_bf16 v[212:215], a[44:47], v[24:27], v[212:215]
    buffer_load_dwordx4 v[64:67], v249, s[8:11], s52 offen sc1
    v_mfma_f32_16x16x32_bf16 v[216:219], a[48:51], v[24:27], v[216:219]
    s_waitcnt vmcnt(9)
    v_cmp_gt_i32 vcc, 0, v31
    v_mfma_f32_16x16x32_bf16 v[220:223], a[52:55], v[24:27], v[220:223]
    v_mfma_f32_16x16x32_bf16 v[224:227], a[56:59], v[24:27], v[224:227]
    s_cbranch_vccnz k2_hr126
k2_hr126b:
    v_mfma_f32_16x16x32_bf16 v[208:211], a[60:63], v[28:31], v[208:211]
    v_mfma_f32_16x16x32_bf16 v[212:215], a[64:67], v[28:31], v[212:215]
    buffer_load_dwordx4 v[68:71], v249, s[8:11], s53 offen sc1
    v_mfma_f32_16x16x32_bf16 v[216:219], a[68:71], v[28:31], v[216:219]
    s_waitcnt vmcnt(9)
    v_cmp_gt_i32 vcc, 0, v35
    v_mfma_f32_16x16x32_bf16 v[220:223], a[72:75], v[28:31], v[220:223]
    v_mfma_f32_16x16x32_bf16 v[224:227], a[76:79], v[28:31], v[224:227]
    s_cbranch_vccnz k2_hr127
k2_hr127b:
    v_mfma_f32_16x16x32_bf16 v[208:211], a[80:83], v[32:35], v[208:211]
    v_mfma_f32_16x16x32_bf16 v[212:215], a[84:87], v[32:35], v[212:215]
    buffer_load_dwordx4 v[72:75], v249, s[8:11], s54 offen sc1
    v_mfma_f32_16x16x32_bf16 v[216:219], a[88:91], v[32:35], v[216:219]
    s_waitcnt vmcnt(9)
    v_cmp_gt_i32 vcc, 0, v39
    v_mfma_f32_16x16x32_bf16 v[220:223], a[92:95], v[32:35], v[220:223]
    v_mfma_f32_16x16x32_bf16 v[224:227], a[96:99], v[32:35], v[224:227]
    s_cbranch_vccnz k2_hr128
k2_hr128b:
    v_mfma_f32_16x16x32_bf16 v[208:211], a[100:103], v[36:39], v[208:211]
    v_mfma_f32_16x16x32_bf16 v[212:215], a[104:107], v[36:39], v[212:215]
    buffer_load_dwordx4 v[76:79], v249, s[8:11], s55 offen sc1
    v_mfma_f32_16x16x32_bf16 v[216:219], a[108:111], v[36:39], v[216:219]
    s_waitcnt vmcnt(9)
    v_cmp_gt_i32 vcc, 0, v43
    v_mfma_f32_16x16x32_bf16 v[220:223], a[112:115], v[36:39], v[220:223]
    v_mfma_f32_16x16x32_bf16 v[224:227], a[116:119], v[36:39], v[224:227]
    s_cbranch_vccnz k2_hr129
k2_hr129b:
    v_mfma_f32_16x16x32_bf16 v[208:211], a[120:123], v[40:43], v[208:211]
    v_mfma_f32_16x16x32_bf16 v[212:215], a[124:127], v[40:43], v[212:215]
    buffer_load_dwordx4 v[80:83], v249, s[8:11], s56 offen sc1
    v_mfma_f32_16x16x32_bf16 v[216:219], a[128:131], v[40:43], v[216:219]
    s_waitcnt vmcnt(9)
    v_cmp_gt_i32 vcc, 0, v47
    v_mfma_f32_16x16x32_bf16 v[220:223], a[132:135], v[40:43], v[220:223]
    v_mfma_f32_16x16x32_bf16 v[224:227], a[136:139], v[40:43], v[224:227]
    s_cbranch_vccnz k2_hr130
k2_hr130b:
    v_mfma_f32_16x16x32_bf16 v[208:211], a[140:143], v[44:47], v[208:211]
    v_mfma_f32_16x16x32_bf16 v[212:215], a[144:147], v[44:47], v[212:215]
    buffer_load_dwordx4 v[84:87], v249, s[8:11], s57 offen sc1
    v_mfma_f32_16x16x32_bf16 v[216:219], a[148:151], v[44:47], v[216:219]
    s_waitcnt vmcnt(9)
    v_cmp_gt_i32 vcc, 0, v51
    v_mfma_f32_16x16x32_bf16 v[220:223], a[152:155], v[44:47], v[220:223]
    v_mfma_f32_16x16x32_bf16 v[224:227], a[156:159], v[44:47], v[224:227]
    s_cbranch_vccnz k2_hr131
k2_hr131b:
    v_mfma_f32_16x16x32_bf16 v[208:211], a[160:163], v[48:51], v[208:211]
    v_mfma_f32_16x16x32_bf16 v[212:215], a[164:167], v[48:51], v[212:215]
    buffer_load_dwordx4 v[88:91], v249, s[8:11], s58 offen sc1
    v_mfma_f32_16x16x32_bf16 v[216:219], a[168:171], v[48:51], v[216:219]
    s_waitcnt vmcnt(9)
    v_cmp_gt_i32 vcc, 0, v55
    v_mfma_f32_16x16x32_bf16 v[220:223], a[172:175], v[48:51], v[220:223]
    v_mfma_f32_16x16x32_bf16 v[224:227], a[176:179], v[48:51], v[224:227]
    s_cbranch_vccnz k2_hr132
k2_hr132b:
    v_mfma_f32_16x16x32_bf16 v[208:211], a[180:183], v[52:55], v[208:211]
    v_mfma_f32_16x16x32_bf16 v[212:215], a[184:187], v[52:55], v[212:215]
    buffer_load_dwordx4 v[92:95], v249, s[8:11], s59 offen sc1
    v_mfma_f32_16x16x32_bf16 v[216:219], a[188:191], v[52:55], v[216:219]
    s_waitcnt vmcnt(9)
    v_cmp_gt_i32 vcc, 0, v59
    v_mfma_f32_16x16x32_bf16 v[220:223], a[192:195], v[52:55], v[220:223]
    v_mfma_f32_16x16x32_bf16 v[224:227], a[196:199], v[52:55], v[224:227]
    s_cbranch_vccnz k2_hr133
k2_hr133b:
    v_mfma_f32_16x16x32_bf16 v[208:211], a[200:203], v[56:59], v[208:211]
    v_mfma_f32_16x16x32_bf16 v[212:215], a[204:207], v[56:59], v[212:215]
    buffer_load_dwordx4 v[96:99], v249, s[8:11], s60 offen sc1
    v_mfma_f32_16x16x32_bf16 v[216:219], a[208:211], v[56:59], v[216:219]
    s_waitcnt vmcnt(9)
    v_cmp_gt_i32 vcc, 0, v63
    v_mfma_f32_16x16x32_bf16 v[220:223], a[212:215], v[56:59], v[220:223]
    v_mfma_f32_16x16x32_bf16 v[224:227], a[216:219], v[56:59], v[224:227]
    s_cbranch_vccnz k2_hr134
k2_hr134b:
    v_mfma_f32_16x16x32_bf16 v[208:211], a[220:223], v[60:63], v[208:211]
    v_mfma_f32_16x16x32_bf16 v[212:215], a[224:227], v[60:63], v[212:215]
    buffer_load_dwordx4 v[100:103], v249, s[8:11], s61 offen sc1
    v_mfma_f32_16x16x32_bf16 v[216:219], a[228:231], v[60:63], v[216:219]
    s_waitcnt vmcnt(9)
    v_cmp_gt_i32 vcc, 0, v67
    v_mfma_f32_16x16x32_bf16 v[220:223], a[232:235], v[60:63], v[220:223]
    v_mfma_f32_16x16x32_bf16 v[224:227], a[236:239], v[60:63], v[224:227]
    s_cbranch_vccnz k2_hr135
k2_hr135b:
    v_mfma_f32_16x16x32_bf16 v[228:231], a[0:3], v[64:67], 0
    v_mfma_f32_16x16x32_bf16 v[232:235], a[4:7], v[64:67], 0
    buffer_load_dwordx4 v[104:107], v249, s[8:11], s62 offen sc1
    v_mfma_f32_16x16x32_bf16 v[236:239], a[8:11], v[64:67], 0
    s_waitcnt vmcnt(9)
    v_cmp_gt_i32 vcc, 0, v71
    v_mfma_f32_16x16x32_bf16 v[240:243], a[12:15], v[64:67], 0
    v_mfma_f32_16x16x32_bf16 v[244:247], a[16:19], v[64:67], 0
    s_cbranch_vccnz k2_hr136
k2_hr136b:
    v_mfma_f32_16x16x32_bf16 v[228:231], a[20:23], v[68:71], v[228:231]
    v_mfma_f32_16x16x32_bf16 v[232:235], a[24:27], v[68:71], v[232:235]
    buffer_load_dwordx4 v[108:111], v249, s[8:11], s63 offen sc1
    v_mfma_f32_16x16x32_bf16 v[236:239], a[28:31], v[68:71], v[236:239]
    s_waitcnt vmcnt(9)
    v_cmp_gt_i32 vcc, 0, v75
    v_mfma_f32_16x16x32_bf16 v[240:243], a[32:35], v[68:71], v[240:243]
    s_add_u32 s23, s18, 1
    s_and_b32 s23, s23, 3
    s_mul_i32 s23, s23, 15360
    s_add_u32 s23, s23, 81920
    v_add_u32 v14, s23, v1
    v_mfma_f32_16x16x32_bf16 v[244:247], a[36:39], v[68:71], v[244:247]
    s_cbranch_vccnz k2_hr137
k2_hr137b:
    v_mfma_f32_16x16x32_bf16 v[228:231], a[40:43], v[72:75], v[228:231]
    ds_write_b128 v14, v[208:211] offset:0
    v_mfma_f32_16x16x32_bf16 v[232:235], a[44:47], v[72:75], v[232:235]
    buffer_load_dwordx4 v[112:115], v250, s[8:11], s52 offen sc1
    v_mfma_f32_16x16x32_bf16 v[236:239], a[48:51], v[72:75], v[236:239]
    s_waitcnt vmcnt(9)
    v_cmp_gt_i32 vcc, 0, v79
    ds_write_b128 v14, v[212:215] offset:1024
    v_mfma_f32_16x16x32_bf16 v[240:243], a[52:55], v[72:75], v[240:243]
    v_mfma_f32_16x16x32_bf16 v[244:247], a[56:59], v[72:75], v[244:247]
    s_cbranch_vccnz k2_hr138
k2_hr138b:
    ds_write_b128 v14, v[216:219] offset:2048
    v_mfma_f32_16x16x32_bf16 v[228:231], a[60:63], v[76:79], v[228:231]
    v_mfma_f32_16x16x32_bf16 v[232:235], a[64:67], v[76:79], v[232:235]
    buffer_load_dwordx4 v[116:119], v250, s[8:11], s53 offen sc1
    ds_write_b128 v14, v[220:223] offset:3072
    v_mfma_f32_16x16x32_bf16 v[236:239], a[68:71], v[76:79], v[236:239]
    s_waitcnt vmcnt(9)
    v_cmp_gt_i32 vcc, 0, v83
    v_mfma_f32_16x16x32_bf16 v[240:243], a[72:75], v[76:79], v[240:243]
    ds_write_b128 v14, v[224:227] offset:4096
    v_mfma_f32_16x16x32_bf16 v[244:247], a[76:79], v[76:79], v[244:247]
    s_cbranch_vccnz k2_hr139
k2_hr139b:
    v_mfma_f32_16x16x32_bf16 v[228:231], a[80:83], v[80:83], v[228:231]
    v_mfma_f32_16x16x32_bf16 v[232:235], a[84:87], v[80:83], v[232:235]
    buffer_load_dwordx4 v[120:123], v250, s[8:11], s54 offen sc1
    v_mfma_f32_16x16x32_bf16 v[236:239], a[88:91], v[80:83], v[236:239]
    s_waitcnt vmcnt(9)
    v_cmp_gt_i32 vcc, 0, v87
    v_mfma_f32_16x16x32_bf16 v[240:243], a[92:95], v[80:83], v[240:243]
    v_mfma_f32_16x16x32_bf16 v[244:247], a[96:99], v[80:83], v[244:247]
    s_cbranch_vccnz k2_hr140
k2_hr140b:
    s_add_u32 s34, s24, 7077888
    s_add_u32 s35, s34, 40960
    buffer_load_dwordx4 v[16:19], v8, s[8:11], s34 offen sc1
    buffer_load_dwordx4 v[20:23], v8, s[8:11], s35 offen sc1
    buffer_load_dword v24, v9, s[8:11], s34 offen sc1
    buffer_load_dword v25, v9, s[8:11], s35 offen sc1
    v_mfma_f32_16x16x32_bf16 v[228:231], a[100:103], v[84:87], v[228:231]
    v_mfma_f32_16x16x32_bf16 v[232:235], a[104:107], v[84:87], v[232:235]
    buffer_load_dwordx4 v[124:127], v250, s[8:11], s55 offen sc1
    v_mfma_f32_16x16x32_bf16 v[236:239], a[108:111], v[84:87], v[236:239]
    s_waitcnt vmcnt(13)
    v_cmp_gt_i32 vcc, 0, v91
    v_mfma_f32_16x16x32_bf16 v[240:243], a[112:115], v[84:87], v[240:243]
    v_mfma_f32_16x16x32_bf16 v[244:247], a[116:119], v[84:87], v[244:247]
    s_cbranch_vccnz k2_hr141
k2_hr141b:
    v_mfma_f32_16x16x32_bf16 v[228:231], a[120:123], v[88:91], v[228:231]
    v_mfma_f32_16x16x32_bf16 v[232:235], a[124:127], v[88:91], v[232:235]
    buffer_load_dwordx4 v[128:131], v250, s[8:11], s56 offen sc1
    v_mfma_f32_16x16x32_bf16 v[236:239], a[128:131], v[88:91], v[236:239]
    s_waitcnt vmcnt(13)
    v_cmp_gt_i32 vcc, 0, v95
    v_mfma_f32_16x16x32_bf16 v[240:243], a[132:135], v[88:91], v[240:243]
    v_mfma_f32_16x16x32_bf16 v[244:247], a[136:139], v[88:91], v[244:247]
    s_cbranch_vccnz k2_hr142
k2_hr142b:
    v_mfma_f32_16x16x32_bf16 v[228:231], a[140:143], v[92:95], v[228:231]
    v_mfma_f32_16x16x32_bf16 v[232:235], a[144:147], v[92:95], v[232:235]
    buffer_load_dwordx4 v[132:135], v250, s[8:11], s57 offen sc1
    v_mfma_f32_16x16x32_bf16 v[236:239], a[148:151], v[92:95], v[236:239]
    s_waitcnt vmcnt(13)
    v_cmp_gt_i32 vcc, 0, v99
    v_mfma_f32_16x16x32_bf16 v[240:243], a[152:155], v[92:95], v[240:243]
    v_mfma_f32_16x16x32_bf16 v[244:247], a[156:159], v[92:95], v[244:247]
    s_cbranch_vccnz k2_hr143
k2_hr143b:
    v_mfma_f32_16x16x32_bf16 v[228:231], a[160:163], v[96:99], v[228:231]
    v_mfma_f32_16x16x32_bf16 v[232:235], a[164:167], v[96:99], v[232:235]
    buffer_load_dwordx4 v[136:139], v250, s[8:11], s58 offen sc1
    v_mfma_f32_16x16x32_bf16 v[236:239], a[168:171], v[96:99], v[236:239]
    s_waitcnt vmcnt(13)
    v_cmp_gt_i32 vcc, 0, v103
    v_mfma_f32_16x16x32_bf16 v[240:243], a[172:175], v[96:99], v[240:243]
    v_mfma_f32_16x16x32_bf16 v[244:247], a[176:179], v[96:99], v[244:247]
    s_cbranch_vccnz k2_hr144
k2_hr144b:
    v_mfma_f32_16x16x32_bf16 v[228:231], a[180:183], v[100:103], v[228:231]
    v_mfma_f32_16x16x32_bf16 v[232:235], a[184:187], v[100:103], v[232:235]
    buffer_load_dwordx4 v[140:143], v250, s[8:11], s59 offen sc1
    v_mfma_f32_16x16x32_bf16 v[236:239], a[188:191], v[100:103], v[236:239]
    s_waitcnt vmcnt(13)
    v_cmp_gt_i32 vcc, 0, v107
    v_mfma_f32_16x16x32_bf16 v[240:243], a[192:195], v[100:103], v[240:243]
    v_mfma_f32_16x16x32_bf16 v[244:247], a[196:199], v[100:103], v[244:247]
    s_cbranch_vccnz k2_hr145
k2_hr145b:
    v_mfma_f32_16x16x32_bf16 v[228:231], a[200:203], v[104:107], v[228:231]
    v_mfma_f32_16x16x32_bf16 v[232:235], a[204:207], v[104:107], v[232:235]
    buffer_load_dwordx4 v[144:147], v250, s[8:11], s60 offen sc1
    v_mfma_f32_16x16x32_bf16 v[236:239], a[208:211], v[104:107], v[236:239]
    s_waitcnt vmcnt(13)
    v_cmp_gt_i32 vcc, 0, v111
    v_mfma_f32_16x16x32_bf16 v[240:243], a[212:215], v[104:107], v[240:243]
    v_mfma_f32_16x16x32_bf16 v[244:247], a[216:219], v[104:107], v[244:247]
    s_cbranch_vccnz k2_hr146
k2_hr146b:
    v_mfma_f32_16x16x32_bf16 v[228:231], a[220:223], v[108:111], v[228:231]
    v_mfma_f32_16x16x32_bf16 v[232:235], a[224:227], v[108:111], v[232:235]
    buffer_load_dwordx4 v[148:151], v250, s[8:11], s61 offen sc1
    v_mfma_f32_16x16x32_bf16 v[236:239], a[228:231], v[108:111], v[236:239]
    s_waitcnt vmcnt(13)
    v_cmp_gt_i32 vcc, 0, v115
    v_mfma_f32_16x16x32_bf16 v[240:243], a[232:235], v[108:111], v[240:243]
    v_mfma_f32_16x16x32_bf16 v[244:247], a[236:239], v[108:111], v[244:247]
    s_cbranch_vccnz k2_hr147
k2_hr147b:
    v_mfma_f32_16x16x32_bf16 v[208:211], a[0:3], v[112:115], 0
    v_mfma_f32_16x16x32_bf16 v[212:215], a[4:7], v[112:115], 0
    buffer_load_dwordx4 v[152:155], v250, s[8:11], s62 offen sc1
    v_mfma_f32_16x16x32_bf16 v[216:219], a[8:11], v[112:115], 0
    s_waitcnt vmcnt(13)
    v_cmp_gt_i32 vcc, 0, v119
    v_mfma_f32_16x16x32_bf16 v[220:223], a[12:15], v[112:115], 0
    v_mfma_f32_16x16x32_bf16 v[224:227], a[16:19], v[112:115], 0
    s_cbranch_vccnz k2_hr148
k2_hr148b:
    v_mfma_f32_16x16x32_bf16 v[208:211], a[20:23], v[116:119], v[208:211]
    v_mfma_f32_16x16x32_bf16 v[212:215], a[24:27], v[116:119], v[212:215]
    buffer_load_dwordx4 v[156:159], v250, s[8:11], s63 offen sc1
    v_mfma_f32_16x16x32_bf16 v[216:219], a[28:31], v[116:119], v[216:219]
    s_waitcnt vmcnt(13)
    v_cmp_gt_i32 vcc, 0, v123
    v_mfma_f32_16x16x32_bf16 v[220:223], a[32:35], v[116:119], v[220:223]
    s_add_u32 s23, s18, 2
    s_and_b32 s23, s23, 3
    s_mul_i32 s23, s23, 15360
    s_add_u32 s23, s23, 87040
    v_add_u32 v14, s23, v1
    v_mfma_f32_16x16x32_bf16 v[224:227], a[36:39], v[116:119], v[224:227]
    s_cbranch_vccnz k2_hr149
k2_hr149b:
    v_mfma_f32_16x16x32_bf16 v[208:211], a[40:43], v[120:123], v[208:211]
    ds_write_b128 v14, v[228:231] offset:0
    v_mfma_f32_16x16x32_bf16 v[212:215], a[44:47], v[120:123], v[212:215]
    buffer_load_dwordx4 v[160:163], v251, s[8:11], s52 offen sc1
    v_mfma_f32_16x16x32_bf16 v[216:219], a[48:51], v[120:123], v[216:219]
    s_waitcnt vmcnt(9)
    v_cmp_gt_i32 vcc, 0, v127
    ds_write_b128 v14, v[232:235] offset:1024
    v_mfma_f32_16x16x32_bf16 v[220:223], a[52:55], v[120:123], v[220:223]
    v_mfma_f32_16x16x32_bf16 v[224:227], a[56:59], v[120:123], v[224:227]
    s_cbranch_vccnz k2_hr150
k2_hr150b:
    ds_write_b128 v14, v[236:239] offset:2048
    v_mfma_f32_16x16x32_bf16 v[208:211], a[60:63], v[124:127], v[208:211]
    v_mfma_f32_16x16x32_bf16 v[212:215], a[64:67], v[124:127], v[212:215]
    buffer_load_dwordx4 v[164:167], v251, s[8:11], s53 offen sc1
    ds_write_b128 v14, v[240:243] offset:3072
    v_mfma_f32_16x16x32_bf16 v[216:219], a[68:71], v[124:127], v[216:219]
    s_waitcnt vmcnt(9)
    v_cmp_gt_i32 vcc, 0, v131
    v_mfma_f32_16x16x32_bf16 v[220:223], a[72:75], v[124:127], v[220:223]
    ds_write_b128 v14, v[244:247] offset:4096
    v_mfma_f32_16x16x32_bf16 v[224:227], a[76:79], v[124:127], v[224:227]
    s_cbranch_vccnz k2_hr151
k2_hr151b:
    v_mfma_f32_16x16x32_bf16 v[208:211], a[80:83], v[128:131], v[208:211]
    v_mfma_f32_16x16x32_bf16 v[212:215], a[84:87], v[128:131], v[212:215]
    buffer_load_dwordx4 v[168:171], v251, s[8:11], s54 offen sc1
    v_mfma_f32_16x16x32_bf16 v[216:219], a[88:91], v[128:131], v[216:219]
    s_waitcnt vmcnt(9)
    v_cmp_gt_i32 vcc, 0, v135
    v_mfma_f32_16x16x32_bf16 v[220:223], a[92:95], v[128:131], v[220:223]
    v_mfma_f32_16x16x32_bf16 v[224:227], a[96:99], v[128:131], v[224:227]
    s_cbranch_vccnz k2_hr152
k2_hr152b:
    v_mfma_f32_16x16x32_bf16 v[208:211], a[100:103], v[132:135], v[208:211]
    v_mfma_f32_16x16x32_bf16 v[212:215], a[104:107], v[132:135], v[212:215]
    buffer_load_dwordx4 v[172:175], v251, s[8:11], s55 offen sc1
    v_mfma_f32_16x16x32_bf16 v[216:219], a[108:111], v[132:135], v[216:219]
    s_waitcnt vmcnt(9)
    v_cmp_gt_i32 vcc, 0, v139
    v_mfma_f32_16x16x32_bf16 v[220:223], a[112:115], v[132:135], v[220:223]
    v_mfma_f32_16x16x32_bf16 v[224:227], a[116:119], v[132:135], v[224:227]
    s_cbranch_vccnz k2_hr153
k2_hr153b:
    v_mfma_f32_16x16x32_bf16 v[208:211], a[120:123], v[136:139], v[208:211]
    v_mfma_f32_16x16x32_bf16 v[212:215], a[124:127], v[136:139], v[212:215]
    buffer_load_dwordx4 v[176:179], v251, s[8:11], s56 offen sc1
    v_mfma_f32_16x16x32_bf16 v[216:219], a[128:131], v[136:139], v[216:219]
    s_waitcnt vmcnt(9)
    v_cmp_gt_i32 vcc, 0, v143
    v_mfma_f32_16x16x32_bf16 v[220:223], a[132:135], v[136:139], v[220:223]
    v_mfma_f32_16x16x32_bf16 v[224:227], a[136:139], v[136:139], v[224:227]
    s_cbranch_vccnz k2_hr154
k2_hr154b:
    v_mfma_f32_16x16x32_bf16 v[208:211], a[140:143], v[140:143], v[208:211]
    v_mfma_f32_16x16x32_bf16 v[212:215], a[144:147], v[140:143], v[212:215]
    buffer_load_dwordx4 v[180:183], v251, s[8:11], s57 offen sc1
    v_mfma_f32_16x16x32_bf16 v[216:219], a[148:151], v[140:143], v[216:219]
    s_waitcnt vmcnt(9)
    v_cmp_gt_i32 vcc, 0, v147
    v_mfma_f32_16x16x32_bf16 v[220:223], a[152:155], v[140:143], v[220:223]
    v_mfma_f32_16x16x32_bf16 v[224:227], a[156:159], v[140:143], v[224:227]
    s_cbranch_vccnz k2_hr155
k2_hr155b:
    v_mfma_f32_16x16x32_bf16 v[208:211], a[160:163], v[144:147], v[208:211]
    v_mfma_f32_16x16x32_bf16 v[212:215], a[164:167], v[144:147], v[212:215]
    buffer_load_dwordx4 v[184:187], v251, s[8:11], s58 offen sc1
    v_mfma_f32_16x16x32_bf16 v[216:219], a[168:171], v[144:147], v[216:219]
    s_waitcnt vmcnt(9)
    v_cmp_gt_i32 vcc, 0, v151
    v_mfma_f32_16x16x32_bf16 v[220:223], a[172:175], v[144:147], v[220:223]
    v_mfma_f32_16x16x32_bf16 v[224:227], a[176:179], v[144:147], v[224:227]
    s_cbranch_vccnz k2_hr156
k2_hr156b:
    v_mfma_f32_16x16x32_bf16 v[208:211], a[180:183], v[148:151], v[208:211]
    v_mfma_f32_16x16x32_bf16 v[212:215], a[184:187], v[148:151], v[212:215]
    buffer_load_dwordx4 v[188:191], v251, s[8:11], s59 offen sc1
    v_mfma_f32_16x16x32_bf16 v[216:219], a[188:191], v[148:151], v[216:219]
    s_waitcnt vmcnt(9)
    v_cmp_gt_i32 vcc, 0, v155
    v_mfma_f32_16x16x32_bf16 v[220:223], a[192:195], v[148:151], v[220:223]
    v_mfma_f32_16x16x32_bf16 v[224:227], a[196:199], v[148:151], v[224:227]
    s_cbranch_vccnz k2_hr157
k2_hr157b:
    v_mfma_f32_16x16x32_bf16 v[208:211], a[200:203], v[152:155], v[208:211]
    v_mfma_f32_16x16x32_bf16 v[212:215], a[204:207], v[152:155], v[212:215]
    buffer_load_dwordx4 v[192:195], v251, s[8:11], s60 offen sc1
    v_mfma_f32_16x16x32_bf16 v[216:219], a[208:211], v[152:155], v[216:219]
    s_waitcnt vmcnt(9)
    v_cmp_gt_i32 vcc, 0, v159
    v_mfma_f32_16x16x32_bf16 v[220:223], a[212:215], v[152:155], v[220:223]
    v_mfma_f32_16x16x32_bf16 v[224:227], a[216:219], v[152:155], v[224:227]
    s_cbranch_vccnz k2_hr158
k2_hr158b:
    v_mfma_f32_16x16x32_bf16 v[208:211], a[220:223], v[156:159], v[208:211]
    v_mfma_f32_16x16x32_bf16 v[212:215], a[224:227], v[156:159], v[212:215]
    buffer_load_dwordx4 v[196:199], v251, s[8:11], s61 offen sc1
    v_mfma_f32_16x16x32_bf16 v[216:219], a[228:231], v[156:159], v[216:219]
    s_waitcnt vmcnt(9)
    v_cmp_gt_i32 vcc, 0, v163
    v_mfma_f32_16x16x32_bf16 v[220:223], a[232:235], v[156:159], v[220:223]
    v_mfma_f32_16x16x32_bf16 v[224:227], a[236:239], v[156:159], v[224:227]
    s_cbranch_vccnz k2_hr159
k2_hr159b:
    v_mfma_f32_16x16x32_bf16 v[228:231], a[0:3], v[160:163], 0
    v_mfma_f32_16x16x32_bf16 v[232:235], a[4:7], v[160:163], 0
    buffer_load_dwordx4 v[200:203], v251, s[8:11], s62 offen sc1
    v_mfma_f32_16x16x32_bf16 v[236:239], a[8:11], v[160:163], 0
    s_waitcnt vmcnt(9)
    v_cmp_gt_i32 vcc, 0, v167
    v_mfma_f32_16x16x32_bf16 v[240:243], a[12:15], v[160:163], 0
    v_mfma_f32_16x16x32_bf16 v[244:247], a[16:19], v[160:163], 0
    s_cbranch_vccnz k2_hr160
k2_hr160b:
    v_mfma_f32_16x16x32_bf16 v[228:231], a[20:23], v[164:167], v[228:231]
    v_mfma_f32_16x16x32_bf16 v[232:235], a[24:27], v[164:167], v[232:235]
    buffer_load_dwordx4 v[204:207], v251, s[8:11], s63 offen sc1
    v_mfma_f32_16x16x32_bf16 v[236:239], a[28:31], v[164:167], v[236:239]
    s_waitcnt vmcnt(9)
    v_cmp_gt_i32 vcc, 0, v171
    v_mfma_f32_16x16x32_bf16 v[240:243], a[32:35], v[164:167], v[240:243]
    s_add_u32 s23, s18, 3
    s_and_b32 s23, s23, 3
    s_mul_i32 s23, s23, 15360
    s_add_u32 s23, s23, 92160
    v_add_u32 v14, s23, v1
    v_mfma_f32_16x16x32_bf16 v[244:247], a[36:39], v[164:167], v[244:247]
    s_cbranch_vccnz k2_hr161
k2_hr161b:
    v_mfma_f32_16x16x32_bf16 v[228:231], a[40:43], v[168:171], v[228:231]
    ds_write_b128 v14, v[208:211] offset:0
    v_mfma_f32_16x16x32_bf16 v[232:235], a[44:47], v[168:171], v[232:235]
    v_mfma_f32_16x16x32_bf16 v[236:239], a[48:51], v[168:171], v[236:239]
    s_waitcnt vmcnt(8)
    v_cmp_gt_i32 vcc, 0, v175
    ds_write_b128 v14, v[212:215] offset:1024
    v_mfma_f32_16x16x32_bf16 v[240:243], a[52:55], v[168:171], v[240:243]
    v_mfma_f32_16x16x32_bf16 v[244:247], a[56:59], v[168:171], v[244:247]
    s_cbranch_vccnz k2_hr162
k2_hr162b:
    ds_write_b128 v14, v[216:219] offset:2048
    v_mfma_f32_16x16x32_bf16 v[228:231], a[60:63], v[172:175], v[228:231]
    v_mfma_f32_16x16x32_bf16 v[232:235], a[64:67], v[172:175], v[232:235]
    ds_write_b128 v14, v[220:223] offset:3072
    v_mfma_f32_16x16x32_bf16 v[236:239], a[68:71], v[172:175], v[236:239]
    s_waitcnt vmcnt(7)
    v_cmp_gt_i32 vcc, 0, v179
    v_mfma_f32_16x16x32_bf16 v[240:243], a[72:75], v[172:175], v[240:243]
    ds_write_b128 v14, v[224:227] offset:4096
    v_mfma_f32_16x16x32_bf16 v[244:247], a[76:79], v[172:175], v[244:247]
    s_cbranch_vccnz k2_hr163
k2_hr163b:
    v_mfma_f32_16x16x32_bf16 v[228:231], a[80:83], v[176:179], v[228:231]
    v_mfma_f32_16x16x32_bf16 v[232:235], a[84:87], v[176:179], v[232:235]
    v_mfma_f32_16x16x32_bf16 v[236:239], a[88:91], v[176:179], v[236:239]
    s_waitcnt vmcnt(6)
    v_cmp_gt_i32 vcc, 0, v183
    v_mfma_f32_16x16x32_bf16 v[240:243], a[92:95], v[176:179], v[240:243]
    v_mfma_f32_16x16x32_bf16 v[244:247], a[96:99], v[176:179], v[244:247]
    s_cbranch_vccnz k2_hr164
k2_hr164b:
    v_mfma_f32_16x16x32_bf16 v[228:231], a[100:103], v[180:183], v[228:231]
    v_mfma_f32_16x16x32_bf16 v[232:235], a[104:107], v[180:183], v[232:235]
    v_mfma_f32_16x16x32_bf16 v[236:239], a[108:111], v[180:183], v[236:239]
    s_waitcnt vmcnt(5)
    v_cmp_gt_i32 vcc, 0, v187
    v_mfma_f32_16x16x32_bf16 v[240:243], a[112:115], v[180:183], v[240:243]
    v_mfma_f32_16x16x32_bf16 v[244:247], a[116:119], v[180:183], v[244:247]
    s_cbranch_vccnz k2_hr165
k2_hr165b:
    s_waitcnt lgkmcnt(0)
    s_barrier
    s_mul_i32 s23, s18, 15360
    s_add_u32 s23, s23, 81920
    v_add_u32 v14, s23, v1
    v_mfma_f32_16x16x32_bf16 v[228:231], a[120:123], v[184:187], v[228:231]
    v_mfma_f32_16x16x32_bf16 v[232:235], a[124:127], v[184:187], v[232:235]
    ds_read_b128 v[64:67], v14 offset:0
    v_mfma_f32_16x16x32_bf16 v[236:239], a[128:131], v[184:187], v[236:239]
    s_waitcnt vmcnt(4)
    v_cmp_gt_i32 vcc, 0, v191
    ds_read_b128 v[68:71], v14 offset:1024
    v_mfma_f32_16x16x32_bf16 v[240:243], a[132:135], v[184:187], v[240:243]
    ds_read_b128 v[72:75], v14 offset:2048
    v_mfma_f32_16x16x32_bf16 v[244:247], a[136:139], v[184:187], v[244:247]
    s_cbranch_vccnz k2_hr166
k2_hr166b:
    ds_read_b128 v[76:79], v14 offset:3072
    v_mfma_f32_16x16x32_bf16 v[228:231], a[140:143], v[188:191], v[228:231]
    ds_read_b128 v[80:83], v14 offset:4096
    v_mfma_f32_16x16x32_bf16 v[232:235], a[144:147], v[188:191], v[232:235]
    ds_read_b128 v[84:87], v14 offset:5120
    v_mfma_f32_16x16x32_bf16 v[236:239], a[148:151], v[188:191], v[236:239]
    s_waitcnt vmcnt(3)
    v_cmp_gt_i32 vcc, 0, v195
    ds_read_b128 v[88:91], v14 offset:6144
    v_mfma_f32_16x16x32_bf16 v[240:243], a[152:155], v[188:191], v[240:243]
    ds_read_b128 v[92:95], v14 offset:7168
    v_mfma_f32_16x16x32_bf16 v[244:247], a[156:159], v[188:191], v[244:247]
    s_cbranch_vccnz k2_hr167
k2_hr167b:
    ds_read_b128 v[96:99], v14 offset:8192
    v_mfma_f32_16x16x32_bf16 v[228:231], a[160:163], v[192:195], v[228:231]
    ds_read_b128 v[100:103], v14 offset:9216
    v_mfma_f32_16x16x32_bf16 v[232:235], a[164:167], v[192:195], v[232:235]
    ds_read_b128 v[104:107], v14 offset:10240
    v_mfma_f32_16x16x32_bf16 v[236:239], a[168:171], v[192:195], v[236:239]
    s_waitcnt vmcnt(2)
    v_cmp_gt_i32 vcc, 0, v199
    ds_read_b128 v[108:111], v14 offset:11264
    v_mfma_f32_16x16x32_bf16 v[240:243], a[172:175], v[192:195], v[240:243]
    ds_read_b128 v[112:115], v14 offset:12288
    v_mfma_f32_16x16x32_bf16 v[244:247], a[176:179], v[192:195], v[244:247]
    s_cbranch_vccnz k2_hr168
k2_hr168b:
    ds_read_b128 v[116:119], v14 offset:13312
    v_mfma_f32_16x16x32_bf16 v[228:231], a[180:183], v[196:199], v[228:231]
    ds_read_b128 v[120:123], v14 offset:14336
    v_mfma_f32_16x16x32_bf16 v[232:235], a[184:187], v[196:199], v[232:235]
    v_mfma_f32_16x16x32_bf16 v[236:239], a[188:191], v[196:199], v[236:239]
    s_waitcnt vmcnt(1)
    v_cmp_gt_i32 vcc, 0, v203
    v_mfma_f32_16x16x32_bf16 v[240:243], a[192:195], v[196:199], v[240:243]
    v_mfma_f32_16x16x32_bf16 v[244:247], a[196:199], v[196:199], v[244:247]
    s_cbranch_vccnz k2_hr169
k2_hr169b:
    v_mfma_f32_16x16x32_bf16 v[228:231], a[200:203], v[200:203], v[228:231]
    v_mfma_f32_16x16x32_bf16 v[232:235], a[204:207], v[200:203], v[232:235]
    v_mfma_f32_16x16x32_bf16 v[236:239], a[208:211], v[200:203], v[236:239]
    s_waitcnt vmcnt(0)
    v_cmp_gt_i32 vcc, 0, v207
    v_mfma_f32_16x16x32_bf16 v[240:243], a[212:215], v[200:203], v[240:243]
    v_mfma_f32_16x16x32_bf16 v[244:247], a[216:219], v[200:203], v[244:247]
    s_cbranch_vccnz k2_hr170
k2_hr170b:
    v_mfma_f32_16x16x32_bf16 v[228:231], a[220:223], v[204:207], v[228:231]
    v_mfma_f32_16x16x32_bf16 v[232:235], a[224:227], v[204:207], v[232:235]
    v_mfma_f32_16x16x32_bf16 v[236:239], a[228:231], v[204:207], v[236:239]
    v_mfma_f32_16x16x32_bf16 v[240:243], a[232:235], v[204:207], v[240:243]
    v_mfma_f32_16x16x32_bf16 v[244:247], a[236:239], v[204:207], v[244:247]
    v_lshlrev_b32 v32, 16, v16
    v_and_b32 v36, 0xffff0000, v16
    v_lshlrev_b32 v33, 16, v17
    v_and_b32 v37, 0xffff0000, v17
    v_lshlrev_b32 v34, 16, v18
    v_and_b32 v38, 0xffff0000, v18
    v_lshlrev_b32 v35, 16, v19
    v_and_b32 v39, 0xffff0000, v19
    v_lshlrev_b32 v40, 16, v20
    v_and_b32 v44, 0xffff0000, v20
    v_lshlrev_b32 v41, 16, v21
    v_and_b32 v45, 0xffff0000, v21
    v_lshlrev_b32 v42, 16, v22
    v_and_b32 v46, 0xffff0000, v22
    v_lshlrev_b32 v43, 16, v23
    v_and_b32 v47, 0xffff0000, v23
    v_lshlrev_b32 v48, 16, v24
    v_and_b32 v49, 0xffff0000, v24
    v_lshlrev_b32 v50, 16, v25
    v_and_b32 v51, 0xffff0000, v25
    s_waitcnt lgkmcnt(0)
    v_pk_add_f32 v[64:65], v[64:65], v[84:85]
    v_pk_add_f32 v[228:229], v[228:229], v[104:105]
    v_pk_add_f32 v[66:67], v[66:67], v[86:87]
    v_pk_add_f32 v[230:231], v[230:231], v[106:107]
    v_pk_add_f32 v[68:69], v[68:69], v[88:89]
    v_pk_add_f32 v[232:233], v[232:233], v[108:109]
    v_pk_add_f32 v[70:71], v[70:71], v[90:91]
    v_pk_add_f32 v[234:235], v[234:235], v[110:111]
    v_pk_add_f32 v[72:73], v[72:73], v[92:93]
    v_pk_add_f32 v[236:237], v[236:237], v[112:113]
    v_pk_add_f32 v[74:75], v[74:75], v[94:95]
    v_pk_add_f32 v[238:239], v[238:239], v[114:115]
    v_pk_add_f32 v[76:77], v[76:77], v[96:97]
    v_pk_add_f32 v[240:241], v[240:241], v[116:117]
    v_pk_add_f32 v[78:79], v[78:79], v[98:99]
    v_pk_add_f32 v[242:243], v[242:243], v[118:119]
    v_pk_add_f32 v[80:81], v[80:81], v[100:101]
    v_pk_add_f32 v[244:245], v[244:245], v[120:121]
    v_pk_add_f32 v[82:83], v[82:83], v[102:103]
    v_pk_add_f32 v[246:247], v[246:247], v[122:123]
    v_pk_add_f32 v[228:229], v[228:229], v[64:65]
    v_pk_add_f32 v[230:231], v[230:231], v[66:67]
    v_pk_add_f32 v[232:233], v[232:233], v[68:69]
    v_pk_add_f32 v[234:235], v[234:235], v[70:71]
    v_pk_add_f32 v[236:237], v[236:237], v[72:73]
    v_pk_add_f32 v[238:239], v[238:239], v[74:75]
    v_pk_add_f32 v[240:241], v[240:241], v[76:77]
    v_pk_add_f32 v[242:243], v[242:243], v[78:79]
    v_pk_add_f32 v[244:245], v[244:245], v[80:81]
    v_pk_add_f32 v[246:247], v[246:247], v[82:83]
    v_mov_b32 v14, v7
    v_pk_fma_f32 v[32:33], v[228:229], v[14:15], v[32:33] op_sel_hi:[1,0,1]
    v_pk_fma_f32 v[34:35], v[230:231], v[14:15], v[34:35] op_sel_hi:[1,0,1]
    v_pk_fma_f32 v[36:37], v[232:233], v[14:15], v[36:37] op_sel_hi:[1,0,1]
    v_pk_fma_f32 v[38:39], v[234:235], v[14:15], v[38:39] op_sel_hi:[1,0,1]
    v_pk_fma_f32 v[40:41], v[236:237], v[14:15], v[40:41] op_sel_hi:[1,0,1]
    v_pk_fma_f32 v[42:43], v[238:239], v[14:15], v[42:43] op_sel_hi:[1,0,1]
    v_pk_fma_f32 v[44:45], v[240:241], v[14:15], v[44:45] op_sel_hi:[1,0,1]
    v_pk_fma_f32 v[46:47], v[242:243], v[14:15], v[46:47] op_sel_hi:[1,0,1]
    v_pk_fma_f32 v[48:49], v[244:245], v[14:15], v[48:49] op_sel_hi:[1,0,1]
    v_pk_fma_f32 v[50:51], v[246:247], v[14:15], v[50:51] op_sel_hi:[1,0,1]
    v_cvt_pk_bf16_f32 v64, v32, v36
    v_cvt_pk_bf16_f32 v68, v47, v43
    v_cvt_pk_bf16_f32 v65, v33, v37
    v_cvt_pk_bf16_f32 v69, v46, v42
    v_cvt_pk_bf16_f32 v66, v34, v38
    v_cvt_pk_bf16_f32 v70, v45, v41
    v_cvt_pk_bf16_f32 v67, v35, v39
    v_cvt_pk_bf16_f32 v71, v44, v40
    buffer_store_dwordx4 v[64:67], v2, s[12:15], 0 offen
    v_cvt_pk_bf16_f32 v72, v48, v49
    v_cvt_pk_bf16_f32 v73, v50, v51
    buffer_store_dwordx4 v[68:71], v3, s[12:15], 0 offen
    buffer_store_dword v72, v4, s[12:15], 0 offen
    buffer_store_short v73, v5, s[12:15], 0 offen
    buffer_store_short_d16_hi v73, v6, s[12:15], 0 offen
k2_done:
    s_endpgm
k2_nonw:
    s_mov_b32 s38, 0
k2_nonl:
    buffer_load_dword v11, v10, s[52:55], 0 offen sc1
    s_add_u32 s38, s38, 1
    s_cmp_gt_u32 s38, 60000
    s_cbranch_scc1 k2_nonb
    s_waitcnt vmcnt(0)
    v_readfirstlane_b32 s46, v11
    s_nop 0
    s_cmp_eq_u32 s46, 0
    s_cbranch_scc1 k2_nonl
    s_branch k2_nonb
k2_nou8:
    buffer_load_dword v11, v12, s[8:11], 0 offen offset:128 sc1
    s_waitcnt vmcnt(0)
    s_branch k2_nou8x
k2_idv11:
    s_mov_b32 s38, 0
    s_add_u32 s23, s46, 16
k2_idv11a:
    buffer_load_dword v11, v12, s[8:11], 0 offen offset:128 sc1
    s_add_u32 s38, s38, 1
    s_cmp_gt_u32 s38, 60000
    s_cbranch_scc1 k2_idv11b
    s_waitcnt vmcnt(0)
    v_subrev_u32 v14, s23, v11
    v_cmp_lt_u32 vcc, 15, v14
    s_cbranch_vccnz k2_idv11a
k2_idv11b:
    v_cmp_ne_u32 vcc, s26, v11
    s_nop 1
    s_cmp_lg_u64 vcc, 0
    s_cselect_b32 s27, 1, s27
    s_branch k2_idd10
k2_pubs13:
    buffer_wbl2 sc1
    s_waitcnt vmcnt(0)
    s_mov_b64 exec, 1
    buffer_store_dword v15, v14, s[8:11], 0 offen offset:0 sc1
    s_mov_b64 exec, -1
    s_branch k2_pub12
k2_idv15:
    s_mov_b32 s38, 0
    s_add_u32 s23, s46, 16
k2_idv15a:
    buffer_load_dword v11, v12, s[8:11], 0 offen offset:128 sc1
    s_add_u32 s38, s38, 1
    s_cmp_gt_u32 s38, 60000
    s_cbranch_scc1 k2_idv15b
    s_waitcnt vmcnt(0)
    v_subrev_u32 v14, s23, v11
    v_cmp_lt_u32 vcc, 15, v14
    s_cbranch_vccnz k2_idv15a
k2_idv15b:
    v_cmp_ne_u32 vcc, s26, v11
    s_nop 1
    s_cmp_lg_u64 vcc, 0
    s_cselect_b32 s27, 1, s27
    s_branch k2_idd14
k2_pubs17:
    buffer_wbl2 sc1
    s_waitcnt vmcnt(0)
    s_mov_b64 exec, 1
    buffer_store_dword v15, v14, s[8:11], 0 offen offset:0 sc1
    s_mov_b64 exec, -1
    s_branch k2_pub16
k2_acqs21:
    buffer_inv sc1
    s_waitcnt vmcnt(0)
    s_branch k2_acq20
k2_pubs26:
    buffer_wbl2 sc1
    s_waitcnt vmcnt(0)
    s_mov_b64 exec, 1
    buffer_store_dword v15, v14, s[8:11], 0 offen offset:0 sc1
    s_mov_b64 exec, -1
    s_branch k2_pub25
k2_pubs28:
    buffer_wbl2 sc1
    s_waitcnt vmcnt(0)
    s_mov_b64 exec, 1
    buffer_store_dword v15, v14, s[8:11], 0 offen offset:0 sc1
    s_mov_b64 exec, -1
    s_branch k2_pub27
k2_acqs32:
    buffer_inv sc1
    s_waitcnt vmcnt(0)
    s_branch k2_acq31
k2_hs22:
    s_cmp_eq_u32 s18, 3
    s_cbranch_scc1 k2_w323
    s_waitcnt vmcnt(0)
    s_add_u32 s23, s46, 2
    v_mov_b32 v14, s45
    v_mov_b32 v15, s23
    s_cmp_lg_u32 s27, 0
    s_cbranch_scc1 k2_pubs26
    s_mov_b64 exec, 1
    buffer_store_dword v15, v14, s[8:11], 0 offen offset:0
    s_mov_b64 exec, -1
k2_pub25:
    s_branch k2_sb24
k2_w323:
    s_waitcnt vmcnt(0)
    s_add_u32 s23, s46, 2
    v_mov_b32 v14, s45
    v_mov_b32 v15, s23
    s_cmp_lg_u32 s27, 0
    s_cbranch_scc1 k2_pubs28
    s_mov_b64 exec, 1
    buffer_store_dword v15, v14, s[8:11], 0 offen offset:0
    s_mov_b64 exec, -1
k2_pub27:
    s_mov_b32 s38, 0
    s_add_u32 s23, s46, 2
k2_poll29:
    buffer_load_dwordx4 v[252:255], v12, s[8:11], 0 offen offset:0 sc1
    s_add_u32 s38, s38, 1
    s_cmp_gt_u32 s38, 60000
    s_cbranch_scc1 k2_pout30
    s_waitcnt vmcnt(0)
    v_subrev_u32 v252, s23, v252
    v_subrev_u32 v253, s23, v253
    v_subrev_u32 v254, s23, v254
    v_subrev_u32 v255, s23, v255
    v_max3_u32 v252, v252, v253, v254
    v_max_u32 v252, v252, v255
    v_cmp_lt_u32 vcc, 15, v252
    s_cbranch_vccnz k2_poll29
k2_pout30:
k2_sb24:
    s_waitcnt lgkmcnt(0)
    s_barrier
    s_cmp_lg_u32 s27, 0
    s_cbranch_scc1 k2_acqs32
k2_acq31:
    s_branch k2_hs22b
k2_hr36:
    s_mov_b32 s38, 0
k2_hr36a:
    buffer_load_dwordx4 v[16:19], v248, s[8:11], s52 offen sc1
    buffer_load_dwordx4 v[20:23], v248, s[8:11], s53 offen sc1
    buffer_load_dwordx4 v[24:27], v248, s[8:11], s54 offen sc1
    buffer_load_dwordx4 v[28:31], v248, s[8:11], s55 offen sc1
    buffer_load_dwordx4 v[32:35], v248, s[8:11], s56 offen sc1
    buffer_load_dwordx4 v[36:39], v248, s[8:11], s57 offen sc1
    buffer_load_dwordx4 v[40:43], v248, s[8:11], s58 offen sc1
    buffer_load_dwordx4 v[44:47], v248, s[8:11], s59 offen sc1
    buffer_load_dwordx4 v[48:51], v248, s[8:11], s60 offen sc1
    buffer_load_dwordx4 v[52:55], v248, s[8:11], s61 offen sc1
    s_add_u32 s38, s38, 1
    s_cmp_gt_u32 s38, 60000
    s_cbranch_scc1 k2_hr36b
    s_waitcnt vmcnt(0)
    v_cmp_gt_i32 vcc, 0, v19
    s_cbranch_vccnz k2_hr36a
    s_branch k2_hr36b
k2_hr37:
    s_mov_b32 s38, 0
k2_hr37a:
    buffer_load_dwordx4 v[20:23], v248, s[8:11], s53 offen sc1
    buffer_load_dwordx4 v[24:27], v248, s[8:11], s54 offen sc1
    buffer_load_dwordx4 v[28:31], v248, s[8:11], s55 offen sc1
    buffer_load_dwordx4 v[32:35], v248, s[8:11], s56 offen sc1
    buffer_load_dwordx4 v[36:39], v248, s[8:11], s57 offen sc1
    buffer_load_dwordx4 v[40:43], v248, s[8:11], s58 offen sc1
    buffer_load_dwordx4 v[44:47], v248, s[8:11], s59 offen sc1
    buffer_load_dwordx4 v[48:51], v248, s[8:11], s60 offen sc1
    buffer_load_dwordx4 v[52:55], v248, s[8:11], s61 offen sc1
    buffer_load_dwordx4 v[56:59], v248, s[8:11], s62 offen sc1
    s_add_u32 s38, s38, 1
    s_cmp_gt_u32 s38, 60000
    s_cbranch_scc1 k2_hr37b
    s_waitcnt vmcnt(0)
    v_cmp_gt_i32 vcc, 0, v23
    s_cbranch_vccnz k2_hr37a
    s_branch k2_hr37b
k2_hr38:
    s_mov_b32 s38, 0
k2_hr38a:
    buffer_load_dwordx4 v[24:27], v248, s[8:11], s54 offen sc1
    buffer_load_dwordx4 v[28:31], v248, s[8:11], s55 offen sc1
    buffer_load_dwordx4 v[32:35], v248, s[8:11], s56 offen sc1
    buffer_load_dwordx4 v[36:39], v248, s[8:11], s57 offen sc1
    buffer_load_dwordx4 v[40:43], v248, s[8:11], s58 offen sc1
    buffer_load_dwordx4 v[44:47], v248, s[8:11], s59 offen sc1
    buffer_load_dwordx4 v[48:51], v248, s[8:11], s60 offen sc1
    buffer_load_dwordx4 v[52:55], v248, s[8:11], s61 offen sc1
    buffer_load_dwordx4 v[56:59], v248, s[8:11], s62 offen sc1
    buffer_load_dwordx4 v[60:63], v248, s[8:11], s63 offen sc1
    s_add_u32 s38, s38, 1
    s_cmp_gt_u32 s38, 60000
    s_cbranch_scc1 k2_hr38b
    s_waitcnt vmcnt(0)
    v_cmp_gt_i32 vcc, 0, v27
    s_cbranch_vccnz k2_hr38a
    s_branch k2_hr38b
k2_hr39:
    s_mov_b32 s38, 0
k2_hr39a:
    buffer_load_dwordx4 v[28:31], v248, s[8:11], s55 offen sc1
    buffer_load_dwordx4 v[32:35], v248, s[8:11], s56 offen sc1
    buffer_load_dwordx4 v[36:39], v248, s[8:11], s57 offen sc1
    buffer_load_dwordx4 v[40:43], v248, s[8:11], s58 offen sc1
    buffer_load_dwordx4 v[44:47], v248, s[8:11], s59 offen sc1
    buffer_load_dwordx4 v[48:51], v248, s[8:11], s60 offen sc1
    buffer_load_dwordx4 v[52:55], v248, s[8:11], s61 offen sc1
    buffer_load_dwordx4 v[56:59], v248, s[8:11], s62 offen sc1
    buffer_load_dwordx4 v[60:63], v248, s[8:11], s63 offen sc1
    buffer_load_dwordx4 v[64:67], v249, s[8:11], s52 offen sc1
    s_add_u32 s38, s38, 1
    s_cmp_gt_u32 s38, 60000
    s_cbranch_scc1 k2_hr39b
    s_waitcnt vmcnt(0)
    v_cmp_gt_i32 vcc, 0, v31
    s_cbranch_vccnz k2_hr39a
    s_branch k2_hr39b
k2_hr40:
    s_mov_b32 s38, 0
k2_hr40a:
    buffer_load_dwordx4 v[32:35], v248, s[8:11], s56 offen sc1
    buffer_load_dwordx4 v[36:39], v248, s[8:11], s57 offen sc1
    buffer_load_dwordx4 v[40:43], v248, s[8:11], s58 offen sc1
    buffer_load_dwordx4 v[44:47], v248, s[8:11], s59 offen sc1
    buffer_load_dwordx4 v[48:51], v248, s[8:11], s60 offen sc1
    buffer_load_dwordx4 v[52:55], v248, s[8:11], s61 offen sc1
    buffer_load_dwordx4 v[56:59], v248, s[8:11], s62 offen sc1
    buffer_load_dwordx4 v[60:63], v248, s[8:11], s63 offen sc1
    buffer_load_dwordx4 v[64:67], v249, s[8:11], s52 offen sc1
    buffer_load_dwordx4 v[68:71], v249, s[8:11], s53 offen sc1
    s_add_u32 s38, s38, 1
    s_cmp_gt_u32 s38, 60000
    s_cbranch_scc1 k2_hr40b
    s_waitcnt vmcnt(0)
    v_cmp_gt_i32 vcc, 0, v35
    s_cbranch_vccnz k2_hr40a
    s_branch k2_hr40b
k2_hr41:
    s_mov_b32 s38, 0
k2_hr41a:
    buffer_load_dwordx4 v[36:39], v248, s[8:11], s57 offen sc1
    buffer_load_dwordx4 v[40:43], v248, s[8:11], s58 offen sc1
    buffer_load_dwordx4 v[44:47], v248, s[8:11], s59 offen sc1
    buffer_load_dwordx4 v[48:51], v248, s[8:11], s60 offen sc1
    buffer_load_dwordx4 v[52:55], v248, s[8:11], s61 offen sc1
    buffer_load_dwordx4 v[56:59], v248, s[8:11], s62 offen sc1
    buffer_load_dwordx4 v[60:63], v248, s[8:11], s63 offen sc1
    buffer_load_dwordx4 v[64:67], v249, s[8:11], s52 offen sc1
    buffer_load_dwordx4 v[68:71], v249, s[8:11], s53 offen sc1
    buffer_load_dwordx4 v[72:75], v249, s[8:11], s54 offen sc1
    s_add_u32 s38, s38, 1
    s_cmp_gt_u32 s38, 60000
    s_cbranch_scc1 k2_hr41b
    s_waitcnt vmcnt(0)
    v_cmp_gt_i32 vcc, 0, v39
    s_cbranch_vccnz k2_hr41a
    s_branch k2_hr41b
k2_hr42:
    s_mov_b32 s38, 0
k2_hr42a:
    buffer_load_dwordx4 v[40:43], v248, s[8:11], s58 offen sc1
    buffer_load_dwordx4 v[44:47], v248, s[8:11], s59 offen sc1
    buffer_load_dwordx4 v[48:51], v248, s[8:11], s60 offen sc1
    buffer_load_dwordx4 v[52:55], v248, s[8:11], s61 offen sc1
    buffer_load_dwordx4 v[56:59], v248, s[8:11], s62 offen sc1
    buffer_load_dwordx4 v[60:63], v248, s[8:11], s63 offen sc1
    buffer_load_dwordx4 v[64:67], v249, s[8:11], s52 offen sc1
    buffer_load_dwordx4 v[68:71], v249, s[8:11], s53 offen sc1
    buffer_load_dwordx4 v[72:75], v249, s[8:11], s54 offen sc1
    buffer_load_dwordx4 v[76:79], v249, s[8:11], s55 offen sc1
    s_add_u32 s38, s38, 1
    s_cmp_gt_u32 s38, 60000
    s_cbranch_scc1 k2_hr42b
    s_waitcnt vmcnt(0)
    v_cmp_gt_i32 vcc, 0, v43
    s_cbranch_vccnz k2_hr42a
    s_branch k2_hr42b
k2_hr43:
    s_mov_b32 s38, 0
k2_hr43a:
    buffer_load_dwordx4 v[44:47], v248, s[8:11], s59 offen sc1
    buffer_load_dwordx4 v[48:51], v248, s[8:11], s60 offen sc1
    buffer_load_dwordx4 v[52:55], v248, s[8:11], s61 offen sc1
    buffer_load_dwordx4 v[56:59], v248, s[8:11], s62 offen sc1
    buffer_load_dwordx4 v[60:63], v248, s[8:11], s63 offen sc1
    buffer_load_dwordx4 v[64:67], v249, s[8:11], s52 offen sc1
    buffer_load_dwordx4 v[68:71], v249, s[8:11], s53 offen sc1
    buffer_load_dwordx4 v[72:75], v249, s[8:11], s54 offen sc1
    buffer_load_dwordx4 v[76:79], v249, s[8:11], s55 offen sc1
    buffer_load_dwordx4 v[80:83], v249, s[8:11], s56 offen sc1
    s_add_u32 s38, s38, 1
    s_cmp_gt_u32 s38, 60000
    s_cbranch_scc1 k2_hr43b
    s_waitcnt vmcnt(0)
    v_cmp_gt_i32 vcc, 0, v47
    s_cbranch_vccnz k2_hr43a
    s_branch k2_hr43b
k2_hr44:
    s_mov_b32 s38, 0
k2_hr44a:
    buffer_load_dwordx4 v[48:51], v248, s[8:11], s60 offen sc1
    buffer_load_dwordx4 v[52:55], v248, s[8:11], s61 offen sc1
    buffer_load_dwordx4 v[56:59], v248, s[8:11], s62 offen sc1
    buffer_load_dwordx4 v[60:63], v248, s[8:11], s63 offen sc1
    buffer_load_dwordx4 v[64:67], v249, s[8:11], s52 offen sc1
    buffer_load_dwordx4 v[68:71], v249, s[8:11], s53 offen sc1
    buffer_load_dwordx4 v[72:75], v249, s[8:11], s54 offen sc1
    buffer_load_dwordx4 v[76:79], v249, s[8:11], s55 offen sc1
    buffer_load_dwordx4 v[80:83], v249, s[8:11], s56 offen sc1
    buffer_load_dwordx4 v[84:87], v249, s[8:11], s57 offen sc1
    s_add_u32 s38, s38, 1
    s_cmp_gt_u32 s38, 60000
    s_cbranch_scc1 k2_hr44b
    s_waitcnt vmcnt(0)
    v_cmp_gt_i32 vcc, 0, v51
    s_cbranch_vccnz k2_hr44a
    s_branch k2_hr44b
k2_hr45:
    s_mov_b32 s38, 0
k2_hr45a:
    buffer_load_dwordx4 v[52:55], v248, s[8:11], s61 offen sc1
    buffer_load_dwordx4 v[56:59], v248, s[8:11], s62 offen sc1
    buffer_load_dwordx4 v[60:63], v248, s[8:11], s63 offen sc1
    buffer_load_dwordx4 v[64:67], v249, s[8:11], s52 offen sc1
    buffer_load_dwordx4 v[68:71], v249, s[8:11], s53 offen sc1
    buffer_load_dwordx4 v[72:75], v249, s[8:11], s54 offen sc1
    buffer_load_dwordx4 v[76:79], v249, s[8:11], s55 offen sc1
    buffer_load_dwordx4 v[80:83], v249, s[8:11], s56 offen sc1
    buffer_load_dwordx4 v[84:87], v249, s[8:11], s57 offen sc1
    buffer_load_dwordx4 v[88:91], v249, s[8:11], s58 offen sc1
    s_add_u32 s38, s38, 1
    s_cmp_gt_u32 s38, 60000
    s_cbranch_scc1 k2_hr45b
    s_waitcnt vmcnt(0)
    v_cmp_gt_i32 vcc, 0, v55
    s_cbranch_vccnz k2_hr45a
    s_branch k2_hr45b
k2_hr46:
    s_mov_b32 s38, 0
k2_hr46a:
    buffer_load_dwordx4 v[56:59], v248, s[8:11], s62 offen sc1
    buffer_load_dwordx4 v[60:63], v248, s[8:11], s63 offen sc1
    buffer_load_dwordx4 v[64:67], v249, s[8:11], s52 offen sc1
    buffer_load_dwordx4 v[68:71], v249, s[8:11], s53 offen sc1
    buffer_load_dwordx4 v[72:75], v249, s[8:11], s54 offen sc1
    buffer_load_dwordx4 v[76:79], v249, s[8:11], s55 offen sc1
    buffer_load_dwordx4 v[80:83], v249, s[8:11], s56 offen sc1
    buffer_load_dwordx4 v[84:87], v249, s[8:11], s57 offen sc1
    buffer_load_dwordx4 v[88:91], v249, s[8:11], s58 offen sc1
    buffer_load_dwordx4 v[92:95], v249, s[8:11], s59 offen sc1
    s_add_u32 s38, s38, 1
    s_cmp_gt_u32 s38, 60000
    s_cbranch_scc1 k2_hr46b
    s_waitcnt vmcnt(0)
    v_cmp_gt_i32 vcc, 0, v59
    s_cbranch_vccnz k2_hr46a
    s_branch k2_hr46b
k2_hr47:
    s_mov_b32 s38, 0
k2_hr47a:
    buffer_load_dwordx4 v[60:63], v248, s[8:11], s63 offen sc1
    buffer_load_dwordx4 v[64:67], v249, s[8:11], s52 offen sc1
    buffer_load_dwordx4 v[68:71], v249, s[8:11], s53 offen sc1
    buffer_load_dwordx4 v[72:75], v249, s[8:11], s54 offen sc1
    buffer_load_dwordx4 v[76:79], v249, s[8:11], s55 offen sc1
    buffer_load_dwordx4 v[80:83], v249, s[8:11], s56 offen sc1
    buffer_load_dwordx4 v[84:87], v249, s[8:11], s57 offen sc1
    buffer_load_dwordx4 v[88:91], v249, s[8:11], s58 offen sc1
    buffer_load_dwordx4 v[92:95], v249, s[8:11], s59 offen sc1
    buffer_load_dwordx4 v[96:99], v249, s[8:11], s60 offen sc1
    s_add_u32 s38, s38, 1
    s_cmp_gt_u32 s38, 60000
    s_cbranch_scc1 k2_hr47b
    s_waitcnt vmcnt(0)
    v_cmp_gt_i32 vcc, 0, v63
    s_cbranch_vccnz k2_hr47a
    s_branch k2_hr47b
k2_hr48:
    s_mov_b32 s38, 0
k2_hr48a:
    buffer_load_dwordx4 v[64:67], v249, s[8:11], s52 offen sc1
    buffer_load_dwordx4 v[68:71], v249, s[8:11], s53 offen sc1
    buffer_load_dwordx4 v[72:75], v249, s[8:11], s54 offen sc1
    buffer_load_dwordx4 v[76:79], v249, s[8:11], s55 offen sc1
    buffer_load_dwordx4 v[80:83], v249, s[8:11], s56 offen sc1
    buffer_load_dwordx4 v[84:87], v249, s[8:11], s57 offen sc1
    buffer_load_dwordx4 v[88:91], v249, s[8:11], s58 offen sc1
    buffer_load_dwordx4 v[92:95], v249, s[8:11], s59 offen sc1
    buffer_load_dwordx4 v[96:99], v249, s[8:11], s60 offen sc1
    buffer_load_dwordx4 v[100:103], v249, s[8:11], s61 offen sc1
    s_add_u32 s38, s38, 1
    s_cmp_gt_u32 s38, 60000
    s_cbranch_scc1 k2_hr48b
    s_waitcnt vmcnt(0)
    v_cmp_gt_i32 vcc, 0, v67
    s_cbranch_vccnz k2_hr48a
    s_branch k2_hr48b
k2_hr49:
    s_mov_b32 s38, 0
k2_hr49a:
    buffer_load_dwordx4 v[68:71], v249, s[8:11], s53 offen sc1
    s_add_u32 s38, s38, 1
    s_cmp_gt_u32 s38, 60000
    s_cbranch_scc1 k2_hr49b
    s_waitcnt vmcnt(0)
    v_cmp_gt_i32 vcc, 0, v71
    s_cbranch_vccnz k2_hr49a
    s_branch k2_hr49b
k2_hr50:
    s_mov_b32 s38, 0
k2_hr50a:
    buffer_load_dwordx4 v[72:75], v249, s[8:11], s54 offen sc1
    s_add_u32 s38, s38, 1
    s_cmp_gt_u32 s38, 60000
    s_cbranch_scc1 k2_hr50b
    s_waitcnt vmcnt(0)
    v_cmp_gt_i32 vcc, 0, v75
    s_cbranch_vccnz k2_hr50a
    s_branch k2_hr50b
k2_hr51:
    s_mov_b32 s38, 0
k2_hr51a:
    buffer_load_dwordx4 v[76:79], v249, s[8:11], s55 offen sc1
    s_add_u32 s38, s38, 1
    s_cmp_gt_u32 s38, 60000
    s_cbranch_scc1 k2_hr51b
    s_waitcnt vmcnt(0)
    v_cmp_gt_i32 vcc, 0, v79
    s_cbranch_vccnz k2_hr51a
    s_branch k2_hr51b
k2_hr52:
    s_mov_b32 s38, 0
k2_hr52a:
    buffer_load_dwordx4 v[80:83], v249, s[8:11], s56 offen sc1
    s_add_u32 s38, s38, 1
    s_cmp_gt_u32 s38, 60000
    s_cbranch_scc1 k2_hr52b
    s_waitcnt vmcnt(0)
    v_cmp_gt_i32 vcc, 0, v83
    s_cbranch_vccnz k2_hr52a
    s_branch k2_hr52b
k2_hr53:
    s_mov_b32 s38, 0
k2_hr53a:
    buffer_load_dwordx4 v[84:87], v249, s[8:11], s57 offen sc1
    s_add_u32 s38, s38, 1
    s_cmp_gt_u32 s38, 60000
    s_cbranch_scc1 k2_hr53b
    s_waitcnt vmcnt(0)
    v_cmp_gt_i32 vcc, 0, v87
    s_cbranch_vccnz k2_hr53a
    s_branch k2_hr53b
k2_hr54:
    s_mov_b32 s38, 0
k2_hr54a:
    buffer_load_dwordx4 v[88:91], v249, s[8:11], s58 offen sc1
    s_add_u32 s38, s38, 1
    s_cmp_gt_u32 s38, 60000
    s_cbranch_scc1 k2_hr54b
    s_waitcnt vmcnt(0)
    v_cmp_gt_i32 vcc, 0, v91
    s_cbranch_vccnz k2_hr54a
    s_branch k2_hr54b
k2_hr55:
    s_mov_b32 s38, 0
k2_hr55a:
    buffer_load_dwordx4 v[92:95], v249, s[8:11], s59 offen sc1
    s_add_u32 s38, s38, 1
    s_cmp_gt_u32 s38, 60000
    s_cbranch_scc1 k2_hr55b
    s_waitcnt vmcnt(0)
    v_cmp_gt_i32 vcc, 0, v95
    s_cbranch_vccnz k2_hr55a
    s_branch k2_hr55b
k2_hr56:
    s_mov_b32 s38, 0
k2_hr56a:
    buffer_load_dwordx4 v[96:99], v249, s[8:11], s60 offen sc1
    s_add_u32 s38, s38, 1
    s_cmp_gt_u32 s38, 60000
    s_cbranch_scc1 k2_hr56b
    s_waitcnt vmcnt(0)
    v_cmp_gt_i32 vcc, 0, v99
    s_cbranch_vccnz k2_hr56a
    s_branch k2_hr56b
k2_hr57:
    s_mov_b32 s38, 0
k2_hr57a:
    buffer_load_dwordx4 v[100:103], v249, s[8:11], s61 offen sc1
    s_add_u32 s38, s38, 1
    s_cmp_gt_u32 s38, 60000
    s_cbranch_scc1 k2_hr57b
    s_waitcnt vmcnt(0)
    v_cmp_gt_i32 vcc, 0, v103
    s_cbranch_vccnz k2_hr57a
    s_branch k2_hr57b
k2_hr58:
    s_mov_b32 s38, 0
k2_hr58a:
    buffer_load_dwordx4 v[104:107], v249, s[8:11], s62 offen sc1
    s_add_u32 s38, s38, 1
    s_cmp_gt_u32 s38, 60000
    s_cbranch_scc1 k2_hr58b
    s_waitcnt vmcnt(0)
    v_cmp_gt_i32 vcc, 0, v107
    s_cbranch_vccnz k2_hr58a
    s_branch k2_hr58b
k2_hr59:
    s_mov_b32 s38, 0
k2_hr59a:
    buffer_load_dwordx4 v[108:111], v249, s[8:11], s63 offen sc1
    s_add_u32 s38, s38, 1
    s_cmp_gt_u32 s38, 60000
    s_cbranch_scc1 k2_hr59b
    s_waitcnt vmcnt(0)
    v_cmp_gt_i32 vcc, 0, v111
    s_cbranch_vccnz k2_hr59a
    s_branch k2_hr59b
k2_hr60:
    s_mov_b32 s38, 0
k2_hr60a:
    buffer_load_dwordx4 v[112:115], v250, s[8:11], s52 offen sc1
    s_add_u32 s38, s38, 1
    s_cmp_gt_u32 s38, 60000
    s_cbranch_scc1 k2_hr60b
    s_waitcnt vmcnt(0)
    v_cmp_gt_i32 vcc, 0, v115
    s_cbranch_vccnz k2_hr60a
    s_branch k2_hr60b
k2_hr61:
    s_mov_b32 s38, 0
k2_hr61a:
    buffer_load_dwordx4 v[116:119], v250, s[8:11], s53 offen sc1
    s_add_u32 s38, s38, 1
    s_cmp_gt_u32 s38, 60000
    s_cbranch_scc1 k2_hr61b
    s_waitcnt vmcnt(0)
    v_cmp_gt_i32 vcc, 0, v119
    s_cbranch_vccnz k2_hr61a
    s_branch k2_hr61b
k2_hr62:
    s_mov_b32 s38, 0
k2_hr62a:
    buffer_load_dwordx4 v[120:123], v250, s[8:11], s54 offen sc1
    s_add_u32 s38, s38, 1
    s_cmp_gt_u32 s38, 60000
    s_cbranch_scc1 k2_hr62b
    s_waitcnt vmcnt(0)
    v_cmp_gt_i32 vcc, 0, v123
    s_cbranch_vccnz k2_hr62a
    s_branch k2_hr62b
k2_hr63:
    s_mov_b32 s38, 0
k2_hr63a:
    buffer_load_dwordx4 v[124:127], v250, s[8:11], s55 offen sc1
    s_add_u32 s38, s38, 1
    s_cmp_gt_u32 s38, 60000
    s_cbranch_scc1 k2_hr63b
    s_waitcnt vmcnt(0)
    v_cmp_gt_i32 vcc, 0, v127
    s_cbranch_vccnz k2_hr63a
    s_branch k2_hr63b
k2_hr64:
    s_mov_b32 s38, 0
k2_hr64a:
    buffer_load_dwordx4 v[128:131], v250, s[8:11], s56 offen sc1
    s_add_u32 s38, s38, 1
    s_cmp_gt_u32 s38, 60000
    s_cbranch_scc1 k2_hr64b
    s_waitcnt vmcnt(0)
    v_cmp_gt_i32 vcc, 0, v131
    s_cbranch_vccnz k2_hr64a
    s_branch k2_hr64b
k2_hr65:
    s_mov_b32 s38, 0
k2_hr65a:
    buffer_load_dwordx4 v[132:135], v250, s[8:11], s57 offen sc1
    s_add_u32 s38, s38, 1
    s_cmp_gt_u32 s38, 60000
    s_cbranch_scc1 k2_hr65b
    s_waitcnt vmcnt(0)
    v_cmp_gt_i32 vcc, 0, v135
    s_cbranch_vccnz k2_hr65a
    s_branch k2_hr65b
k2_hr66:
    s_mov_b32 s38, 0
k2_hr66a:
    buffer_load_dwordx4 v[136:139], v250, s[8:11], s58 offen sc1
    s_add_u32 s38, s38, 1
    s_cmp_gt_u32 s38, 60000
    s_cbranch_scc1 k2_hr66b
    s_waitcnt vmcnt(0)
    v_cmp_gt_i32 vcc, 0, v139
    s_cbranch_vccnz k2_hr66a
    s_branch k2_hr66b
k2_hr67:
    s_mov_b32 s38, 0
k2_hr67a:
    buffer_load_dwordx4 v[140:143], v250, s[8:11], s59 offen sc1
    s_add_u32 s38, s38, 1
    s_cmp_gt_u32 s38, 60000
    s_cbranch_scc1 k2_hr67b
    s_waitcnt vmcnt(0)
    v_cmp_gt_i32 vcc, 0, v143
    s_cbranch_vccnz k2_hr67a
    s_branch k2_hr67b
k2_hr68:
    s_mov_b32 s38, 0
k2_hr68a:
    buffer_load_dwordx4 v[144:147], v250, s[8:11], s60 offen sc1
    s_add_u32 s38, s38, 1
    s_cmp_gt_u32 s38, 60000
    s_cbranch_scc1 k2_hr68b
    s_waitcnt vmcnt(0)
    v_cmp_gt_i32 vcc, 0, v147
    s_cbranch_vccnz k2_hr68a
    s_branch k2_hr68b
k2_hr69:
    s_mov_b32 s38, 0
k2_hr69a:
    buffer_load_dwordx4 v[148:151], v250, s[8:11], s61 offen sc1
    s_add_u32 s38, s38, 1
    s_cmp_gt_u32 s38, 60000
    s_cbranch_scc1 k2_hr69b
    s_waitcnt vmcnt(0)
    v_cmp_gt_i32 vcc, 0, v151
    s_cbranch_vccnz k2_hr69a
    s_branch k2_hr69b
k2_hr70:
    s_mov_b32 s38, 0
k2_hr70a:
    buffer_load_dwordx4 v[152:155], v250, s[8:11], s62 offen sc1
    s_add_u32 s38, s38, 1
    s_cmp_gt_u32 s38, 60000
    s_cbranch_scc1 k2_hr70b
    s_waitcnt vmcnt(0)
    v_cmp_gt_i32 vcc, 0, v155
    s_cbranch_vccnz k2_hr70a
    s_branch k2_hr70b
k2_hr71:
    s_mov_b32 s38, 0
k2_hr71a:
    buffer_load_dwordx4 v[156:159], v250, s[8:11], s63 offen sc1
    s_add_u32 s38, s38, 1
    s_cmp_gt_u32 s38, 60000
    s_cbranch_scc1 k2_hr71b
    s_waitcnt vmcnt(0)
    v_cmp_gt_i32 vcc, 0, v159
    s_cbranch_vccnz k2_hr71a
    s_branch k2_hr71b
k2_hr72:
    s_mov_b32 s38, 0
k2_hr72a:
    buffer_load_dwordx4 v[160:163], v251, s[8:11], s52 offen sc1
    s_add_u32 s38, s38, 1
    s_cmp_gt_u32 s38, 60000
    s_cbranch_scc1 k2_hr72b
    s_waitcnt vmcnt(0)
    v_cmp_gt_i32 vcc, 0, v163
    s_cbranch_vccnz k2_hr72a
    s_branch k2_hr72b
k2_hr73:
    s_mov_b32 s38, 0
k2_hr73a:
    buffer_load_dwordx4 v[164:167], v251, s[8:11], s53 offen sc1
    s_add_u32 s38, s38, 1
    s_cmp_gt_u32 s38, 60000
    s_cbranch_scc1 k2_hr73b
    s_waitcnt vmcnt(0)
    v_cmp_gt_i32 vcc, 0, v167
    s_cbranch_vccnz k2_hr73a
    s_branch k2_hr73b
k2_hr74:
    s_mov_b32 s38, 0
k2_hr74a:
    buffer_load_dwordx4 v[168:171], v251, s[8:11], s54 offen sc1
    s_add_u32 s38, s38, 1
    s_cmp_gt_u32 s38, 60000
    s_cbranch_scc1 k2_hr74b
    s_waitcnt vmcnt(0)
    v_cmp_gt_i32 vcc, 0, v171
    s_cbranch_vccnz k2_hr74a
    s_branch k2_hr74b
k2_hr75:
    s_mov_b32 s38, 0
k2_hr75a:
    buffer_load_dwordx4 v[172:175], v251, s[8:11], s55 offen sc1
    s_add_u32 s38, s38, 1
    s_cmp_gt_u32 s38, 60000
    s_cbranch_scc1 k2_hr75b
    s_waitcnt vmcnt(0)
    v_cmp_gt_i32 vcc, 0, v175
    s_cbranch_vccnz k2_hr75a
    s_branch k2_hr75b
k2_hr76:
    s_mov_b32 s38, 0
k2_hr76a:
    buffer_load_dwordx4 v[176:179], v251, s[8:11], s56 offen sc1
    s_add_u32 s38, s38, 1
    s_cmp_gt_u32 s38, 60000
    s_cbranch_scc1 k2_hr76b
    s_waitcnt vmcnt(0)
    v_cmp_gt_i32 vcc, 0, v179
    s_cbranch_vccnz k2_hr76a
    s_branch k2_hr76b
k2_hr77:
    s_mov_b32 s38, 0
k2_hr77a:
    buffer_load_dwordx4 v[180:183], v251, s[8:11], s57 offen sc1
    s_add_u32 s38, s38, 1
    s_cmp_gt_u32 s38, 60000
    s_cbranch_scc1 k2_hr77b
    s_waitcnt vmcnt(0)
    v_cmp_gt_i32 vcc, 0, v183
    s_cbranch_vccnz k2_hr77a
    s_branch k2_hr77b
k2_hr78:
    s_mov_b32 s38, 0
k2_hr78a:
    buffer_load_dwordx4 v[184:187], v251, s[8:11], s58 offen sc1
    s_add_u32 s38, s38, 1
    s_cmp_gt_u32 s38, 60000
    s_cbranch_scc1 k2_hr78b
    s_waitcnt vmcnt(0)
    v_cmp_gt_i32 vcc, 0, v187
    s_cbranch_vccnz k2_hr78a
    s_branch k2_hr78b
k2_hr79:
    s_mov_b32 s38, 0
k2_hr79a:
    buffer_load_dwordx4 v[188:191], v251, s[8:11], s59 offen sc1
    s_add_u32 s38, s38, 1
    s_cmp_gt_u32 s38, 60000
    s_cbranch_scc1 k2_hr79b
    s_waitcnt vmcnt(0)
    v_cmp_gt_i32 vcc, 0, v191
    s_cbranch_vccnz k2_hr79a
    s_branch k2_hr79b
k2_hr80:
    s_mov_b32 s38, 0
k2_hr80a:
    buffer_load_dwordx4 v[192:195], v251, s[8:11], s60 offen sc1
    s_add_u32 s38, s38, 1
    s_cmp_gt_u32 s38, 60000
    s_cbranch_scc1 k2_hr80b
    s_waitcnt vmcnt(0)
    v_cmp_gt_i32 vcc, 0, v195
    s_cbranch_vccnz k2_hr80a
    s_branch k2_hr80b
k2_hr81:
    s_mov_b32 s38, 0
k2_hr81a:
    buffer_load_dwordx4 v[196:199], v251, s[8:11], s61 offen sc1
    s_add_u32 s38, s38, 1
    s_cmp_gt_u32 s38, 60000
    s_cbranch_scc1 k2_hr81b
    s_waitcnt vmcnt(0)
    v_cmp_gt_i32 vcc, 0, v199
    s_cbranch_vccnz k2_hr81a
    s_branch k2_hr81b
k2_hr82:
    s_mov_b32 s38, 0
k2_hr82a:
    buffer_load_dwordx4 v[200:203], v251, s[8:11], s62 offen sc1
    s_add_u32 s38, s38, 1
    s_cmp_gt_u32 s38, 60000
    s_cbranch_scc1 k2_hr82b
    s_waitcnt vmcnt(0)
    v_cmp_gt_i32 vcc, 0, v203
    s_cbranch_vccnz k2_hr82a
    s_branch k2_hr82b
k2_hr83:
    s_mov_b32 s38, 0
k2_hr83a:
    buffer_load_dwordx4 v[204:207], v251, s[8:11], s63 offen sc1
    s_add_u32 s38, s38, 1
    s_cmp_gt_u32 s38, 60000
    s_cbranch_scc1 k2_hr83b
    s_waitcnt vmcnt(0)
    v_cmp_gt_i32 vcc, 0, v207
    s_cbranch_vccnz k2_hr83a
    s_branch k2_hr83b
k2_pubs88:
    buffer_wbl2 sc1
    s_waitcnt vmcnt(0)
    s_mov_b64 exec, 1
    buffer_store_dword v15, v14, s[8:11], 0 offen offset:0 sc1
    s_mov_b64 exec, -1
    s_branch k2_pub87
k2_pubs91:
    buffer_wbl2 sc1
    s_waitcnt vmcnt(0)
    s_mov_b64 exec, 1
    buffer_store_dword v15, v14, s[8:11], 0 offen offset:0 sc1
    s_mov_b64 exec, -1
    s_branch k2_pub90
k2_acqs95:
    buffer_inv sc1
    s_waitcnt vmcnt(0)
    s_branch k2_acq94
k2_tr101a:
    s_add_u32 s47, s47, 1
    s_cmp_gt_u32 s47, 60000
    s_cbranch_scc1 k2_tr101b
    s_mov_b32 s48, 0
    v_max_u32 v15, v160, v161
    v_max3_u32 v15, v15, v162, v163
    v_cmp_eq_u32 vcc, -1, v15
    s_cbranch_vccz k2_tr101s0
    s_mov_b32 s48, 1
    buffer_load_dword v160, v2, s[8:11], s31 offen offset:0 sc1
    buffer_load_dword v161, v2, s[8:11], s31 offen offset:128 sc1
    buffer_load_dword v162, v2, s[8:11], s31 offen offset:256 sc1
    buffer_load_dword v163, v2, s[8:11], s31 offen offset:384 sc1
k2_tr101s0:
    v_max_u32 v15, v164, v165
    v_max3_u32 v15, v15, v166, v167
    v_cmp_eq_u32 vcc, -1, v15
    s_cbranch_vccz k2_tr101s1
    s_mov_b32 s48, 1
    buffer_load_dword v164, v2, s[8:11], s31 offen offset:1024 sc1
    buffer_load_dword v165, v2, s[8:11], s31 offen offset:1152 sc1
    buffer_load_dword v166, v2, s[8:11], s31 offen offset:1280 sc1
    buffer_load_dword v167, v2, s[8:11], s31 offen offset:1408 sc1
k2_tr101s1:
    v_max_u32 v15, v168, v169
    v_max3_u32 v15, v15, v170, v171
    v_cmp_eq_u32 vcc, -1, v15
    s_cbranch_vccz k2_tr101s2
    s_mov_b32 s48, 1
    buffer_load_dword v168, v2, s[8:11], s31 offen offset:2048 sc1
    buffer_load_dword v169, v2, s[8:11], s31 offen offset:2176 sc1
    buffer_load_dword v170, v2, s[8:11], s31 offen offset:2304 sc1
    buffer_load_dword v171, v2, s[8:11], s31 offen offset:2432 sc1
k2_tr101s2:
    v_max_u32 v15, v172, v173
    v_max3_u32 v15, v15, v174, v175
    v_cmp_eq_u32 vcc, -1, v15
    s_cbranch_vccz k2_tr101s3
    s_mov_b32 s48, 1
    buffer_load_dword v172, v2, s[8:11], s31 offen offset:3072 sc1
    buffer_load_dword v173, v2, s[8:11], s31 offen offset:3200 sc1
    buffer_load_dword v174, v2, s[8:11], s31 offen offset:3328 sc1
    buffer_load_dword v175, v2, s[8:11], s31 offen offset:3456 sc1
k2_tr101s3:
    v_max_u32 v15, v176, v177
    v_max3_u32 v15, v15, v178, v179
    v_cmp_eq_u32 vcc, -1, v15
    s_cbranch_vccz k2_tr101s4
    s_mov_b32 s48, 1
    buffer_load_dword v176, v2, s[8:11], s32 offen offset:0 sc1
    buffer_load_dword v177, v2, s[8:11], s32 offen offset:128 sc1
    buffer_load_dword v178, v2, s[8:11], s32 offen offset:256 sc1
    buffer_load_dword v179, v2, s[8:11], s32 offen offset:384 sc1
k2_tr101s4:
    v_max_u32 v15, v180, v181
    v_max3_u32 v15, v15, v182, v183
    v_cmp_eq_u32 vcc, -1, v15
    s_cbranch_vccz k2_tr101s5
    s_mov_b32 s48, 1
    buffer_load_dword v180, v2, s[8:11], s32 offen offset:1024 sc1
    buffer_load_dword v181, v2, s[8:11], s32 offen offset:1152 sc1
    buffer_load_dword v182, v2, s[8:11], s32 offen offset:1280 sc1
    buffer_load_dword v183, v2, s[8:11], s32 offen offset:1408 sc1
k2_tr101s5:
    v_max_u32 v15, v184, v185
    v_max3_u32 v15, v15, v186, v187
    v_cmp_eq_u32 vcc, -1, v15
    s_cbranch_vccz k2_tr101s6
    s_mov_b32 s48, 1
    buffer_load_dword v184, v2, s[8:11], s32 offen offset:2048 sc1
    buffer_load_dword v185, v2, s[8:11], s32 offen offset:2176 sc1
    buffer_load_dword v186, v2, s[8:11], s32 offen offset:2304 sc1
    buffer_load_dword v187, v2, s[8:11], s32 offen offset:2432 sc1
k2_tr101s6:
    v_max_u32 v15, v188, v189
    v_max3_u32 v15, v15, v190, v191
    v_cmp_eq_u32 vcc, -1, v15
    s_cbranch_vccz k2_tr101s7
    s_mov_b32 s48, 1
    buffer_load_dword v188, v2, s[8:11], s32 offen offset:3072 sc1
    buffer_load_dword v189, v2, s[8:11], s32 offen offset:3200 sc1
    buffer_load_dword v190, v2, s[8:11], s32 offen offset:3328 sc1
    buffer_load_dword v191, v2, s[8:11], s32 offen offset:3456 sc1
k2_tr101s7:
    s_waitcnt vmcnt(0)
    s_cmp_lg_u32 s48, 0
    s_cbranch_scc1 k2_tr101a
    s_branch k2_tr101
k2_pubs105:
    buffer_wbl2 sc1
    s_waitcnt vmcnt(0)
    s_mov_b64 exec, 1
    buffer_store_dword v15, v14, s[8:11], 0 offen offset:0 sc1
    s_mov_b64 exec, -1
    s_branch k2_pub104
k2_pubs107:
    buffer_wbl2 sc1
    s_waitcnt vmcnt(0)
    s_mov_b64 exec, 1
    buffer_store_dword v15, v14, s[8:11], 0 offen offset:0 sc1
    s_mov_b64 exec, -1
    s_branch k2_pub106
k2_acqs111:
    buffer_inv sc1
    s_waitcnt vmcnt(0)
    s_branch k2_acq110
k2_pubs116:
    buffer_wbl2 sc1
    s_waitcnt vmcnt(0)
    s_mov_b64 exec, 1
    buffer_store_dword v15, v14, s[8:11], 0 offen offset:0 sc1
    s_mov_b64 exec, -1
    s_branch k2_pub115
k2_pubs118:
    buffer_wbl2 sc1
    s_waitcnt vmcnt(0)
    s_mov_b64 exec, 1
    buffer_store_dword v15, v14, s[8:11], 0 offen offset:0 sc1
    s_mov_b64 exec, -1
    s_branch k2_pub117
k2_acqs122:
    buffer_inv sc1
    s_waitcnt vmcnt(0)
    s_branch k2_acq121
k2_hs112:
    s_cmp_eq_u32 s18, 3
    s_cbranch_scc1 k2_w3113
    s_waitcnt vmcnt(0)
    s_add_u32 s23, s46, 6
    v_mov_b32 v14, s45
    v_mov_b32 v15, s23
    s_cmp_lg_u32 s27, 0
    s_cbranch_scc1 k2_pubs116
    s_mov_b64 exec, 1
    buffer_store_dword v15, v14, s[8:11], 0 offen offset:0
    s_mov_b64 exec, -1
k2_pub115:
    s_branch k2_sb114
k2_w3113:
    s_waitcnt vmcnt(0)
    s_add_u32 s23, s46, 6
    v_mov_b32 v14, s45
    v_mov_b32 v15, s23
    s_cmp_lg_u32 s27, 0
    s_cbranch_scc1 k2_pubs118
    s_mov_b64 exec, 1
    buffer_store_dword v15, v14, s[8:11], 0 offen offset:0
    s_mov_b64 exec, -1
k2_pub117:
    s_mov_b32 s38, 0
    s_add_u32 s23, s46, 6
k2_poll119:
    buffer_load_dwordx4 v[252:255], v12, s[8:11], 0 offen offset:0 sc1
    s_add_u32 s38, s38, 1
    s_cmp_gt_u32 s38, 60000
    s_cbranch_scc1 k2_pout120
    s_waitcnt vmcnt(0)
    v_subrev_u32 v252, s23, v252
    v_subrev_u32 v253, s23, v253
    v_subrev_u32 v254, s23, v254
    v_subrev_u32 v255, s23, v255
    v_max3_u32 v252, v252, v253, v254
    v_max_u32 v252, v252, v255
    v_cmp_lt_u32 vcc, 15, v252
    s_cbranch_vccnz k2_poll119
k2_pout120:
k2_sb114:
    s_waitcnt lgkmcnt(0)
    s_barrier
    s_cmp_lg_u32 s27, 0
    s_cbranch_scc1 k2_acqs122
k2_acq121:
    s_branch k2_hs112b
k2_hr123:
    s_mov_b32 s38, 0
k2_hr123a:
    buffer_load_dwordx4 v[16:19], v248, s[8:11], s52 offen sc1
    buffer_load_dwordx4 v[20:23], v248, s[8:11], s53 offen sc1
    buffer_load_dwordx4 v[24:27], v248, s[8:11], s54 offen sc1
    buffer_load_dwordx4 v[28:31], v248, s[8:11], s55 offen sc1
    buffer_load_dwordx4 v[32:35], v248, s[8:11], s56 offen sc1
    buffer_load_dwordx4 v[36:39], v248, s[8:11], s57 offen sc1
    buffer_load_dwordx4 v[40:43], v248, s[8:11], s58 offen sc1
    buffer_load_dwordx4 v[44:47], v248, s[8:11], s59 offen sc1
    buffer_load_dwordx4 v[48:51], v248, s[8:11], s60 offen sc1
    buffer_load_dwordx4 v[52:55], v248, s[8:11], s61 offen sc1
    s_add_u32 s38, s38, 1
    s_cmp_gt_u32 s38, 60000
    s_cbranch_scc1 k2_hr123b
    s_waitcnt vmcnt(0)
    v_cmp_gt_i32 vcc, 0, v19
    s_cbranch_vccnz k2_hr123a
    s_branch k2_hr123b
k2_hr124:
    s_mov_b32 s38, 0
k2_hr124a:
    buffer_load_dwordx4 v[20:23], v248, s[8:11], s53 offen sc1
    buffer_load_dwordx4 v[24:27], v248, s[8:11], s54 offen sc1
    buffer_load_dwordx4 v[28:31], v248, s[8:11], s55 offen sc1
    buffer_load_dwordx4 v[32:35], v248, s[8:11], s56 offen sc1
    buffer_load_dwordx4 v[36:39], v248, s[8:11], s57 offen sc1
    buffer_load_dwordx4 v[40:43], v248, s[8:11], s58 offen sc1
    buffer_load_dwordx4 v[44:47], v248, s[8:11], s59 offen sc1
    buffer_load_dwordx4 v[48:51], v248, s[8:11], s60 offen sc1
    buffer_load_dwordx4 v[52:55], v248, s[8:11], s61 offen sc1
    buffer_load_dwordx4 v[56:59], v248, s[8:11], s62 offen sc1
    s_add_u32 s38, s38, 1
    s_cmp_gt_u32 s38, 60000
    s_cbranch_scc1 k2_hr124b
    s_waitcnt vmcnt(0)
    v_cmp_gt_i32 vcc, 0, v23
    s_cbranch_vccnz k2_hr124a
    s_branch k2_hr124b
k2_hr125:
    s_mov_b32 s38, 0
k2_hr125a:
    buffer_load_dwordx4 v[24:27], v248, s[8:11], s54 offen sc1
    buffer_load_dwordx4 v[28:31], v248, s[8:11], s55 offen sc1
    buffer_load_dwordx4 v[32:35], v248, s[8:11], s56 offen sc1
    buffer_load_dwordx4 v[36:39], v248, s[8:11], s57 offen sc1
    buffer_load_dwordx4 v[40:43], v248, s[8:11], s58 offen sc1
    buffer_load_dwordx4 v[44:47], v248, s[8:11], s59 offen sc1
    buffer_load_dwordx4 v[48:51], v248, s[8:11], s60 offen sc1
    buffer_load_dwordx4 v[52:55], v248, s[8:11], s61 offen sc1
    buffer_load_dwordx4 v[56:59], v248, s[8:11], s62 offen sc1
    buffer_load_dwordx4 v[60:63], v248, s[8:11], s63 offen sc1
    s_add_u32 s38, s38, 1
    s_cmp_gt_u32 s38, 60000
    s_cbranch_scc1 k2_hr125b
    s_waitcnt vmcnt(0)
    v_cmp_gt_i32 vcc, 0, v27
    s_cbranch_vccnz k2_hr125a
    s_branch k2_hr125b
k2_hr126:
    s_mov_b32 s38, 0
k2_hr126a:
    buffer_load_dwordx4 v[28:31], v248, s[8:11], s55 offen sc1
    buffer_load_dwordx4 v[32:35], v248, s[8:11], s56 offen sc1
    buffer_load_dwordx4 v[36:39], v248, s[8:11], s57 offen sc1
    buffer_load_dwordx4 v[40:43], v248, s[8:11], s58 offen sc1
    buffer_load_dwordx4 v[44:47], v248, s[8:11], s59 offen sc1
    buffer_load_dwordx4 v[48:51], v248, s[8:11], s60 offen sc1
    buffer_load_dwordx4 v[52:55], v248, s[8:11], s61 offen sc1
    buffer_load_dwordx4 v[56:59], v248, s[8:11], s62 offen sc1
    buffer_load_dwordx4 v[60:63], v248, s[8:11], s63 offen sc1
    buffer_load_dwordx4 v[64:67], v249, s[8:11], s52 offen sc1
    s_add_u32 s38, s38, 1
    s_cmp_gt_u32 s38, 60000
    s_cbranch_scc1 k2_hr126b
    s_waitcnt vmcnt(0)
    v_cmp_gt_i32 vcc, 0, v31
    s_cbranch_vccnz k2_hr126a
    s_branch k2_hr126b
k2_hr127:
    s_mov_b32 s38, 0
k2_hr127a:
    buffer_load_dwordx4 v[32:35], v248, s[8:11], s56 offen sc1
    buffer_load_dwordx4 v[36:39], v248, s[8:11], s57 offen sc1
    buffer_load_dwordx4 v[40:43], v248, s[8:11], s58 offen sc1
    buffer_load_dwordx4 v[44:47], v248, s[8:11], s59 offen sc1
    buffer_load_dwordx4 v[48:51], v248, s[8:11], s60 offen sc1
    buffer_load_dwordx4 v[52:55], v248, s[8:11], s61 offen sc1
    buffer_load_dwordx4 v[56:59], v248, s[8:11], s62 offen sc1
    buffer_load_dwordx4 v[60:63], v248, s[8:11], s63 offen sc1
    buffer_load_dwordx4 v[64:67], v249, s[8:11], s52 offen sc1
    buffer_load_dwordx4 v[68:71], v249, s[8:11], s53 offen sc1
    s_add_u32 s38, s38, 1
    s_cmp_gt_u32 s38, 60000
    s_cbranch_scc1 k2_hr127b
    s_waitcnt vmcnt(0)
    v_cmp_gt_i32 vcc, 0, v35
    s_cbranch_vccnz k2_hr127a
    s_branch k2_hr127b
k2_hr128:
    s_mov_b32 s38, 0
k2_hr128a:
    buffer_load_dwordx4 v[36:39], v248, s[8:11], s57 offen sc1
    buffer_load_dwordx4 v[40:43], v248, s[8:11], s58 offen sc1
    buffer_load_dwordx4 v[44:47], v248, s[8:11], s59 offen sc1
    buffer_load_dwordx4 v[48:51], v248, s[8:11], s60 offen sc1
    buffer_load_dwordx4 v[52:55], v248, s[8:11], s61 offen sc1
    buffer_load_dwordx4 v[56:59], v248, s[8:11], s62 offen sc1
    buffer_load_dwordx4 v[60:63], v248, s[8:11], s63 offen sc1
    buffer_load_dwordx4 v[64:67], v249, s[8:11], s52 offen sc1
    buffer_load_dwordx4 v[68:71], v249, s[8:11], s53 offen sc1
    buffer_load_dwordx4 v[72:75], v249, s[8:11], s54 offen sc1
    s_add_u32 s38, s38, 1
    s_cmp_gt_u32 s38, 60000
    s_cbranch_scc1 k2_hr128b
    s_waitcnt vmcnt(0)
    v_cmp_gt_i32 vcc, 0, v39
    s_cbranch_vccnz k2_hr128a
    s_branch k2_hr128b
k2_hr129:
    s_mov_b32 s38, 0
k2_hr129a:
    buffer_load_dwordx4 v[40:43], v248, s[8:11], s58 offen sc1
    buffer_load_dwordx4 v[44:47], v248, s[8:11], s59 offen sc1
    buffer_load_dwordx4 v[48:51], v248, s[8:11], s60 offen sc1
    buffer_load_dwordx4 v[52:55], v248, s[8:11], s61 offen sc1
    buffer_load_dwordx4 v[56:59], v248, s[8:11], s62 offen sc1
    buffer_load_dwordx4 v[60:63], v248, s[8:11], s63 offen sc1
    buffer_load_dwordx4 v[64:67], v249, s[8:11], s52 offen sc1
    buffer_load_dwordx4 v[68:71], v249, s[8:11], s53 offen sc1
    buffer_load_dwordx4 v[72:75], v249, s[8:11], s54 offen sc1
    buffer_load_dwordx4 v[76:79], v249, s[8:11], s55 offen sc1
    s_add_u32 s38, s38, 1
    s_cmp_gt_u32 s38, 60000
    s_cbranch_scc1 k2_hr129b
    s_waitcnt vmcnt(0)
    v_cmp_gt_i32 vcc, 0, v43
    s_cbranch_vccnz k2_hr129a
    s_branch k2_hr129b
k2_hr130:
    s_mov_b32 s38, 0
k2_hr130a:
    buffer_load_dwordx4 v[44:47], v248, s[8:11], s59 offen sc1
    buffer_load_dwordx4 v[48:51], v248, s[8:11], s60 offen sc1
    buffer_load_dwordx4 v[52:55], v248, s[8:11], s61 offen sc1
    buffer_load_dwordx4 v[56:59], v248, s[8:11], s62 offen sc1
    buffer_load_dwordx4 v[60:63], v248, s[8:11], s63 offen sc1
    buffer_load_dwordx4 v[64:67], v249, s[8:11], s52 offen sc1
    buffer_load_dwordx4 v[68:71], v249, s[8:11], s53 offen sc1
    buffer_load_dwordx4 v[72:75], v249, s[8:11], s54 offen sc1
    buffer_load_dwordx4 v[76:79], v249, s[8:11], s55 offen sc1
    buffer_load_dwordx4 v[80:83], v249, s[8:11], s56 offen sc1
    s_add_u32 s38, s38, 1
    s_cmp_gt_u32 s38, 60000
    s_cbranch_scc1 k2_hr130b
    s_waitcnt vmcnt(0)
    v_cmp_gt_i32 vcc, 0, v47
    s_cbranch_vccnz k2_hr130a
    s_branch k2_hr130b
k2_hr131:
    s_mov_b32 s38, 0
k2_hr131a:
    buffer_load_dwordx4 v[48:51], v248, s[8:11], s60 offen sc1
    buffer_load_dwordx4 v[52:55], v248, s[8:11], s61 offen sc1
    buffer_load_dwordx4 v[56:59], v248, s[8:11], s62 offen sc1
    buffer_load_dwordx4 v[60:63], v248, s[8:11], s63 offen sc1
    buffer_load_dwordx4 v[64:67], v249, s[8:11], s52 offen sc1
    buffer_load_dwordx4 v[68:71], v249, s[8:11], s53 offen sc1
    buffer_load_dwordx4 v[72:75], v249, s[8:11], s54 offen sc1
    buffer_load_dwordx4 v[76:79], v249, s[8:11], s55 offen sc1
    buffer_load_dwordx4 v[80:83], v249, s[8:11], s56 offen sc1
    buffer_load_dwordx4 v[84:87], v249, s[8:11], s57 offen sc1
    s_add_u32 s38, s38, 1
    s_cmp_gt_u32 s38, 60000
    s_cbranch_scc1 k2_hr131b
    s_waitcnt vmcnt(0)
    v_cmp_gt_i32 vcc, 0, v51
    s_cbranch_vccnz k2_hr131a
    s_branch k2_hr131b
k2_hr132:
    s_mov_b32 s38, 0
k2_hr132a:
    buffer_load_dwordx4 v[52:55], v248, s[8:11], s61 offen sc1
    buffer_load_dwordx4 v[56:59], v248, s[8:11], s62 offen sc1
    buffer_load_dwordx4 v[60:63], v248, s[8:11], s63 offen sc1
    buffer_load_dwordx4 v[64:67], v249, s[8:11], s52 offen sc1
    buffer_load_dwordx4 v[68:71], v249, s[8:11], s53 offen sc1
    buffer_load_dwordx4 v[72:75], v249, s[8:11], s54 offen sc1
    buffer_load_dwordx4 v[76:79], v249, s[8:11], s55 offen sc1
    buffer_load_dwordx4 v[80:83], v249, s[8:11], s56 offen sc1
    buffer_load_dwordx4 v[84:87], v249, s[8:11], s57 offen sc1
    buffer_load_dwordx4 v[88:91], v249, s[8:11], s58 offen sc1
    s_add_u32 s38, s38, 1
    s_cmp_gt_u32 s38, 60000
    s_cbranch_scc1 k2_hr132b
    s_waitcnt vmcnt(0)
    v_cmp_gt_i32 vcc, 0, v55
    s_cbranch_vccnz k2_hr132a
    s_branch k2_hr132b
k2_hr133:
    s_mov_b32 s38, 0
k2_hr133a:
    buffer_load_dwordx4 v[56:59], v248, s[8:11], s62 offen sc1
    buffer_load_dwordx4 v[60:63], v248, s[8:11], s63 offen sc1
    buffer_load_dwordx4 v[64:67], v249, s[8:11], s52 offen sc1
    buffer_load_dwordx4 v[68:71], v249, s[8:11], s53 offen sc1
    buffer_load_dwordx4 v[72:75], v249, s[8:11], s54 offen sc1
    buffer_load_dwordx4 v[76:79], v249, s[8:11], s55 offen sc1
    buffer_load_dwordx4 v[80:83], v249, s[8:11], s56 offen sc1
    buffer_load_dwordx4 v[84:87], v249, s[8:11], s57 offen sc1
    buffer_load_dwordx4 v[88:91], v249, s[8:11], s58 offen sc1
    buffer_load_dwordx4 v[92:95], v249, s[8:11], s59 offen sc1
    s_add_u32 s38, s38, 1
    s_cmp_gt_u32 s38, 60000
    s_cbranch_scc1 k2_hr133b
    s_waitcnt vmcnt(0)
    v_cmp_gt_i32 vcc, 0, v59
    s_cbranch_vccnz k2_hr133a
    s_branch k2_hr133b
k2_hr134:
    s_mov_b32 s38, 0
k2_hr134a:
    buffer_load_dwordx4 v[60:63], v248, s[8:11], s63 offen sc1
    buffer_load_dwordx4 v[64:67], v249, s[8:11], s52 offen sc1
    buffer_load_dwordx4 v[68:71], v249, s[8:11], s53 offen sc1
    buffer_load_dwordx4 v[72:75], v249, s[8:11], s54 offen sc1
    buffer_load_dwordx4 v[76:79], v249, s[8:11], s55 offen sc1
    buffer_load_dwordx4 v[80:83], v249, s[8:11], s56 offen sc1
    buffer_load_dwordx4 v[84:87], v249, s[8:11], s57 offen sc1
    buffer_load_dwordx4 v[88:91], v249, s[8:11], s58 offen sc1
    buffer_load_dwordx4 v[92:95], v249, s[8:11], s59 offen sc1
    buffer_load_dwordx4 v[96:99], v249, s[8:11], s60 offen sc1
    s_add_u32 s38, s38, 1
    s_cmp_gt_u32 s38, 60000
    s_cbranch_scc1 k2_hr134b
    s_waitcnt vmcnt(0)
    v_cmp_gt_i32 vcc, 0, v63
    s_cbranch_vccnz k2_hr134a
    s_branch k2_hr134b
k2_hr135:
    s_mov_b32 s38, 0
k2_hr135a:
    buffer_load_dwordx4 v[64:67], v249, s[8:11], s52 offen sc1
    buffer_load_dwordx4 v[68:71], v249, s[8:11], s53 offen sc1
    buffer_load_dwordx4 v[72:75], v249, s[8:11], s54 offen sc1
    buffer_load_dwordx4 v[76:79], v249, s[8:11], s55 offen sc1
    buffer_load_dwordx4 v[80:83], v249, s[8:11], s56 offen sc1
    buffer_load_dwordx4 v[84:87], v249, s[8:11], s57 offen sc1
    buffer_load_dwordx4 v[88:91], v249, s[8:11], s58 offen sc1
    buffer_load_dwordx4 v[92:95], v249, s[8:11], s59 offen sc1
    buffer_load_dwordx4 v[96:99], v249, s[8:11], s60 offen sc1
    buffer_load_dwordx4 v[100:103], v249, s[8:11], s61 offen sc1
    s_add_u32 s38, s38, 1
    s_cmp_gt_u32 s38, 60000
    s_cbranch_scc1 k2_hr135b
    s_waitcnt vmcnt(0)
    v_cmp_gt_i32 vcc, 0, v67
    s_cbranch_vccnz k2_hr135a
    s_branch k2_hr135b
k2_hr136:
    s_mov_b32 s38, 0
k2_hr136a:
    buffer_load_dwordx4 v[68:71], v249, s[8:11], s53 offen sc1
    s_add_u32 s38, s38, 1
    s_cmp_gt_u32 s38, 60000
    s_cbranch_scc1 k2_hr136b
    s_waitcnt vmcnt(0)
    v_cmp_gt_i32 vcc, 0, v71
    s_cbranch_vccnz k2_hr136a
    s_branch k2_hr136b
k2_hr137:
    s_mov_b32 s38, 0
k2_hr137a:
    buffer_load_dwordx4 v[72:75], v249, s[8:11], s54 offen sc1
    s_add_u32 s38, s38, 1
    s_cmp_gt_u32 s38, 60000
    s_cbranch_scc1 k2_hr137b
    s_waitcnt vmcnt(0)
    v_cmp_gt_i32 vcc, 0, v75
    s_cbranch_vccnz k2_hr137a
    s_branch k2_hr137b
k2_hr138:
    s_mov_b32 s38, 0
k2_hr138a:
    buffer_load_dwordx4 v[76:79], v249, s[8:11], s55 offen sc1
    s_add_u32 s38, s38, 1
    s_cmp_gt_u32 s38, 60000
    s_cbranch_scc1 k2_hr138b
    s_waitcnt vmcnt(0)
    v_cmp_gt_i32 vcc, 0, v79
    s_cbranch_vccnz k2_hr138a
    s_branch k2_hr138b
k2_hr139:
    s_mov_b32 s38, 0
k2_hr139a:
    buffer_load_dwordx4 v[80:83], v249, s[8:11], s56 offen sc1
    s_add_u32 s38, s38, 1
    s_cmp_gt_u32 s38, 60000
    s_cbranch_scc1 k2_hr139b
    s_waitcnt vmcnt(0)
    v_cmp_gt_i32 vcc, 0, v83
    s_cbranch_vccnz k2_hr139a
    s_branch k2_hr139b
k2_hr140:
    s_mov_b32 s38, 0
k2_hr140a:
    buffer_load_dwordx4 v[84:87], v249, s[8:11], s57 offen sc1
    s_add_u32 s38, s38, 1
    s_cmp_gt_u32 s38, 60000
    s_cbranch_scc1 k2_hr140b
    s_waitcnt vmcnt(0)
    v_cmp_gt_i32 vcc, 0, v87
    s_cbranch_vccnz k2_hr140a
    s_branch k2_hr140b
k2_hr141:
    s_mov_b32 s38, 0
k2_hr141a:
    buffer_load_dwordx4 v[88:91], v249, s[8:11], s58 offen sc1
    s_add_u32 s38, s38, 1
    s_cmp_gt_u32 s38, 60000
    s_cbranch_scc1 k2_hr141b
    s_waitcnt vmcnt(0)
    v_cmp_gt_i32 vcc, 0, v91
    s_cbranch_vccnz k2_hr141a
    s_branch k2_hr141b
k2_hr142:
    s_mov_b32 s38, 0
k2_hr142a:
    buffer_load_dwordx4 v[92:95], v249, s[8:11], s59 offen sc1
    s_add_u32 s38, s38, 1
    s_cmp_gt_u32 s38, 60000
    s_cbranch_scc1 k2_hr142b
    s_waitcnt vmcnt(0)
    v_cmp_gt_i32 vcc, 0, v95
    s_cbranch_vccnz k2_hr142a
    s_branch k2_hr142b
k2_hr143:
    s_mov_b32 s38, 0
k2_hr143a:
    buffer_load_dwordx4 v[96:99], v249, s[8:11], s60 offen sc1
    s_add_u32 s38, s38, 1
    s_cmp_gt_u32 s38, 60000
    s_cbranch_scc1 k2_hr143b
    s_waitcnt vmcnt(0)
    v_cmp_gt_i32 vcc, 0, v99
    s_cbranch_vccnz k2_hr143a
    s_branch k2_hr143b
k2_hr144:
    s_mov_b32 s38, 0
k2_hr144a:
    buffer_load_dwordx4 v[100:103], v249, s[8:11], s61 offen sc1
    s_add_u32 s38, s38, 1
    s_cmp_gt_u32 s38, 60000
    s_cbranch_scc1 k2_hr144b
    s_waitcnt vmcnt(0)
    v_cmp_gt_i32 vcc, 0, v103
    s_cbranch_vccnz k2_hr144a
    s_branch k2_hr144b
k2_hr145:
    s_mov_b32 s38, 0
k2_hr145a:
    buffer_load_dwordx4 v[104:107], v249, s[8:11], s62 offen sc1
    s_add_u32 s38, s38, 1
    s_cmp_gt_u32 s38, 60000
    s_cbranch_scc1 k2_hr145b
    s_waitcnt vmcnt(0)
    v_cmp_gt_i32 vcc, 0, v107
    s_cbranch_vccnz k2_hr145a
    s_branch k2_hr145b
k2_hr146:
    s_mov_b32 s38, 0
k2_hr146a:
    buffer_load_dwordx4 v[108:111], v249, s[8:11], s63 offen sc1
    s_add_u32 s38, s38, 1
    s_cmp_gt_u32 s38, 60000
    s_cbranch_scc1 k2_hr146b
    s_waitcnt vmcnt(0)
    v_cmp_gt_i32 vcc, 0, v111
    s_cbranch_vccnz k2_hr146a
    s_branch k2_hr146b
k2_hr147:
    s_mov_b32 s38, 0
k2_hr147a:
    buffer_load_dwordx4 v[112:115], v250, s[8:11], s52 offen sc1
    s_add_u32 s38, s38, 1
    s_cmp_gt_u32 s38, 60000
    s_cbranch_scc1 k2_hr147b
    s_waitcnt vmcnt(0)
    v_cmp_gt_i32 vcc, 0, v115
    s_cbranch_vccnz k2_hr147a
    s_branch k2_hr147b
k2_hr148:
    s_mov_b32 s38, 0
k2_hr148a:
    buffer_load_dwordx4 v[116:119], v250, s[8:11], s53 offen sc1
    s_add_u32 s38, s38, 1
    s_cmp_gt_u32 s38, 60000
    s_cbranch_scc1 k2_hr148b
    s_waitcnt vmcnt(0)
    v_cmp_gt_i32 vcc, 0, v119
    s_cbranch_vccnz k2_hr148a
    s_branch k2_hr148b
k2_hr149:
    s_mov_b32 s38, 0
k2_hr149a:
    buffer_load_dwordx4 v[120:123], v250, s[8:11], s54 offen sc1
    s_add_u32 s38, s38, 1
    s_cmp_gt_u32 s38, 60000
    s_cbranch_scc1 k2_hr149b
    s_waitcnt vmcnt(0)
    v_cmp_gt_i32 vcc, 0, v123
    s_cbranch_vccnz k2_hr149a
    s_branch k2_hr149b
k2_hr150:
    s_mov_b32 s38, 0
k2_hr150a:
    buffer_load_dwordx4 v[124:127], v250, s[8:11], s55 offen sc1
    s_add_u32 s38, s38, 1
    s_cmp_gt_u32 s38, 60000
    s_cbranch_scc1 k2_hr150b
    s_waitcnt vmcnt(0)
    v_cmp_gt_i32 vcc, 0, v127
    s_cbranch_vccnz k2_hr150a
    s_branch k2_hr150b
k2_hr151:
    s_mov_b32 s38, 0
k2_hr151a:
    buffer_load_dwordx4 v[128:131], v250, s[8:11], s56 offen sc1
    s_add_u32 s38, s38, 1
    s_cmp_gt_u32 s38, 60000
    s_cbranch_scc1 k2_hr151b
    s_waitcnt vmcnt(0)
    v_cmp_gt_i32 vcc, 0, v131
    s_cbranch_vccnz k2_hr151a
    s_branch k2_hr151b
k2_hr152:
    s_mov_b32 s38, 0
k2_hr152a:
    buffer_load_dwordx4 v[132:135], v250, s[8:11], s57 offen sc1
    s_add_u32 s38, s38, 1
    s_cmp_gt_u32 s38, 60000
    s_cbranch_scc1 k2_hr152b
    s_waitcnt vmcnt(0)
    v_cmp_gt_i32 vcc, 0, v135
    s_cbranch_vccnz k2_hr152a
    s_branch k2_hr152b
k2_hr153:
    s_mov_b32 s38, 0
k2_hr153a:
    buffer_load_dwordx4 v[136:139], v250, s[8:11], s58 offen sc1
    s_add_u32 s38, s38, 1
    s_cmp_gt_u32 s38, 60000
    s_cbranch_scc1 k2_hr153b
    s_waitcnt vmcnt(0)
    v_cmp_gt_i32 vcc, 0, v139
    s_cbranch_vccnz k2_hr153a
    s_branch k2_hr153b
k2_hr154:
    s_mov_b32 s38, 0
k2_hr154a:
    buffer_load_dwordx4 v[140:143], v250, s[8:11], s59 offen sc1
    s_add_u32 s38, s38, 1
    s_cmp_gt_u32 s38, 60000
    s_cbranch_scc1 k2_hr154b
    s_waitcnt vmcnt(0)
    v_cmp_gt_i32 vcc, 0, v143
    s_cbranch_vccnz k2_hr154a
    s_branch k2_hr154b
k2_hr155:
    s_mov_b32 s38, 0
k2_hr155a:
    buffer_load_dwordx4 v[144:147], v250, s[8:11], s60 offen sc1
    s_add_u32 s38, s38, 1
    s_cmp_gt_u32 s38, 60000
    s_cbranch_scc1 k2_hr155b
    s_waitcnt vmcnt(0)
    v_cmp_gt_i32 vcc, 0, v147
    s_cbranch_vccnz k2_hr155a
    s_branch k2_hr155b
k2_hr156:
    s_mov_b32 s38, 0
k2_hr156a:
    buffer_load_dwordx4 v[148:151], v250, s[8:11], s61 offen sc1
    s_add_u32 s38, s38, 1
    s_cmp_gt_u32 s38, 60000
    s_cbranch_scc1 k2_hr156b
    s_waitcnt vmcnt(0)
    v_cmp_gt_i32 vcc, 0, v151
    s_cbranch_vccnz k2_hr156a
    s_branch k2_hr156b
k2_hr157:
    s_mov_b32 s38, 0
k2_hr157a:
    buffer_load_dwordx4 v[152:155], v250, s[8:11], s62 offen sc1
    s_add_u32 s38, s38, 1
    s_cmp_gt_u32 s38, 60000
    s_cbranch_scc1 k2_hr157b
    s_waitcnt vmcnt(0)
    v_cmp_gt_i32 vcc, 0, v155
    s_cbranch_vccnz k2_hr157a
    s_branch k2_hr157b
k2_hr158:
    s_mov_b32 s38, 0
k2_hr158a:
    buffer_load_dwordx4 v[156:159], v250, s[8:11], s63 offen sc1
    s_add_u32 s38, s38, 1
    s_cmp_gt_u32 s38, 60000
    s_cbranch_scc1 k2_hr158b
    s_waitcnt vmcnt(0)
    v_cmp_gt_i32 vcc, 0, v159
    s_cbranch_vccnz k2_hr158a
    s_branch k2_hr158b
k2_hr159:
    s_mov_b32 s38, 0
k2_hr159a:
    buffer_load_dwordx4 v[160:163], v251, s[8:11], s52 offen sc1
    s_add_u32 s38, s38, 1
    s_cmp_gt_u32 s38, 60000
    s_cbranch_scc1 k2_hr159b
    s_waitcnt vmcnt(0)
    v_cmp_gt_i32 vcc, 0, v163
    s_cbranch_vccnz k2_hr159a
    s_branch k2_hr159b
k2_hr160:
    s_mov_b32 s38, 0
k2_hr160a:
    buffer_load_dwordx4 v[164:167], v251, s[8:11], s53 offen sc1
    s_add_u32 s38, s38, 1
    s_cmp_gt_u32 s38, 60000
    s_cbranch_scc1 k2_hr160b
    s_waitcnt vmcnt(0)
    v_cmp_gt_i32 vcc, 0, v167
    s_cbranch_vccnz k2_hr160a
    s_branch k2_hr160b
k2_hr161:
    s_mov_b32 s38, 0
k2_hr161a:
    buffer_load_dwordx4 v[168:171], v251, s[8:11], s54 offen sc1
    s_add_u32 s38, s38, 1
    s_cmp_gt_u32 s38, 60000
    s_cbranch_scc1 k2_hr161b
    s_waitcnt vmcnt(0)
    v_cmp_gt_i32 vcc, 0, v171
    s_cbranch_vccnz k2_hr161a
    s_branch k2_hr161b
k2_hr162:
    s_mov_b32 s38, 0
k2_hr162a:
    buffer_load_dwordx4 v[172:175], v251, s[8:11], s55 offen sc1
    s_add_u32 s38, s38, 1
    s_cmp_gt_u32 s38, 60000
    s_cbranch_scc1 k2_hr162b
    s_waitcnt vmcnt(0)
    v_cmp_gt_i32 vcc, 0, v175
    s_cbranch_vccnz k2_hr162a
    s_branch k2_hr162b
k2_hr163:
    s_mov_b32 s38, 0
k2_hr163a:
    buffer_load_dwordx4 v[176:179], v251, s[8:11], s56 offen sc1
    s_add_u32 s38, s38, 1
    s_cmp_gt_u32 s38, 60000
    s_cbranch_scc1 k2_hr163b
    s_waitcnt vmcnt(0)
    v_cmp_gt_i32 vcc, 0, v179
    s_cbranch_vccnz k2_hr163a
    s_branch k2_hr163b
k2_hr164:
    s_mov_b32 s38, 0
k2_hr164a:
    buffer_load_dwordx4 v[180:183], v251, s[8:11], s57 offen sc1
    s_add_u32 s38, s38, 1
    s_cmp_gt_u32 s38, 60000
    s_cbranch_scc1 k2_hr164b
    s_waitcnt vmcnt(0)
    v_cmp_gt_i32 vcc, 0, v183
    s_cbranch_vccnz k2_hr164a
    s_branch k2_hr164b
k2_hr165:
    s_mov_b32 s38, 0
k2_hr165a:
    buffer_load_dwordx4 v[184:187], v251, s[8:11], s58 offen sc1
    s_add_u32 s38, s38, 1
    s_cmp_gt_u32 s38, 60000
    s_cbranch_scc1 k2_hr165b
    s_waitcnt vmcnt(0)
    v_cmp_gt_i32 vcc, 0, v187
    s_cbranch_vccnz k2_hr165a
    s_branch k2_hr165b
k2_hr166:
    s_mov_b32 s38, 0
k2_hr166a:
    buffer_load_dwordx4 v[188:191], v251, s[8:11], s59 offen sc1
    s_add_u32 s38, s38, 1
    s_cmp_gt_u32 s38, 60000
    s_cbranch_scc1 k2_hr166b
    s_waitcnt vmcnt(0)
    v_cmp_gt_i32 vcc, 0, v191
    s_cbranch_vccnz k2_hr166a
    s_branch k2_hr166b
k2_hr167:
    s_mov_b32 s38, 0
k2_hr167a:
    buffer_load_dwordx4 v[192:195], v251, s[8:11], s60 offen sc1
    s_add_u32 s38, s38, 1
    s_cmp_gt_u32 s38, 60000
    s_cbranch_scc1 k2_hr167b
    s_waitcnt vmcnt(0)
    v_cmp_gt_i32 vcc, 0, v195
    s_cbranch_vccnz k2_hr167a
    s_branch k2_hr167b
k2_hr168:
    s_mov_b32 s38, 0
k2_hr168a:
    buffer_load_dwordx4 v[196:199], v251, s[8:11], s61 offen sc1
    s_add_u32 s38, s38, 1
    s_cmp_gt_u32 s38, 60000
    s_cbranch_scc1 k2_hr168b
    s_waitcnt vmcnt(0)
    v_cmp_gt_i32 vcc, 0, v199
    s_cbranch_vccnz k2_hr168a
    s_branch k2_hr168b
k2_hr169:
    s_mov_b32 s38, 0
k2_hr169a:
    buffer_load_dwordx4 v[200:203], v251, s[8:11], s62 offen sc1
    s_add_u32 s38, s38, 1
    s_cmp_gt_u32 s38, 60000
    s_cbranch_scc1 k2_hr169b
    s_waitcnt vmcnt(0)
    v_cmp_gt_i32 vcc, 0, v203
    s_cbranch_vccnz k2_hr169a
    s_branch k2_hr169b
k2_hr170:
    s_mov_b32 s38, 0
k2_hr170a:
    buffer_load_dwordx4 v[204:207], v251, s[8:11], s63 offen sc1
    s_add_u32 s38, s38, 1
    s_cmp_gt_u32 s38, 60000
    s_cbranch_scc1 k2_hr170b
    s_waitcnt vmcnt(0)
    v_cmp_gt_i32 vcc, 0, v207
    s_cbranch_vccnz k2_hr170a
    s_branch k2_hr170b
k2_end:
.section .rodata,"a"
.p2align 6
.amdhsa_kernel interleave_layers__spectral_fnet__dense_activation_relu__prompt_kernel
  .amdhsa_next_free_vgpr 512
  .amdhsa_next_free_sgpr 100
  .amdhsa_accum_offset 256
  .amdhsa_group_segment_fixed_size 0
  .amdhsa_kernarg_size 88
  .amdhsa_user_sgpr_count 2
  .amdhsa_user_sgpr_kernarg_segment_ptr 1
  .amdhsa_system_sgpr_workgroup_id_x 1
.end_amdhsa_kernel
```
